```python
import torch

def _softmax(x, axis=-1):
    return torch.softmax(x, dim=axis)
def _gelu(x):
    return torch.nn.functional.gelu(x, approximate="tanh")
def _silu(x):
    return torch.nn.functional.silu(x)
def _sigmoid(x):
    return torch.sigmoid(x)
def _layernorm(x, axis=-1, eps=1e-5):
    m = x.mean(dim=axis, keepdim=True)
    v = x.var(dim=axis, keepdim=True, unbiased=False)
    return (x - m) / torch.sqrt(v + eps)
def _scatter_add(tgt, idx, src, axis=0):
    return tgt.clone().index_add_(axis, idx, src)
def _segment_sum(src, seg, n):
    out = torch.zeros((n,) + src.shape[1:], dtype=src.dtype)
    return out.index_add_(0, seg, src)
def _pad(x, pw):
    flat = tuple(v for pair in reversed(pw) for v in pair)
    return torch.nn.functional.pad(x, flat)

kernel_name = 'sequential_preLN__linear_attn_block__glu_gated_glu__prompt'

def setup_inputs():

    _w = (lambda a: (lambda t: t.to(torch.bfloat16) if t.is_floating_point() else t)(torch.as_tensor(a)))
    def _A_setup():
        B, S, D = 1, 2048, 576
        return {
            "x": _w((lambda *s: torch.randn(*s, dtype=torch.bfloat16) * 0.05)(B, S, D)),
            "wqkv": _w((lambda *s: torch.randn(*s, dtype=torch.bfloat16) * 0.05)(D, 3 * D)),
            "wo": _w((lambda *s: torch.randn(*s, dtype=torch.bfloat16) * 0.05)(D, D)),
        }
    _A_in = _A_setup()

    def _B_setup():
        B, S, D, F = 1, 2048, 576, 4608
        return {
            "x": _w((lambda *s: torch.randn(*s, dtype=torch.bfloat16) * 0.05)(B, S, D)),
            "w_gate": _w((lambda *s: torch.randn(*s, dtype=torch.bfloat16) * 0.05)(D, F)),
            "w_up": _w((lambda *s: torch.randn(*s, dtype=torch.bfloat16) * 0.05)(D, F)),
            "w_down": _w((lambda *s: torch.randn(*s, dtype=torch.bfloat16) * 0.05)(F, D)),
        }
    _B_in = _B_setup()

    return {
        "A_x": _A_in["x"],
        "A_wqkv": _A_in["wqkv"],
        "A_wo": _A_in["wo"],
        "B_x": _B_in["x"],
        "B_w_gate": _B_in["w_gate"],
        "B_w_up": _B_in["w_up"],
        "B_w_down": _B_in["w_down"],
    }

def reference(A_x, A_wqkv, A_wo, B_x, B_w_gate, B_w_up, B_w_down):
    def _A_ref(x, wqkv, wo):
        B, S, D = x.shape
        H = 32; Dh = D // H
        qkv = (lambda x, *d: x.permute(*d))((x @ wqkv).reshape(B, S, 3, H, Dh), 2, 0, 3, 1, 4)
        q, k, v = qkv[0], qkv[1], qkv[2]
        phi = lambda t: torch.where(t > 0, t + 1, torch.exp(t)) + 1e-6
        pq, pk = phi(q), phi(k)
        kv = torch.einsum("bhsd,bhse->bhde", pk, v)
        z = torch.einsum("bhsd->bhd", pk)
        num = torch.einsum("bhqd,bhde->bhqe", pq, kv)
        den = torch.einsum("bhqd,bhd->bhq", pq, z)[..., None] + 1e-6
        o = num / den
        return (lambda x, *d: x.permute(*d))(o, 0, 2, 1, 3).reshape(B, S, D) @ wo

    def _B_ref(x, w_gate, w_up, w_down):
        g = torch.einsum("bsd,df->bsf", x, w_gate)
        u = torch.einsum("bsd,df->bsf", x, w_up)
        h = _sigmoid(g) * u
        return torch.einsum("bsf,fd->bsd", h, w_down)

    x = A_x
    h = x + _A_ref(_layernorm(x, axis=-1), A_wqkv, A_wo)
    h2 = h + _B_ref(_layernorm(h, axis=-1), B_w_gate, B_w_up, B_w_down)
    return h2
```

```asm
; @launch kernel=qkv_kernel grid=(256,1,1) block=(256,1,1) lds=132096
; @launch kernel=attn_kernel grid=(256,1,1) block=(512,1,1) lds=158720
; @launch kernel=ffn_kernel grid=(256,1,1) block=(256,1,1) lds=147968
; @launch kernel=red_kernel grid=(256,1,1) block=(576,1,1) lds=0
.amdgcn_target "amdgcn-amd-amdhsa--gfx950"
.text
.globl qkv_kernel
.p2align 8
.type qkv_kernel,@function
qkv_kernel:

    s_cmp_ge_u32 s2, 256
    s_cbranch_scc1 L_k1_done
    s_load_dwordx4 s[4:7], s[0:1], 0
    s_load_dwordx4 s[28:31], s[0:1], 64
    s_load_dwordx2 s[56:57], s[0:1], 16
    s_load_dwordx4 s[88:91], s[0:1], 32
    s_load_dwordx2 s[86:87], s[0:1], 48
    s_getpc_b64 s[52:53]
L_k1_pc:
    s_lshr_b32 s26, s2, 3
    s_lshl_b32 s54, s26, 5
    v_add_u32 v251, s54, v0
    v_lshlrev_b32 v251, 7, v251
    v_cmp_gt_u32 vcc, 32, v0
    v_min_u32 v251, L_code_end-L_k1_pc-4, v251
    s_and_saveexec_b64 s[58:59], vcc
    s_cbranch_execz L_k1_nopf
    global_load_dword v252, v251, s[52:53]
L_k1_nopf:
    s_mov_b64 exec, -1
    s_mul_i32 s47, s26, 288
    s_and_b32 s48, s2, 1
    s_mul_i32 s48, s48, 9216
    s_add_u32 s47, s47, s48
    v_add_u32 v4, s47, v0
    v_lshlrev_b32 v4, 7, v4
    v_mov_b32 v6, 2146435072
    v_add_u32 v7, 0x8000, v4
    v_cndmask_b32 v7, v6, v7, vcc
    s_mul_i32 s47, s26, 162
    v_cmp_gt_u32 vcc, 162, v0
    v_min_u32 v5, 161, v0
    v_add_u32 v5, s47, v5
    v_mul_u32_u24 v11, 58255, v5
    v_lshrrev_b32 v11, 19, v11
    v_mul_u32_u24 v8, 9, v11
    v_sub_u32 v8, v5, v8
    v_mul_u32_u24 v9, 11, v8
    v_lshrrev_b32 v9, 5, v9
    v_mul_u32_u24 v10, 3, v9
    v_sub_u32 v8, v8, v10
    v_mul_u32_u24 v11, 3456, v11
    v_mul_u32_u24 v9, 1152, v9
    v_lshl_add_u32 v11, v8, 7, v11
    s_bfe_u32 s48, s2, 0x20001
    s_mul_i32 s48, s48, 288
    s_and_b32 s48, s48, 0xff80
    v_add3_u32 v5, v11, v9, s48
    v_cndmask_b32 v5, v6, v5, vcc
    v_lshrrev_b32 v1, 6, v0
    s_nop 0
    v_readfirstlane_b32 s3, v1
    v_and_b32 v1, 63, v0
    s_waitcnt lgkmcnt(0)
    s_mov_b32 s8, s4
    s_and_b32 s9, s5, 0xffff
    s_mov_b32 s10, 2359296
    s_mov_b32 s11, 0x00020000
    s_mov_b32 s12, s6
    s_and_b32 s13, s7, 0xffff
    s_mov_b32 s14, 1990656
    s_mov_b32 s15, 0x00020000
    buffer_load_dword v252, v4, s[8:11], 0 offen
    buffer_load_dword v252, v5, s[12:15], 0 offen
    buffer_load_dword v252, v7, s[8:11], 0 offen
    s_and_b32 s24, s2, 1
    s_lshl_b32 s24, s24, 3
    s_and_b32 s27, s26, 7
    s_add_u32 s24, s24, s27
    s_bfe_u32 s25, s2, 0x20001
    s_lshl_b32 s25, s25, 2
    s_lshr_b32 s26, s26, 3
    s_add_u32 s25, s25, s26
    s_lshl_b32 s32, s24, 7
    s_lshl_b32 s33, s3, 5
    s_add_u32 s32, s32, s33
    v_and_b32 v2, 31, v1
    v_lshrrev_b32 v3, 5, v1
    v_lshrrev_b32 v8, 3, v1
    v_bfe_u32 v9, v1, 4, 1
    v_lshlrev_b32 v9, 2, v9
    v_and_b32 v10, 7, v1
    v_xor_b32 v10, v10, v9
    v_mul_u32_u24 v8, 1152, v8
    v_lshl_add_u32 v4, v10, 4, v8
    v_add_u32 v5, 9216, v4
    v_add_u32 v6, 18432, v4
    v_add_u32 v7, 27648, v4
    s_mul_i32 s44, s32, 1152
    v_lshrrev_b32 v12, 4, v1
    v_and_b32 v13, 15, v1
    v_lshlrev_b32 v14, 2, v12
    v_xor_b32 v13, v13, v14
    v_min_u32 v13, 14, v13
    v_mul_u32_u24 v14, 13, v13
    v_lshrrev_b32 v14, 6, v14
    v_mul_u32_u24 v15, 5, v14
    v_sub_u32 v15, v13, v15
    v_mul_u32_u24 v14, 1152, v14
    v_lshl_add_u32 v14, v15, 4, v14
    v_mul_u32_u24 v12, 3456, v12
    v_add_u32 v8, v14, v12
    v_add_u32 v9, 13824, v8
    s_mul_i32 s34, s25, 72
    s_and_b32 s34, s34, 0xfff0
    s_and_b32 s39, s25, 1
    s_mul_i32 s35, s3, 27648
    s_add_u32 s35, s35, s34
    s_mul_i32 s36, s3, 4160
    s_lshl_b32 s38, s3, 11
    s_add_u32 s38, s38, 66560
    s_mov_b32 s62, s36
    s_mov_b32 s63, s38
    s_mov_b32 s46, 0
    s_add_u32 m0, s62, 0
    s_nop 0
    buffer_load_dwordx4 v4, s[8:11], s44 offen lds
    s_add_u32 m0, s62, 1040
    s_nop 0
    buffer_load_dwordx4 v5, s[8:11], s44 offen lds
    s_add_u32 m0, s62, 2080
    s_nop 0
    buffer_load_dwordx4 v6, s[8:11], s44 offen lds
    s_add_u32 m0, s62, 3120
    s_nop 0
    buffer_load_dwordx4 v7, s[8:11], s44 offen lds
    s_add_u32 s44, s44, 128
    s_add_u32 m0, s63, 0
    s_nop 0
    buffer_load_dwordx4 v8, s[12:15], s35 offen lds
    s_add_u32 m0, s63, 1024
    s_nop 0
    buffer_load_dwordx4 v9, s[12:15], s35 offen lds
    s_add_u32 s35, s35, 110592
    s_add_u32 m0, s63, 8192
    s_nop 0
    buffer_load_dwordx4 v8, s[12:15], s35 offen lds
    s_add_u32 m0, s63, 9216
    s_nop 0
    buffer_load_dwordx4 v9, s[12:15], s35 offen lds
    s_add_u32 s35, s35, 110592
    s_add_u32 s62, s62, 16640
    s_add_u32 s63, s63, 16384
    s_add_u32 s46, s46, 1
    s_cmp_eq_u32 s46, 4
    s_cselect_b32 s62, s36, s62
    s_cselect_b32 s63, s38, s63
    s_cselect_b32 s46, 0, s46
    s_add_u32 m0, s62, 0
    s_nop 0
    buffer_load_dwordx4 v4, s[8:11], s44 offen lds
    s_add_u32 m0, s62, 1040
    s_nop 0
    buffer_load_dwordx4 v5, s[8:11], s44 offen lds
    s_add_u32 m0, s62, 2080
    s_nop 0
    buffer_load_dwordx4 v6, s[8:11], s44 offen lds
    s_add_u32 m0, s62, 3120
    s_nop 0
    buffer_load_dwordx4 v7, s[8:11], s44 offen lds
    s_add_u32 s44, s44, 128
    s_add_u32 m0, s63, 0
    s_nop 0
    buffer_load_dwordx4 v8, s[12:15], s35 offen lds
    s_add_u32 m0, s63, 1024
    s_nop 0
    buffer_load_dwordx4 v9, s[12:15], s35 offen lds
    s_add_u32 s35, s35, 110592
    s_add_u32 m0, s63, 8192
    s_nop 0
    buffer_load_dwordx4 v8, s[12:15], s35 offen lds
    s_add_u32 m0, s63, 9216
    s_nop 0
    buffer_load_dwordx4 v9, s[12:15], s35 offen lds
    s_add_u32 s35, s35, 110592
    s_add_u32 s62, s62, 16640
    s_add_u32 s63, s63, 16384
    s_add_u32 s46, s46, 1
    s_cmp_eq_u32 s46, 4
    s_cselect_b32 s62, s36, s62
    s_cselect_b32 s63, s38, s63
    s_cselect_b32 s46, 0, s46
    s_add_u32 s16, s30, 131072
    s_addc_u32 s17, s31, 0
    s_and_b32 s17, s17, 0xffff
    s_mov_b32 s18, 2392064
    s_mov_b32 s19, 0x00020000
    s_add_u32 s20, s30, 0
    s_addc_u32 s21, s31, 0
    s_and_b32 s21, s21, 0xffff
    s_mov_b32 s22, 58368
    s_mov_b32 s23, 0x00020000
    s_mov_b32 s40, s28
    s_and_b32 s41, s29, 0xffff
    s_mov_b32 s42, 256
    s_mov_b32 s43, 0x00020000
    s_lshl_b32 s37, s25, 2
    v_mov_b32 v253, 1
    v_mov_b32 v254, 2146435072
    v_cmp_eq_u32 vcc, 0, v1
    s_nop 1
    v_cndmask_b32 v254, v254, 0, vcc
    v_and_b32 v12, 3, v1
    v_bfe_u32 v13, v1, 2, 2
    v_bfe_u32 v14, v1, 4, 1
    v_lshl_add_u32 v15, v3, 3, v13
    v_lshlrev_b32 v15, 8, v15
    v_add_u32 v15, 66560, v15
    v_lshl_add_u32 v26, v14, 2, v12
    v_add_u32 v26, s39, v26
    s_lshl_b32 s45, s3, 3
    v_add_u32 v27, 0, v26
    v_bfe_u32 v28, v27, 3, 2
    v_xor_b32 v28, v28, v13
    v_and_b32 v27, 7, v27
    v_lshl_add_u32 v27, v27, 3, v15
    v_lshl_add_u32 v16, v28, 6, v27
    v_add_u32 v27, 8, v26
    v_bfe_u32 v28, v27, 3, 2
    v_xor_b32 v28, v28, v13
    v_and_b32 v27, 7, v27
    v_lshl_add_u32 v27, v27, 3, v15
    v_lshl_add_u32 v17, v28, 6, v27
    v_add_u32 v27, 16, v26
    v_bfe_u32 v28, v27, 3, 2
    v_xor_b32 v28, v28, v13
    v_and_b32 v27, 7, v27
    v_lshl_add_u32 v27, v27, 3, v15
    v_lshl_add_u32 v18, v28, 6, v27
    v_add_u32 v27, 24, v26
    v_bfe_u32 v28, v27, 3, 2
    v_xor_b32 v28, v28, v13
    v_and_b32 v27, 7, v27
    v_lshl_add_u32 v27, v27, 3, v15
    v_lshl_add_u32 v19, v28, 6, v27
    v_add_u32 v27, s45, v26
    v_bfe_u32 v28, v27, 3, 2
    v_xor_b32 v28, v28, v13
    v_and_b32 v27, 7, v27
    v_lshl_add_u32 v27, v27, 3, v15
    v_lshl_add_u32 v20, v28, 6, v27
    v_lshrrev_b32 v30, 3, v2
    v_mul_u32_u24 v30, 1040, v30
    v_and_b32 v31, 7, v2
    v_lshl_add_u32 v30, v31, 7, v30
    v_lshl_add_u32 v30, v3, 4, v30
    v_add_u32 v30, s36, v30
    v_bfe_u32 v31, v2, 1, 1
    v_lshl_add_u32 v26, v31, 6, v30
    v_xor_b32 v31, 1, v31
    v_lshl_add_u32 v27, v31, 6, v30
    s_add_u32 s82, s2, 0
    s_and_b32 s82, s82, 7
    s_lshr_b32 s83, s2, 3
    s_lshl_b32 s83, s83, 2
    s_add_u32 s83, s83, s3
    s_mul_i32 s84, s83, 41
    s_mul_i32 s85, s82, 1152
    v_min_u32 v248, 40, v1
    v_add_u32 v248, s84, v248
    v_min_u32 v248, 5183, v248
    v_mul_u32_u24 v249, 58255, v248
    v_lshrrev_b32 v249, 19, v249
    v_mul_u32_u24 v250, 9, v249
    v_sub_u32 v250, v248, v250
    v_mul_u32_u24 v249, 9216, v249
    v_lshl_add_u32 v249, v250, 7, v249
    v_add_u32 v249, s85, v249
    v_lshlrev_b32 v248, 7, v248
    v_mov_b32 v58, 0
    v_mov_b32 v32, 0x3f803f80
    v_mov_b32 v33, 0x3f803f80
    v_mov_b32 v34, 0x3f803f80
    v_mov_b32 v35, 0x3f803f80
    v_cmp_le_u32 s[60:61], 24, v2
    s_mov_b32 s47, 0
    v_mov_b32 v64, 0
    v_mov_b32 v65, 0
    v_mov_b32 v66, 0
    v_mov_b32 v67, 0
    v_mov_b32 v68, 0
    v_mov_b32 v69, 0
    v_mov_b32 v70, 0
    v_mov_b32 v71, 0
    v_mov_b32 v72, 0
    v_mov_b32 v73, 0
    v_mov_b32 v74, 0
    v_mov_b32 v75, 0
    v_mov_b32 v76, 0
    v_mov_b32 v77, 0
    v_mov_b32 v78, 0
    v_mov_b32 v79, 0
    v_mov_b32 v80, 0
    v_mov_b32 v81, 0
    v_mov_b32 v82, 0
    v_mov_b32 v83, 0
    v_mov_b32 v84, 0
    v_mov_b32 v85, 0
    v_mov_b32 v86, 0
    v_mov_b32 v87, 0
    v_mov_b32 v88, 0
    v_mov_b32 v89, 0
    v_mov_b32 v90, 0
    v_mov_b32 v91, 0
    v_mov_b32 v92, 0
    v_mov_b32 v93, 0
    v_mov_b32 v94, 0
    v_mov_b32 v95, 0
    v_mov_b32 v96, 0
    v_mov_b32 v97, 0
    v_mov_b32 v98, 0
    v_mov_b32 v99, 0
    v_mov_b32 v100, 0
    v_mov_b32 v101, 0
    v_mov_b32 v102, 0
    v_mov_b32 v103, 0
    v_mov_b32 v104, 0
    v_mov_b32 v105, 0
    v_mov_b32 v106, 0
    v_mov_b32 v107, 0
    v_mov_b32 v108, 0
    v_mov_b32 v109, 0
    v_mov_b32 v110, 0
    v_mov_b32 v111, 0
    v_mov_b32 v112, 0
    v_mov_b32 v113, 0
    v_mov_b32 v114, 0
    v_mov_b32 v115, 0
    v_mov_b32 v116, 0
    v_mov_b32 v117, 0
    v_mov_b32 v118, 0
    v_mov_b32 v119, 0
    v_mov_b32 v120, 0
    v_mov_b32 v121, 0
    v_mov_b32 v122, 0
    v_mov_b32 v123, 0
    v_mov_b32 v124, 0
    v_mov_b32 v125, 0
    v_mov_b32 v126, 0
    v_mov_b32 v127, 0
    v_mov_b32 v128, 0
    v_mov_b32 v129, 0
    v_mov_b32 v130, 0
    v_mov_b32 v131, 0
    v_mov_b32 v132, 0
    v_mov_b32 v133, 0
    v_mov_b32 v134, 0
    v_mov_b32 v135, 0
    v_mov_b32 v136, 0
    v_mov_b32 v137, 0
    v_mov_b32 v138, 0
    v_mov_b32 v139, 0
    v_mov_b32 v140, 0
    v_mov_b32 v141, 0
    v_mov_b32 v142, 0
    v_mov_b32 v143, 0
    v_mov_b32 v224, 0
    v_mov_b32 v225, 0
    v_mov_b32 v226, 0
    v_mov_b32 v227, 0
    v_mov_b32 v228, 0
    v_mov_b32 v229, 0
    v_mov_b32 v230, 0
    v_mov_b32 v231, 0
    v_mov_b32 v232, 0
    v_mov_b32 v233, 0
    v_mov_b32 v234, 0
    v_mov_b32 v235, 0
    v_mov_b32 v236, 0
    v_mov_b32 v237, 0
    v_mov_b32 v238, 0
    v_mov_b32 v239, 0
    s_waitcnt vmcnt(10)
    s_barrier
    ds_read_b128 v[36:39], v26 offset:0
    ds_read_b64_tr_b16 v[144:145], v16 offset:0
    ds_read_b64_tr_b16 v[146:147], v16 offset:1024
    ds_read_b64_tr_b16 v[148:149], v17 offset:0
    ds_read_b64_tr_b16 v[150:151], v17 offset:1024
    ds_read_b64_tr_b16 v[152:153], v18 offset:0
    ds_read_b64_tr_b16 v[154:155], v18 offset:1024
    ds_read_b64_tr_b16 v[156:157], v19 offset:0
    ds_read_b64_tr_b16 v[158:159], v19 offset:1024
    ds_read_b64_tr_b16 v[160:161], v20 offset:0
    ds_read_b64_tr_b16 v[162:163], v20 offset:1024
    ds_read_b128 v[40:43], v26 offset:32
    ds_read_b64_tr_b16 v[164:165], v16 offset:4096
    ds_read_b64_tr_b16 v[166:167], v16 offset:5120
    ds_read_b64_tr_b16 v[168:169], v17 offset:4096
    ds_read_b64_tr_b16 v[170:171], v17 offset:5120
    s_add_u32 m0, s62, 0
    s_nop 0
    buffer_load_dwordx4 v4, s[8:11], s44 offen lds
    ds_read_b64_tr_b16 v[172:173], v18 offset:4096
    ds_read_b64_tr_b16 v[174:175], v18 offset:5120
    s_waitcnt lgkmcnt(15)
    v_mfma_f32_32x32x16_bf16 v[64:79], v[144:147], v[36:39], v[64:79]
    s_add_u32 m0, s62, 1040
    s_nop 0
    buffer_load_dwordx4 v5, s[8:11], s44 offen lds
    ds_read_b64_tr_b16 v[176:177], v19 offset:4096
    ds_read_b64_tr_b16 v[178:179], v19 offset:5120
    s_waitcnt lgkmcnt(15)
    v_mfma_f32_32x32x16_bf16 v[80:95], v[148:151], v[36:39], v[80:95]
    s_waitcnt lgkmcnt(11)
    v_cndmask_b32 v156, v156, v32, s[60:61]
    v_cndmask_b32 v157, v157, v32, s[60:61]
    v_cndmask_b32 v158, v158, v32, s[60:61]
    v_cndmask_b32 v159, v159, v32, s[60:61]
    s_add_u32 m0, s62, 2080
    s_nop 0
    buffer_load_dwordx4 v6, s[8:11], s44 offen lds
    ds_read_b64_tr_b16 v[180:181], v20 offset:4096
    ds_read_b64_tr_b16 v[182:183], v20 offset:5120
    v_mfma_f32_32x32x16_bf16 v[96:111], v[152:155], v[36:39], v[96:111]
    v_mfma_f32_32x32x16_bf16 v[224:239], v[36:39], v[36:39], v[224:239]
    s_add_u32 m0, s62, 3120
    s_nop 0
    buffer_load_dwordx4 v7, s[8:11], s44 offen lds
    s_waitcnt vmcnt(12)
    s_barrier
    ds_read_b128 v[44:47], v27 offset:0
    ds_read_b64_tr_b16 v[184:185], v16 offset:8192
    ds_read_b64_tr_b16 v[186:187], v16 offset:9216
    v_mfma_f32_32x32x16_bf16 v[112:127], v[156:159], v[36:39], v[112:127]
    s_add_u32 s44, s44, 128
    s_add_u32 m0, s63, 0
    ds_read_b64_tr_b16 v[188:189], v17 offset:8192
    ds_read_b64_tr_b16 v[190:191], v17 offset:9216
    s_waitcnt lgkmcnt(15)
    v_mfma_f32_32x32x16_bf16 v[128:143], v[160:163], v[32:35], v[128:143]
    buffer_load_dwordx4 v8, s[12:15], s35 offen lds
    s_add_u32 m0, s63, 1024
    ds_read_b64_tr_b16 v[192:193], v18 offset:8192
    ds_read_b64_tr_b16 v[194:195], v18 offset:9216
    s_waitcnt lgkmcnt(15)
    v_mfma_f32_32x32x16_bf16 v[64:79], v[164:167], v[40:43], v[64:79]
    buffer_load_dwordx4 v9, s[12:15], s35 offen lds
    s_add_u32 s35, s35, 110592
    ds_read_b64_tr_b16 v[196:197], v19 offset:8192
    ds_read_b64_tr_b16 v[198:199], v19 offset:9216
    s_waitcnt lgkmcnt(15)
    v_mfma_f32_32x32x16_bf16 v[80:95], v[168:171], v[40:43], v[80:95]
    s_waitcnt lgkmcnt(11)
    v_cndmask_b32 v176, v176, v32, s[60:61]
    v_cndmask_b32 v177, v177, v32, s[60:61]
    v_cndmask_b32 v178, v178, v32, s[60:61]
    v_cndmask_b32 v179, v179, v32, s[60:61]
    s_add_u32 m0, s63, 8192
    s_nop 0
    buffer_load_dwordx4 v8, s[12:15], s35 offen lds
    ds_read_b64_tr_b16 v[200:201], v20 offset:8192
    ds_read_b64_tr_b16 v[202:203], v20 offset:9216
    v_mfma_f32_32x32x16_bf16 v[96:111], v[172:175], v[40:43], v[96:111]
    v_mfma_f32_32x32x16_bf16 v[224:239], v[40:43], v[40:43], v[224:239]
    s_add_u32 m0, s63, 9216
    s_nop 0
    buffer_load_dwordx4 v9, s[12:15], s35 offen lds
    ds_read_b128 v[48:51], v27 offset:32
    ds_read_b64_tr_b16 v[204:205], v16 offset:12288
    ds_read_b64_tr_b16 v[206:207], v16 offset:13312
    v_mfma_f32_32x32x16_bf16 v[112:127], v[176:179], v[40:43], v[112:127]
    s_add_u32 s35, s35, 110592
    s_add_u32 s62, s62, 16640
    s_add_u32 s63, s63, 16384
    s_add_u32 s46, s46, 1
    s_cmp_eq_u32 s46, 4
    s_cselect_b32 s62, s36, s62
    s_cselect_b32 s63, s38, s63
    s_cselect_b32 s46, 0, s46
    ds_read_b64_tr_b16 v[208:209], v17 offset:12288
    ds_read_b64_tr_b16 v[210:211], v17 offset:13312
    s_waitcnt lgkmcnt(15)
    v_mfma_f32_32x32x16_bf16 v[128:143], v[180:183], v[32:35], v[128:143]
    s_add_u32 m0, s62, 0
    s_nop 0
    buffer_load_dwordx4 v4, s[8:11], s44 offen lds
    ds_read_b64_tr_b16 v[212:213], v18 offset:12288
    ds_read_b64_tr_b16 v[214:215], v18 offset:13312
    s_waitcnt lgkmcnt(15)
    v_mfma_f32_32x32x16_bf16 v[64:79], v[184:187], v[44:47], v[64:79]
    s_add_u32 m0, s62, 1040
    s_nop 0
    buffer_load_dwordx4 v5, s[8:11], s44 offen lds
    ds_read_b64_tr_b16 v[216:217], v19 offset:12288
    ds_read_b64_tr_b16 v[218:219], v19 offset:13312
    s_waitcnt lgkmcnt(15)
    v_mfma_f32_32x32x16_bf16 v[80:95], v[188:191], v[44:47], v[80:95]
    s_waitcnt lgkmcnt(11)
    v_cndmask_b32 v196, v196, v32, s[60:61]
    v_cndmask_b32 v197, v197, v32, s[60:61]
    v_cndmask_b32 v198, v198, v32, s[60:61]
    v_cndmask_b32 v199, v199, v32, s[60:61]
    s_add_u32 m0, s62, 2080
    s_nop 0
    buffer_load_dwordx4 v6, s[8:11], s44 offen lds
    ds_read_b64_tr_b16 v[220:221], v20 offset:12288
    ds_read_b64_tr_b16 v[222:223], v20 offset:13312
    v_mfma_f32_32x32x16_bf16 v[96:111], v[192:195], v[44:47], v[96:111]
    v_mfma_f32_32x32x16_bf16 v[224:239], v[44:47], v[44:47], v[224:239]
    s_add_u32 m0, s62, 3120
    s_nop 0
    buffer_load_dwordx4 v7, s[8:11], s44 offen lds
    s_waitcnt vmcnt(14)
    s_barrier
    s_add_u32 s47, s47, 1
    s_cmp_eq_u32 s47, 4
    s_mov_b32 s48, 16384
    s_mov_b32 s49, 16640
    s_cselect_b32 s48, 0xffff4000, s48
    s_cselect_b32 s49, 0xffff3d00, s49
    s_cselect_b32 s47, 0, s47
    v_add_u32 v16, s48, v16
    v_add_u32 v17, s48, v17
    v_add_u32 v18, s48, v18
    v_add_u32 v19, s48, v19
    v_add_u32 v20, s48, v20
    v_add_u32 v26, s49, v26
    v_add_u32 v27, s49, v27
    ds_read_b128 v[36:39], v26 offset:0
    ds_read_b64_tr_b16 v[144:145], v16 offset:0
    ds_read_b64_tr_b16 v[146:147], v16 offset:1024
    v_mfma_f32_32x32x16_bf16 v[112:127], v[196:199], v[44:47], v[112:127]
    s_add_u32 s44, s44, 128
    s_add_u32 m0, s63, 0
    ds_read_b64_tr_b16 v[148:149], v17 offset:0
    ds_read_b64_tr_b16 v[150:151], v17 offset:1024
    s_waitcnt lgkmcnt(15)
    v_mfma_f32_32x32x16_bf16 v[128:143], v[200:203], v[32:35], v[128:143]
    buffer_load_dwordx4 v8, s[12:15], s35 offen lds
    s_add_u32 m0, s63, 1024
    ds_read_b64_tr_b16 v[152:153], v18 offset:0
    ds_read_b64_tr_b16 v[154:155], v18 offset:1024
    s_waitcnt lgkmcnt(15)
    v_mfma_f32_32x32x16_bf16 v[64:79], v[204:207], v[48:51], v[64:79]
    buffer_load_dwordx4 v9, s[12:15], s35 offen lds
    s_add_u32 s35, s35, 110592
    ds_read_b64_tr_b16 v[156:157], v19 offset:0
    ds_read_b64_tr_b16 v[158:159], v19 offset:1024
    s_waitcnt lgkmcnt(15)
    v_mfma_f32_32x32x16_bf16 v[80:95], v[208:211], v[48:51], v[80:95]
    s_waitcnt lgkmcnt(11)
    v_cndmask_b32 v216, v216, v32, s[60:61]
    v_cndmask_b32 v217, v217, v32, s[60:61]
    v_cndmask_b32 v218, v218, v32, s[60:61]
    v_cndmask_b32 v219, v219, v32, s[60:61]
    s_add_u32 m0, s63, 8192
    s_nop 0
    buffer_load_dwordx4 v8, s[12:15], s35 offen lds
    ds_read_b64_tr_b16 v[160:161], v20 offset:0
    ds_read_b64_tr_b16 v[162:163], v20 offset:1024
    v_mfma_f32_32x32x16_bf16 v[96:111], v[212:215], v[48:51], v[96:111]
    v_mfma_f32_32x32x16_bf16 v[224:239], v[48:51], v[48:51], v[224:239]
    s_add_u32 m0, s63, 9216
    s_nop 0
    buffer_load_dwordx4 v9, s[12:15], s35 offen lds
    ds_read_b128 v[40:43], v26 offset:32
    ds_read_b64_tr_b16 v[164:165], v16 offset:4096
    ds_read_b64_tr_b16 v[166:167], v16 offset:5120
    v_mfma_f32_32x32x16_bf16 v[112:127], v[216:219], v[48:51], v[112:127]
    s_add_u32 s35, s35, 110592
    s_add_u32 s62, s62, 16640
    s_add_u32 s63, s63, 16384
    s_add_u32 s46, s46, 1
    s_cmp_eq_u32 s46, 4
    s_cselect_b32 s62, s36, s62
    s_cselect_b32 s63, s38, s63
    s_cselect_b32 s46, 0, s46
    ds_read_b64_tr_b16 v[168:169], v17 offset:4096
    ds_read_b64_tr_b16 v[170:171], v17 offset:5120
    s_waitcnt lgkmcnt(15)
    v_mfma_f32_32x32x16_bf16 v[128:143], v[220:223], v[32:35], v[128:143]
    s_add_u32 m0, s62, 0
    s_nop 0
    buffer_load_dwordx4 v4, s[8:11], s44 offen lds
    ds_read_b64_tr_b16 v[172:173], v18 offset:4096
    ds_read_b64_tr_b16 v[174:175], v18 offset:5120
    s_waitcnt lgkmcnt(15)
    v_mfma_f32_32x32x16_bf16 v[64:79], v[144:147], v[36:39], v[64:79]
    s_add_u32 m0, s62, 1040
    s_nop 0
    buffer_load_dwordx4 v5, s[8:11], s44 offen lds
    ds_read_b64_tr_b16 v[176:177], v19 offset:4096
    ds_read_b64_tr_b16 v[178:179], v19 offset:5120
    s_waitcnt lgkmcnt(15)
    v_mfma_f32_32x32x16_bf16 v[80:95], v[148:151], v[36:39], v[80:95]
    s_waitcnt lgkmcnt(11)
    v_cndmask_b32 v156, v156, v32, s[60:61]
    v_cndmask_b32 v157, v157, v32, s[60:61]
    v_cndmask_b32 v158, v158, v32, s[60:61]
    v_cndmask_b32 v159, v159, v32, s[60:61]
    s_add_u32 m0, s62, 2080
    s_nop 0
    buffer_load_dwordx4 v6, s[8:11], s44 offen lds
    ds_read_b64_tr_b16 v[180:181], v20 offset:4096
    ds_read_b64_tr_b16 v[182:183], v20 offset:5120
    v_mfma_f32_32x32x16_bf16 v[96:111], v[152:155], v[36:39], v[96:111]
    v_mfma_f32_32x32x16_bf16 v[224:239], v[36:39], v[36:39], v[224:239]
    s_add_u32 m0, s62, 3120
    s_nop 0
    buffer_load_dwordx4 v7, s[8:11], s44 offen lds
    s_waitcnt vmcnt(20)
    s_barrier
    ds_read_b128 v[44:47], v27 offset:0
    ds_read_b64_tr_b16 v[184:185], v16 offset:8192
    ds_read_b64_tr_b16 v[186:187], v16 offset:9216
    v_mfma_f32_32x32x16_bf16 v[112:127], v[156:159], v[36:39], v[112:127]
    s_add_u32 s44, s44, 128
    s_add_u32 m0, s63, 0
    ds_read_b64_tr_b16 v[188:189], v17 offset:8192
    ds_read_b64_tr_b16 v[190:191], v17 offset:9216
    s_waitcnt lgkmcnt(15)
    v_mfma_f32_32x32x16_bf16 v[128:143], v[160:163], v[32:35], v[128:143]
    buffer_load_dwordx4 v8, s[12:15], s35 offen lds
    s_add_u32 m0, s63, 1024
    ds_read_b64_tr_b16 v[192:193], v18 offset:8192
    ds_read_b64_tr_b16 v[194:195], v18 offset:9216
    s_waitcnt lgkmcnt(15)
    v_mfma_f32_32x32x16_bf16 v[64:79], v[164:167], v[40:43], v[64:79]
    buffer_load_dwordx4 v9, s[12:15], s35 offen lds
    s_add_u32 s35, s35, 110592
    ds_read_b64_tr_b16 v[196:197], v19 offset:8192
    ds_read_b64_tr_b16 v[198:199], v19 offset:9216
    s_waitcnt lgkmcnt(15)
    v_mfma_f32_32x32x16_bf16 v[80:95], v[168:171], v[40:43], v[80:95]
    s_waitcnt lgkmcnt(11)
    v_cndmask_b32 v176, v176, v32, s[60:61]
    v_cndmask_b32 v177, v177, v32, s[60:61]
    v_cndmask_b32 v178, v178, v32, s[60:61]
    v_cndmask_b32 v179, v179, v32, s[60:61]
    s_add_u32 m0, s63, 8192
    s_nop 0
    buffer_load_dwordx4 v8, s[12:15], s35 offen lds
    ds_read_b64_tr_b16 v[200:201], v20 offset:8192
    ds_read_b64_tr_b16 v[202:203], v20 offset:9216
    v_mfma_f32_32x32x16_bf16 v[96:111], v[172:175], v[40:43], v[96:111]
    v_mfma_f32_32x32x16_bf16 v[224:239], v[40:43], v[40:43], v[224:239]
    s_add_u32 m0, s63, 9216
    s_nop 0
    buffer_load_dwordx4 v9, s[12:15], s35 offen lds
    ds_read_b128 v[48:51], v27 offset:32
    ds_read_b64_tr_b16 v[204:205], v16 offset:12288
    ds_read_b64_tr_b16 v[206:207], v16 offset:13312
    v_mfma_f32_32x32x16_bf16 v[112:127], v[176:179], v[40:43], v[112:127]
    s_add_u32 s35, s35, 110592
    s_add_u32 s62, s62, 16640
    s_add_u32 s63, s63, 16384
    s_add_u32 s46, s46, 1
    s_cmp_eq_u32 s46, 4
    s_cselect_b32 s62, s36, s62
    s_cselect_b32 s63, s38, s63
    s_cselect_b32 s46, 0, s46
    ds_read_b64_tr_b16 v[208:209], v17 offset:12288
    ds_read_b64_tr_b16 v[210:211], v17 offset:13312
    s_waitcnt lgkmcnt(15)
    v_mfma_f32_32x32x16_bf16 v[128:143], v[180:183], v[32:35], v[128:143]
    ds_read_b64_tr_b16 v[212:213], v18 offset:12288
    ds_read_b64_tr_b16 v[214:215], v18 offset:13312
    s_waitcnt lgkmcnt(15)
    v_mfma_f32_32x32x16_bf16 v[64:79], v[184:187], v[44:47], v[64:79]
    ds_read_b64_tr_b16 v[216:217], v19 offset:12288
    ds_read_b64_tr_b16 v[218:219], v19 offset:13312
    s_waitcnt lgkmcnt(15)
    v_mfma_f32_32x32x16_bf16 v[80:95], v[188:191], v[44:47], v[80:95]
    s_waitcnt lgkmcnt(11)
    v_cndmask_b32 v196, v196, v32, s[60:61]
    v_cndmask_b32 v197, v197, v32, s[60:61]
    v_cndmask_b32 v198, v198, v32, s[60:61]
    v_cndmask_b32 v199, v199, v32, s[60:61]
    ds_read_b64_tr_b16 v[220:221], v20 offset:12288
    ds_read_b64_tr_b16 v[222:223], v20 offset:13312
    v_mfma_f32_32x32x16_bf16 v[96:111], v[192:195], v[44:47], v[96:111]
    v_mfma_f32_32x32x16_bf16 v[224:239], v[44:47], v[44:47], v[224:239]
    s_waitcnt vmcnt(18)
    s_barrier
    s_add_u32 s47, s47, 1
    s_cmp_eq_u32 s47, 4
    s_mov_b32 s48, 16384
    s_mov_b32 s49, 16640
    s_cselect_b32 s48, 0xffff4000, s48
    s_cselect_b32 s49, 0xffff3d00, s49
    s_cselect_b32 s47, 0, s47
    v_add_u32 v16, s48, v16
    v_add_u32 v17, s48, v17
    v_add_u32 v18, s48, v18
    v_add_u32 v19, s48, v19
    v_add_u32 v20, s48, v20
    v_add_u32 v26, s49, v26
    v_add_u32 v27, s49, v27
    ds_read_b128 v[36:39], v26 offset:0
    ds_read_b64_tr_b16 v[144:145], v16 offset:0
    ds_read_b64_tr_b16 v[146:147], v16 offset:1024
    v_mfma_f32_32x32x16_bf16 v[112:127], v[196:199], v[44:47], v[112:127]
    s_add_u32 m0, s62, 0
    s_nop 0
    buffer_load_dwordx4 v4, s[8:11], s44 offen lds
    ds_read_b64_tr_b16 v[148:149], v17 offset:0
    ds_read_b64_tr_b16 v[150:151], v17 offset:1024
    s_waitcnt lgkmcnt(15)
    v_mfma_f32_32x32x16_bf16 v[128:143], v[200:203], v[32:35], v[128:143]
    s_add_u32 m0, s62, 1040
    s_nop 0
    buffer_load_dwordx4 v5, s[8:11], s44 offen lds
    ds_read_b64_tr_b16 v[152:153], v18 offset:0
    ds_read_b64_tr_b16 v[154:155], v18 offset:1024
    s_waitcnt lgkmcnt(15)
    v_mfma_f32_32x32x16_bf16 v[64:79], v[204:207], v[48:51], v[64:79]
    s_add_u32 m0, s62, 2080
    s_nop 0
    buffer_load_dwordx4 v6, s[8:11], s44 offen lds
    ds_read_b64_tr_b16 v[156:157], v19 offset:0
    ds_read_b64_tr_b16 v[158:159], v19 offset:1024
    s_waitcnt lgkmcnt(15)
    v_mfma_f32_32x32x16_bf16 v[80:95], v[208:211], v[48:51], v[80:95]
    s_waitcnt lgkmcnt(11)
    v_cndmask_b32 v216, v216, v32, s[60:61]
    v_cndmask_b32 v217, v217, v32, s[60:61]
    v_cndmask_b32 v218, v218, v32, s[60:61]
    v_cndmask_b32 v219, v219, v32, s[60:61]
    s_add_u32 m0, s62, 3120
    s_nop 0
    buffer_load_dwordx4 v7, s[8:11], s44 offen lds
    ds_read_b64_tr_b16 v[160:161], v20 offset:0
    ds_read_b64_tr_b16 v[162:163], v20 offset:1024
    v_mfma_f32_32x32x16_bf16 v[96:111], v[212:215], v[48:51], v[96:111]
    v_mfma_f32_32x32x16_bf16 v[224:239], v[48:51], v[48:51], v[224:239]
    s_add_u32 s44, s44, 128
    s_add_u32 m0, s63, 0
    ds_read_b128 v[40:43], v26 offset:32
    ds_read_b64_tr_b16 v[164:165], v16 offset:4096
    ds_read_b64_tr_b16 v[166:167], v16 offset:5120
    v_mfma_f32_32x32x16_bf16 v[112:127], v[216:219], v[48:51], v[112:127]
    buffer_load_dwordx4 v8, s[12:15], s35 offen lds
    s_add_u32 m0, s63, 1024
    ds_read_b64_tr_b16 v[168:169], v17 offset:4096
    ds_read_b64_tr_b16 v[170:171], v17 offset:5120
    s_waitcnt lgkmcnt(15)
    v_mfma_f32_32x32x16_bf16 v[128:143], v[220:223], v[32:35], v[128:143]
    s_cmp_lg_u32 s3, 3
    s_cbranch_scc1 L_k1_noinit
    s_cmp_ge_u32 s2, 16
    s_cbranch_scc1 L_k1_noinit
    s_mul_i32 s45, s2, 3648
    v_lshlrev_b32 v255, 4, v1
    v_cmp_gt_u32 vcc, 36, v1
    v_mov_b32 v60, 2146435072
    s_nop 0
    v_cndmask_b32 v60, v60, v255, vcc
    v_mov_b32 v240, 0
    v_mov_b32 v241, 0
    v_mov_b32 v242, 0
    v_mov_b32 v243, 0
    buffer_store_dwordx4 v[240:243], v255, s[20:23], s45 offen offset:0 sc0 sc1
    buffer_store_dwordx4 v[240:243], v255, s[20:23], s45 offen offset:1024 sc0 sc1
    buffer_store_dwordx4 v[240:243], v255, s[20:23], s45 offen offset:2048 sc0 sc1
    buffer_store_dwordx4 v[240:243], v60, s[20:23], s45 offen offset:3072 sc0 sc1
    s_waitcnt vmcnt(0)
    s_lshl_b32 s45, s2, 2
    buffer_atomic_add v253, v254, s[40:43], s45 offen offset:64
L_k1_noinit:
    s_mov_b32 s55, 3
L_k1_loop:
    buffer_load_dwordx4 v9, s[12:15], s35 offen lds
    s_add_u32 s35, s35, 110592
    ds_read_b64_tr_b16 v[172:173], v18 offset:4096
    ds_read_b64_tr_b16 v[174:175], v18 offset:5120
    s_waitcnt lgkmcnt(15)
    v_mfma_f32_32x32x16_bf16 v[64:79], v[144:147], v[36:39], v[64:79]
    ds_read_b64_tr_b16 v[176:177], v19 offset:4096
    ds_read_b64_tr_b16 v[178:179], v19 offset:5120
    s_waitcnt lgkmcnt(15)
    v_mfma_f32_32x32x16_bf16 v[80:95], v[148:151], v[36:39], v[80:95]
    s_waitcnt lgkmcnt(11)
    v_cndmask_b32 v156, v156, v32, s[60:61]
    v_cndmask_b32 v157, v157, v32, s[60:61]
    v_cndmask_b32 v158, v158, v32, s[60:61]
    v_cndmask_b32 v159, v159, v32, s[60:61]
    ds_read_b64_tr_b16 v[180:181], v20 offset:4096
    ds_read_b64_tr_b16 v[182:183], v20 offset:5120
    v_mfma_f32_32x32x16_bf16 v[96:111], v[152:155], v[36:39], v[96:111]
    v_mfma_f32_32x32x16_bf16 v[224:239], v[36:39], v[36:39], v[224:239]
    s_waitcnt vmcnt(22)
    s_barrier
    ds_read_b128 v[44:47], v27 offset:0
    ds_read_b64_tr_b16 v[184:185], v16 offset:8192
    ds_read_b64_tr_b16 v[186:187], v16 offset:9216
    v_mfma_f32_32x32x16_bf16 v[112:127], v[156:159], v[36:39], v[112:127]
    s_add_u32 m0, s63, 8192
    s_nop 0
    buffer_load_dwordx4 v8, s[12:15], s35 offen lds
    ds_read_b64_tr_b16 v[188:189], v17 offset:8192
    ds_read_b64_tr_b16 v[190:191], v17 offset:9216
    s_waitcnt lgkmcnt(15)
    v_mfma_f32_32x32x16_bf16 v[128:143], v[160:163], v[32:35], v[128:143]
    s_add_u32 m0, s63, 9216
    s_nop 0
    buffer_load_dwordx4 v9, s[12:15], s35 offen lds
    ds_read_b64_tr_b16 v[192:193], v18 offset:8192
    ds_read_b64_tr_b16 v[194:195], v18 offset:9216
    s_waitcnt lgkmcnt(15)
    v_mfma_f32_32x32x16_bf16 v[64:79], v[164:167], v[40:43], v[64:79]
    s_add_u32 s35, s35, 110592
    s_add_u32 s62, s62, 16640
    s_add_u32 s63, s63, 16384
    s_add_u32 s46, s46, 1
    s_cmp_eq_u32 s46, 4
    s_cselect_b32 s62, s36, s62
    s_cselect_b32 s63, s38, s63
    s_cselect_b32 s46, 0, s46
    ds_read_b64_tr_b16 v[196:197], v19 offset:8192
    ds_read_b64_tr_b16 v[198:199], v19 offset:9216
    s_waitcnt lgkmcnt(15)
    v_mfma_f32_32x32x16_bf16 v[80:95], v[168:171], v[40:43], v[80:95]
    s_waitcnt lgkmcnt(11)
    v_cndmask_b32 v176, v176, v32, s[60:61]
    v_cndmask_b32 v177, v177, v32, s[60:61]
    v_cndmask_b32 v178, v178, v32, s[60:61]
    v_cndmask_b32 v179, v179, v32, s[60:61]
    ds_read_b64_tr_b16 v[200:201], v20 offset:8192
    ds_read_b64_tr_b16 v[202:203], v20 offset:9216
    v_mfma_f32_32x32x16_bf16 v[96:111], v[172:175], v[40:43], v[96:111]
    v_mfma_f32_32x32x16_bf16 v[224:239], v[40:43], v[40:43], v[224:239]
    ds_read_b128 v[48:51], v27 offset:32
    ds_read_b64_tr_b16 v[204:205], v16 offset:12288
    ds_read_b64_tr_b16 v[206:207], v16 offset:13312
    v_mfma_f32_32x32x16_bf16 v[112:127], v[176:179], v[40:43], v[112:127]
    ds_read_b64_tr_b16 v[208:209], v17 offset:12288
    ds_read_b64_tr_b16 v[210:211], v17 offset:13312
    s_waitcnt lgkmcnt(15)
    v_mfma_f32_32x32x16_bf16 v[128:143], v[180:183], v[32:35], v[128:143]
    ds_read_b64_tr_b16 v[212:213], v18 offset:12288
    ds_read_b64_tr_b16 v[214:215], v18 offset:13312
    s_waitcnt lgkmcnt(15)
    v_mfma_f32_32x32x16_bf16 v[64:79], v[184:187], v[44:47], v[64:79]
    ds_read_b64_tr_b16 v[216:217], v19 offset:12288
    ds_read_b64_tr_b16 v[218:219], v19 offset:13312
    s_waitcnt lgkmcnt(15)
    v_mfma_f32_32x32x16_bf16 v[80:95], v[188:191], v[44:47], v[80:95]
    s_waitcnt lgkmcnt(11)
    v_cndmask_b32 v196, v196, v32, s[60:61]
    v_cndmask_b32 v197, v197, v32, s[60:61]
    v_cndmask_b32 v198, v198, v32, s[60:61]
    v_cndmask_b32 v199, v199, v32, s[60:61]
    ds_read_b64_tr_b16 v[220:221], v20 offset:12288
    ds_read_b64_tr_b16 v[222:223], v20 offset:13312
    v_mfma_f32_32x32x16_bf16 v[96:111], v[192:195], v[44:47], v[96:111]
    v_mfma_f32_32x32x16_bf16 v[224:239], v[44:47], v[44:47], v[224:239]
    s_waitcnt vmcnt(18)
    s_barrier
    s_add_u32 s47, s47, 1
    s_cmp_eq_u32 s47, 4
    s_mov_b32 s48, 16384
    s_mov_b32 s49, 16640
    s_cselect_b32 s48, 0xffff4000, s48
    s_cselect_b32 s49, 0xffff3d00, s49
    s_cselect_b32 s47, 0, s47
    v_add_u32 v16, s48, v16
    v_add_u32 v17, s48, v17
    v_add_u32 v18, s48, v18
    v_add_u32 v19, s48, v19
    v_add_u32 v20, s48, v20
    v_add_u32 v26, s49, v26
    v_add_u32 v27, s49, v27
    ds_read_b128 v[36:39], v26 offset:0
    ds_read_b64_tr_b16 v[144:145], v16 offset:0
    ds_read_b64_tr_b16 v[146:147], v16 offset:1024
    v_mfma_f32_32x32x16_bf16 v[112:127], v[196:199], v[44:47], v[112:127]
    s_add_u32 m0, s62, 0
    s_nop 0
    buffer_load_dwordx4 v4, s[8:11], s44 offen lds
    ds_read_b64_tr_b16 v[148:149], v17 offset:0
    ds_read_b64_tr_b16 v[150:151], v17 offset:1024
    s_waitcnt lgkmcnt(15)
    v_mfma_f32_32x32x16_bf16 v[128:143], v[200:203], v[32:35], v[128:143]
    s_add_u32 m0, s62, 1040
    s_nop 0
    buffer_load_dwordx4 v5, s[8:11], s44 offen lds
    ds_read_b64_tr_b16 v[152:153], v18 offset:0
    ds_read_b64_tr_b16 v[154:155], v18 offset:1024
    s_waitcnt lgkmcnt(15)
    v_mfma_f32_32x32x16_bf16 v[64:79], v[204:207], v[48:51], v[64:79]
    s_add_u32 m0, s62, 2080
    s_nop 0
    buffer_load_dwordx4 v6, s[8:11], s44 offen lds
    ds_read_b64_tr_b16 v[156:157], v19 offset:0
    ds_read_b64_tr_b16 v[158:159], v19 offset:1024
    s_waitcnt lgkmcnt(15)
    v_mfma_f32_32x32x16_bf16 v[80:95], v[208:211], v[48:51], v[80:95]
    s_waitcnt lgkmcnt(11)
    v_cndmask_b32 v216, v216, v32, s[60:61]
    v_cndmask_b32 v217, v217, v32, s[60:61]
    v_cndmask_b32 v218, v218, v32, s[60:61]
    v_cndmask_b32 v219, v219, v32, s[60:61]
    s_add_u32 m0, s62, 3120
    s_nop 0
    buffer_load_dwordx4 v7, s[8:11], s44 offen lds
    ds_read_b64_tr_b16 v[160:161], v20 offset:0
    ds_read_b64_tr_b16 v[162:163], v20 offset:1024
    v_mfma_f32_32x32x16_bf16 v[96:111], v[212:215], v[48:51], v[96:111]
    v_mfma_f32_32x32x16_bf16 v[224:239], v[48:51], v[48:51], v[224:239]
    s_add_u32 s44, s44, 128
    s_add_u32 m0, s63, 0
    ds_read_b128 v[40:43], v26 offset:32
    ds_read_b64_tr_b16 v[164:165], v16 offset:4096
    ds_read_b64_tr_b16 v[166:167], v16 offset:5120
    v_mfma_f32_32x32x16_bf16 v[112:127], v[216:219], v[48:51], v[112:127]
    buffer_load_dwordx4 v8, s[12:15], s35 offen lds
    s_add_u32 m0, s63, 1024
    ds_read_b64_tr_b16 v[168:169], v17 offset:4096
    ds_read_b64_tr_b16 v[170:171], v17 offset:5120
    s_waitcnt lgkmcnt(15)
    v_mfma_f32_32x32x16_bf16 v[128:143], v[220:223], v[32:35], v[128:143]
    s_sub_u32 s55, s55, 1
    s_cbranch_scc0 L_k1_loop
    buffer_load_dwordx4 v9, s[12:15], s35 offen lds
    s_add_u32 s35, s35, 110592
    ds_read_b64_tr_b16 v[172:173], v18 offset:4096
    ds_read_b64_tr_b16 v[174:175], v18 offset:5120
    s_waitcnt lgkmcnt(15)
    v_mfma_f32_32x32x16_bf16 v[64:79], v[144:147], v[36:39], v[64:79]
    ds_read_b64_tr_b16 v[176:177], v19 offset:4096
    ds_read_b64_tr_b16 v[178:179], v19 offset:5120
    s_waitcnt lgkmcnt(15)
    v_mfma_f32_32x32x16_bf16 v[80:95], v[148:151], v[36:39], v[80:95]
    s_waitcnt lgkmcnt(11)
    v_cndmask_b32 v156, v156, v32, s[60:61]
    v_cndmask_b32 v157, v157, v32, s[60:61]
    v_cndmask_b32 v158, v158, v32, s[60:61]
    v_cndmask_b32 v159, v159, v32, s[60:61]
    ds_read_b64_tr_b16 v[180:181], v20 offset:4096
    ds_read_b64_tr_b16 v[182:183], v20 offset:5120
    v_mfma_f32_32x32x16_bf16 v[96:111], v[152:155], v[36:39], v[96:111]
    v_mfma_f32_32x32x16_bf16 v[224:239], v[36:39], v[36:39], v[224:239]
    s_waitcnt vmcnt(22)
    s_barrier
    ds_read_b128 v[44:47], v27 offset:0
    ds_read_b64_tr_b16 v[184:185], v16 offset:8192
    ds_read_b64_tr_b16 v[186:187], v16 offset:9216
    v_mfma_f32_32x32x16_bf16 v[112:127], v[156:159], v[36:39], v[112:127]
    ds_read_b64_tr_b16 v[188:189], v17 offset:8192
    ds_read_b64_tr_b16 v[190:191], v17 offset:9216
    s_waitcnt lgkmcnt(15)
    v_mfma_f32_32x32x16_bf16 v[128:143], v[160:163], v[32:35], v[128:143]
    ds_read_b64_tr_b16 v[192:193], v18 offset:8192
    ds_read_b64_tr_b16 v[194:195], v18 offset:9216
    s_waitcnt lgkmcnt(15)
    v_mfma_f32_32x32x16_bf16 v[64:79], v[164:167], v[40:43], v[64:79]
    ds_read_b64_tr_b16 v[196:197], v19 offset:8192
    ds_read_b64_tr_b16 v[198:199], v19 offset:9216
    s_waitcnt lgkmcnt(15)
    v_mfma_f32_32x32x16_bf16 v[80:95], v[168:171], v[40:43], v[80:95]
    s_waitcnt lgkmcnt(11)
    v_cndmask_b32 v176, v176, v32, s[60:61]
    v_cndmask_b32 v177, v177, v32, s[60:61]
    v_cndmask_b32 v178, v178, v32, s[60:61]
    v_cndmask_b32 v179, v179, v32, s[60:61]
    ds_read_b64_tr_b16 v[200:201], v20 offset:8192
    ds_read_b64_tr_b16 v[202:203], v20 offset:9216
    v_mfma_f32_32x32x16_bf16 v[96:111], v[172:175], v[40:43], v[96:111]
    v_mfma_f32_32x32x16_bf16 v[224:239], v[40:43], v[40:43], v[224:239]
    ds_read_b128 v[48:51], v27 offset:32
    ds_read_b64_tr_b16 v[204:205], v16 offset:12288
    ds_read_b64_tr_b16 v[206:207], v16 offset:13312
    v_mfma_f32_32x32x16_bf16 v[112:127], v[176:179], v[40:43], v[112:127]
    ds_read_b64_tr_b16 v[208:209], v17 offset:12288
    ds_read_b64_tr_b16 v[210:211], v17 offset:13312
    s_waitcnt lgkmcnt(15)
    v_mfma_f32_32x32x16_bf16 v[128:143], v[180:183], v[32:35], v[128:143]
    ds_read_b64_tr_b16 v[212:213], v18 offset:12288
    ds_read_b64_tr_b16 v[214:215], v18 offset:13312
    s_waitcnt lgkmcnt(15)
    v_mfma_f32_32x32x16_bf16 v[64:79], v[184:187], v[44:47], v[64:79]
    buffer_load_dword v59, v58, s[40:43], s37 offen offset:64 sc0 sc1
    ds_read_b64_tr_b16 v[216:217], v19 offset:12288
    ds_read_b64_tr_b16 v[218:219], v19 offset:13312
    s_waitcnt lgkmcnt(15)
    v_mfma_f32_32x32x16_bf16 v[80:95], v[188:191], v[44:47], v[80:95]
    s_waitcnt lgkmcnt(11)
    v_cndmask_b32 v196, v196, v32, s[60:61]
    v_cndmask_b32 v197, v197, v32, s[60:61]
    v_cndmask_b32 v198, v198, v32, s[60:61]
    v_cndmask_b32 v199, v199, v32, s[60:61]
    global_load_dword v244, v248, s[56:57]
    ds_read_b64_tr_b16 v[220:221], v20 offset:12288
    ds_read_b64_tr_b16 v[222:223], v20 offset:13312
    v_mfma_f32_32x32x16_bf16 v[96:111], v[192:195], v[44:47], v[96:111]
    v_mfma_f32_32x32x16_bf16 v[224:239], v[44:47], v[44:47], v[224:239]
    s_waitcnt vmcnt(18)
    s_barrier
    s_add_u32 s47, s47, 1
    s_cmp_eq_u32 s47, 4
    s_mov_b32 s48, 16384
    s_mov_b32 s49, 16640
    s_cselect_b32 s48, 0xffff4000, s48
    s_cselect_b32 s49, 0xffff3d00, s49
    s_cselect_b32 s47, 0, s47
    v_add_u32 v16, s48, v16
    v_add_u32 v17, s48, v17
    v_add_u32 v18, s48, v18
    v_add_u32 v19, s48, v19
    v_add_u32 v20, s48, v20
    v_add_u32 v26, s49, v26
    v_add_u32 v27, s49, v27
    ds_read_b128 v[36:39], v26 offset:0
    ds_read_b64_tr_b16 v[144:145], v16 offset:0
    ds_read_b64_tr_b16 v[146:147], v16 offset:1024
    v_mfma_f32_32x32x16_bf16 v[112:127], v[196:199], v[44:47], v[112:127]
    global_load_dword v245, v249, s[88:89]
    ds_read_b64_tr_b16 v[148:149], v17 offset:0
    ds_read_b64_tr_b16 v[150:151], v17 offset:1024
    s_waitcnt lgkmcnt(15)
    v_mfma_f32_32x32x16_bf16 v[128:143], v[200:203], v[32:35], v[128:143]
    ds_read_b64_tr_b16 v[152:153], v18 offset:0
    ds_read_b64_tr_b16 v[154:155], v18 offset:1024
    s_waitcnt lgkmcnt(15)
    v_mfma_f32_32x32x16_bf16 v[64:79], v[204:207], v[48:51], v[64:79]
    global_load_dword v246, v249, s[90:91]
    ds_read_b64_tr_b16 v[156:157], v19 offset:0
    ds_read_b64_tr_b16 v[158:159], v19 offset:1024
    s_waitcnt lgkmcnt(15)
    v_mfma_f32_32x32x16_bf16 v[80:95], v[208:211], v[48:51], v[80:95]
    s_waitcnt lgkmcnt(11)
    v_cndmask_b32 v216, v216, v32, s[60:61]
    v_cndmask_b32 v217, v217, v32, s[60:61]
    v_cndmask_b32 v218, v218, v32, s[60:61]
    v_cndmask_b32 v219, v219, v32, s[60:61]
    ds_read_b64_tr_b16 v[160:161], v20 offset:0
    ds_read_b64_tr_b16 v[162:163], v20 offset:1024
    v_mfma_f32_32x32x16_bf16 v[96:111], v[212:215], v[48:51], v[96:111]
    v_mfma_f32_32x32x16_bf16 v[224:239], v[48:51], v[48:51], v[224:239]
    ds_read_b128 v[40:43], v26 offset:32
    ds_read_b64_tr_b16 v[164:165], v16 offset:4096
    ds_read_b64_tr_b16 v[166:167], v16 offset:5120
    v_mfma_f32_32x32x16_bf16 v[112:127], v[216:219], v[48:51], v[112:127]
    ds_read_b64_tr_b16 v[168:169], v17 offset:4096
    ds_read_b64_tr_b16 v[170:171], v17 offset:5120
    s_waitcnt lgkmcnt(15)
    v_mfma_f32_32x32x16_bf16 v[128:143], v[220:223], v[32:35], v[128:143]
    ds_read_b64_tr_b16 v[172:173], v18 offset:4096
    ds_read_b64_tr_b16 v[174:175], v18 offset:5120
    s_waitcnt lgkmcnt(15)
    v_mfma_f32_32x32x16_bf16 v[64:79], v[144:147], v[36:39], v[64:79]
    ds_read_b64_tr_b16 v[176:177], v19 offset:4096
    ds_read_b64_tr_b16 v[178:179], v19 offset:5120
    s_waitcnt lgkmcnt(15)
    v_mfma_f32_32x32x16_bf16 v[80:95], v[148:151], v[36:39], v[80:95]
    s_waitcnt lgkmcnt(11)
    v_cndmask_b32 v156, v156, v32, s[60:61]
    v_cndmask_b32 v157, v157, v32, s[60:61]
    v_cndmask_b32 v158, v158, v32, s[60:61]
    v_cndmask_b32 v159, v159, v32, s[60:61]
    ds_read_b64_tr_b16 v[180:181], v20 offset:4096
    ds_read_b64_tr_b16 v[182:183], v20 offset:5120
    v_mfma_f32_32x32x16_bf16 v[96:111], v[152:155], v[36:39], v[96:111]
    v_mfma_f32_32x32x16_bf16 v[224:239], v[36:39], v[36:39], v[224:239]
    s_waitcnt vmcnt(18)
    s_barrier
    ds_read_b128 v[44:47], v27 offset:0
    ds_read_b64_tr_b16 v[184:185], v16 offset:8192
    ds_read_b64_tr_b16 v[186:187], v16 offset:9216
    v_mfma_f32_32x32x16_bf16 v[112:127], v[156:159], v[36:39], v[112:127]
    ds_read_b64_tr_b16 v[188:189], v17 offset:8192
    ds_read_b64_tr_b16 v[190:191], v17 offset:9216
    s_waitcnt lgkmcnt(15)
    v_mfma_f32_32x32x16_bf16 v[128:143], v[160:163], v[32:35], v[128:143]
    ds_read_b64_tr_b16 v[192:193], v18 offset:8192
    ds_read_b64_tr_b16 v[194:195], v18 offset:9216
    s_waitcnt lgkmcnt(15)
    v_mfma_f32_32x32x16_bf16 v[64:79], v[164:167], v[40:43], v[64:79]
    ds_read_b64_tr_b16 v[196:197], v19 offset:8192
    ds_read_b64_tr_b16 v[198:199], v19 offset:9216
    s_waitcnt lgkmcnt(15)
    v_mfma_f32_32x32x16_bf16 v[80:95], v[168:171], v[40:43], v[80:95]
    s_waitcnt lgkmcnt(11)
    v_cndmask_b32 v176, v176, v32, s[60:61]
    v_cndmask_b32 v177, v177, v32, s[60:61]
    v_cndmask_b32 v178, v178, v32, s[60:61]
    v_cndmask_b32 v179, v179, v32, s[60:61]
    ds_read_b64_tr_b16 v[200:201], v20 offset:8192
    ds_read_b64_tr_b16 v[202:203], v20 offset:9216
    v_mfma_f32_32x32x16_bf16 v[96:111], v[172:175], v[40:43], v[96:111]
    v_mfma_f32_32x32x16_bf16 v[224:239], v[40:43], v[40:43], v[224:239]
    ds_read_b128 v[48:51], v27 offset:32
    ds_read_b64_tr_b16 v[204:205], v16 offset:12288
    ds_read_b64_tr_b16 v[206:207], v16 offset:13312
    v_mfma_f32_32x32x16_bf16 v[112:127], v[176:179], v[40:43], v[112:127]
    ds_read_b64_tr_b16 v[208:209], v17 offset:12288
    ds_read_b64_tr_b16 v[210:211], v17 offset:13312
    s_waitcnt lgkmcnt(15)
    v_mfma_f32_32x32x16_bf16 v[128:143], v[180:183], v[32:35], v[128:143]
    ds_read_b64_tr_b16 v[212:213], v18 offset:12288
    ds_read_b64_tr_b16 v[214:215], v18 offset:13312
    s_waitcnt lgkmcnt(15)
    v_mfma_f32_32x32x16_bf16 v[64:79], v[184:187], v[44:47], v[64:79]
    ds_read_b64_tr_b16 v[216:217], v19 offset:12288
    ds_read_b64_tr_b16 v[218:219], v19 offset:13312
    s_waitcnt lgkmcnt(15)
    v_mfma_f32_32x32x16_bf16 v[80:95], v[188:191], v[44:47], v[80:95]
    s_waitcnt lgkmcnt(11)
    v_cndmask_b32 v196, v196, v32, s[60:61]
    v_cndmask_b32 v197, v197, v32, s[60:61]
    v_cndmask_b32 v198, v198, v32, s[60:61]
    v_cndmask_b32 v199, v199, v32, s[60:61]
    ds_read_b64_tr_b16 v[220:221], v20 offset:12288
    ds_read_b64_tr_b16 v[222:223], v20 offset:13312
    v_mfma_f32_32x32x16_bf16 v[96:111], v[192:195], v[44:47], v[96:111]
    v_mfma_f32_32x32x16_bf16 v[224:239], v[44:47], v[44:47], v[224:239]
    s_waitcnt vmcnt(12)
    s_barrier
    s_add_u32 s47, s47, 1
    s_cmp_eq_u32 s47, 4
    s_mov_b32 s48, 16384
    s_mov_b32 s49, 16640
    s_cselect_b32 s48, 0xffff4000, s48
    s_cselect_b32 s49, 0xffff3d00, s49
    s_cselect_b32 s47, 0, s47
    v_add_u32 v16, s48, v16
    v_add_u32 v17, s48, v17
    v_add_u32 v18, s48, v18
    v_add_u32 v19, s48, v19
    v_add_u32 v20, s48, v20
    v_add_u32 v26, s49, v26
    v_add_u32 v27, s49, v27
    ds_read_b128 v[36:39], v26 offset:0
    ds_read_b64_tr_b16 v[144:145], v16 offset:0
    ds_read_b64_tr_b16 v[146:147], v16 offset:1024
    v_mfma_f32_32x32x16_bf16 v[112:127], v[196:199], v[44:47], v[112:127]
    ds_read_b64_tr_b16 v[148:149], v17 offset:0
    ds_read_b64_tr_b16 v[150:151], v17 offset:1024
    s_waitcnt lgkmcnt(15)
    v_mfma_f32_32x32x16_bf16 v[128:143], v[200:203], v[32:35], v[128:143]
    ds_read_b64_tr_b16 v[152:153], v18 offset:0
    ds_read_b64_tr_b16 v[154:155], v18 offset:1024
    s_waitcnt lgkmcnt(15)
    v_mfma_f32_32x32x16_bf16 v[64:79], v[204:207], v[48:51], v[64:79]
    ds_read_b64_tr_b16 v[156:157], v19 offset:0
    ds_read_b64_tr_b16 v[158:159], v19 offset:1024
    s_waitcnt lgkmcnt(15)
    v_mfma_f32_32x32x16_bf16 v[80:95], v[208:211], v[48:51], v[80:95]
    s_waitcnt lgkmcnt(11)
    v_cndmask_b32 v216, v216, v32, s[60:61]
    v_cndmask_b32 v217, v217, v32, s[60:61]
    v_cndmask_b32 v218, v218, v32, s[60:61]
    v_cndmask_b32 v219, v219, v32, s[60:61]
    ds_read_b64_tr_b16 v[160:161], v20 offset:0
    ds_read_b64_tr_b16 v[162:163], v20 offset:1024
    v_mfma_f32_32x32x16_bf16 v[96:111], v[212:215], v[48:51], v[96:111]
    v_mfma_f32_32x32x16_bf16 v[224:239], v[48:51], v[48:51], v[224:239]
    ds_read_b128 v[40:43], v26 offset:32
    ds_read_b64_tr_b16 v[164:165], v16 offset:4096
    ds_read_b64_tr_b16 v[166:167], v16 offset:5120
    v_mfma_f32_32x32x16_bf16 v[112:127], v[216:219], v[48:51], v[112:127]
    ds_read_b64_tr_b16 v[168:169], v17 offset:4096
    ds_read_b64_tr_b16 v[170:171], v17 offset:5120
    s_waitcnt lgkmcnt(15)
    v_mfma_f32_32x32x16_bf16 v[128:143], v[220:223], v[32:35], v[128:143]
    ds_read_b64_tr_b16 v[172:173], v18 offset:4096
    ds_read_b64_tr_b16 v[174:175], v18 offset:5120
    s_waitcnt lgkmcnt(15)
    v_mfma_f32_32x32x16_bf16 v[64:79], v[144:147], v[36:39], v[64:79]
    ds_read_b64_tr_b16 v[176:177], v19 offset:4096
    ds_read_b64_tr_b16 v[178:179], v19 offset:5120
    s_waitcnt lgkmcnt(15)
    v_mfma_f32_32x32x16_bf16 v[80:95], v[148:151], v[36:39], v[80:95]
    s_waitcnt lgkmcnt(11)
    v_cndmask_b32 v156, v156, v32, s[60:61]
    v_cndmask_b32 v157, v157, v32, s[60:61]
    v_cndmask_b32 v158, v158, v32, s[60:61]
    v_cndmask_b32 v159, v159, v32, s[60:61]
    ds_read_b64_tr_b16 v[180:181], v20 offset:4096
    ds_read_b64_tr_b16 v[182:183], v20 offset:5120
    v_mfma_f32_32x32x16_bf16 v[96:111], v[152:155], v[36:39], v[96:111]
    v_mfma_f32_32x32x16_bf16 v[224:239], v[36:39], v[36:39], v[224:239]
    s_waitcnt vmcnt(10)
    s_barrier
    ds_read_b128 v[44:47], v27 offset:0
    ds_read_b64_tr_b16 v[184:185], v16 offset:8192
    ds_read_b64_tr_b16 v[186:187], v16 offset:9216
    v_mfma_f32_32x32x16_bf16 v[112:127], v[156:159], v[36:39], v[112:127]
    ds_read_b64_tr_b16 v[188:189], v17 offset:8192
    ds_read_b64_tr_b16 v[190:191], v17 offset:9216
    s_waitcnt lgkmcnt(15)
    v_mfma_f32_32x32x16_bf16 v[128:143], v[160:163], v[32:35], v[128:143]
    ds_read_b64_tr_b16 v[192:193], v18 offset:8192
    ds_read_b64_tr_b16 v[194:195], v18 offset:9216
    s_waitcnt lgkmcnt(15)
    v_mfma_f32_32x32x16_bf16 v[64:79], v[164:167], v[40:43], v[64:79]
    ds_read_b64_tr_b16 v[196:197], v19 offset:8192
    ds_read_b64_tr_b16 v[198:199], v19 offset:9216
    s_waitcnt lgkmcnt(15)
    v_mfma_f32_32x32x16_bf16 v[80:95], v[168:171], v[40:43], v[80:95]
    s_waitcnt lgkmcnt(11)
    v_cndmask_b32 v176, v176, v32, s[60:61]
    v_cndmask_b32 v177, v177, v32, s[60:61]
    v_cndmask_b32 v178, v178, v32, s[60:61]
    v_cndmask_b32 v179, v179, v32, s[60:61]
    ds_read_b64_tr_b16 v[200:201], v20 offset:8192
    ds_read_b64_tr_b16 v[202:203], v20 offset:9216
    v_mfma_f32_32x32x16_bf16 v[96:111], v[172:175], v[40:43], v[96:111]
    v_mfma_f32_32x32x16_bf16 v[224:239], v[40:43], v[40:43], v[224:239]
    ds_read_b128 v[48:51], v27 offset:32
    ds_read_b64_tr_b16 v[204:205], v16 offset:12288
    ds_read_b64_tr_b16 v[206:207], v16 offset:13312
    v_mfma_f32_32x32x16_bf16 v[112:127], v[176:179], v[40:43], v[112:127]
    ds_read_b64_tr_b16 v[208:209], v17 offset:12288
    ds_read_b64_tr_b16 v[210:211], v17 offset:13312
    s_waitcnt lgkmcnt(15)
    v_mfma_f32_32x32x16_bf16 v[128:143], v[180:183], v[32:35], v[128:143]
    ds_read_b64_tr_b16 v[212:213], v18 offset:12288
    ds_read_b64_tr_b16 v[214:215], v18 offset:13312
    s_waitcnt lgkmcnt(15)
    v_mfma_f32_32x32x16_bf16 v[64:79], v[184:187], v[44:47], v[64:79]
    ds_read_b64_tr_b16 v[216:217], v19 offset:12288
    ds_read_b64_tr_b16 v[218:219], v19 offset:13312
    s_waitcnt lgkmcnt(15)
    v_mfma_f32_32x32x16_bf16 v[80:95], v[188:191], v[44:47], v[80:95]
    s_waitcnt lgkmcnt(11)
    v_cndmask_b32 v196, v196, v32, s[60:61]
    v_cndmask_b32 v197, v197, v32, s[60:61]
    v_cndmask_b32 v198, v198, v32, s[60:61]
    v_cndmask_b32 v199, v199, v32, s[60:61]
    ds_read_b64_tr_b16 v[220:221], v20 offset:12288
    ds_read_b64_tr_b16 v[222:223], v20 offset:13312
    v_mfma_f32_32x32x16_bf16 v[96:111], v[192:195], v[44:47], v[96:111]
    v_mfma_f32_32x32x16_bf16 v[224:239], v[44:47], v[44:47], v[224:239]
    v_mfma_f32_32x32x16_bf16 v[112:127], v[196:199], v[44:47], v[112:127]
    s_waitcnt lgkmcnt(11)
    v_mfma_f32_32x32x16_bf16 v[128:143], v[200:203], v[32:35], v[128:143]
    s_waitcnt lgkmcnt(8)
    v_mfma_f32_32x32x16_bf16 v[64:79], v[204:207], v[48:51], v[64:79]
    s_waitcnt lgkmcnt(6)
    v_mfma_f32_32x32x16_bf16 v[80:95], v[208:211], v[48:51], v[80:95]
    s_waitcnt lgkmcnt(2)
    v_cndmask_b32 v216, v216, v32, s[60:61]
    v_cndmask_b32 v217, v217, v32, s[60:61]
    v_cndmask_b32 v218, v218, v32, s[60:61]
    v_cndmask_b32 v219, v219, v32, s[60:61]
    v_mfma_f32_32x32x16_bf16 v[96:111], v[212:215], v[48:51], v[96:111]
    v_mfma_f32_32x32x16_bf16 v[224:239], v[48:51], v[48:51], v[224:239]
    v_mfma_f32_32x32x16_bf16 v[112:127], v[216:219], v[48:51], v[112:127]
    s_waitcnt lgkmcnt(0)
    v_mfma_f32_32x32x16_bf16 v[128:143], v[220:223], v[32:35], v[128:143]
    s_waitcnt vmcnt(4)
    v_and_b32 v36, 1, v2
    v_cmp_eq_u32 s[62:63], 1, v36
    v_and_b32 v36, 2, v2
    v_cmp_eq_u32 s[50:51], 2, v36
    v_and_b32 v36, 8, v2
    v_cmp_eq_u32 s[48:49], 8, v36
    v_and_b32 v36, 16, v2
    v_cmp_eq_u32 s[46:47], 16, v36
    v_cndmask_b32 v224, v224, v225, s[62:63]
    v_cndmask_b32 v226, v226, v227, s[62:63]
    v_cndmask_b32 v228, v228, v229, s[62:63]
    v_cndmask_b32 v230, v230, v231, s[62:63]
    v_cndmask_b32 v232, v232, v233, s[62:63]
    v_cndmask_b32 v234, v234, v235, s[62:63]
    v_cndmask_b32 v236, v236, v237, s[62:63]
    v_cndmask_b32 v238, v238, v239, s[62:63]
    v_cndmask_b32 v224, v224, v226, s[50:51]
    v_cndmask_b32 v228, v228, v230, s[50:51]
    v_cndmask_b32 v232, v232, v234, s[50:51]
    v_cndmask_b32 v236, v236, v238, s[50:51]
    v_cndmask_b32 v224, v224, v228, s[48:49]
    v_cndmask_b32 v232, v232, v236, s[48:49]
    v_cndmask_b32 v40, v224, v232, s[46:47]
    v_bfe_u32 v36, v2, 2, 1
    v_cmp_eq_u32 vcc, v36, v3
    s_nop 1
    v_cndmask_b32 v40, 0, v40, vcc
    v_mov_b32 v41, v40
    s_nop 1
    v_permlane32_swap_b32 v40, v41
    v_add_f32 v40, v40, v41
    v_mov_b32 v36, v124
    v_mul_f32 v36, 0x3ae38e39, v36
    v_mul_f32 v40, 0x3ae38e39, v40
    v_fma_f32 v40, -v36, v36, v40
    v_max_f32 v40, 0, v40
    v_add_f32 v40, 0x3727c5ac, v40
    v_rsq_f32 v44, v40
    s_nop 0
    v_mul_f32 v45, v36, v44
    v_sub_f32 v45, 0, v45
    s_barrier
    s_lshl_b32 s45, s3, 7
    v_lshl_add_u32 v46, v3, 4, s45
    v_cmp_eq_u32 vcc, 0, v2
    s_nop 0
    s_and_saveexec_b64 s[58:59], vcc
    ds_write_b128 v46, v[128:131] offset:40960
    ds_write_b128 v46, v[132:135] offset:40992
    ds_write_b128 v46, v[136:139] offset:41024
    ds_write_b128 v46, v[140:143] offset:41056
    s_mov_b64 exec, -1
    v_lshlrev_b32 v46, 4, v3
    s_waitcnt lgkmcnt(0)
    s_barrier
    ds_read_b128 v[144:147], v46 offset:40960
    ds_read_b128 v[148:151], v46 offset:40992
    ds_read_b128 v[152:155], v46 offset:41024
    ds_read_b128 v[156:159], v46 offset:41056
    ds_read_b128 v[160:163], v46 offset:41088
    ds_read_b128 v[164:167], v46 offset:41120
    ds_read_b128 v[168:171], v46 offset:41152
    ds_read_b128 v[172:175], v46 offset:41184
    ds_read_b128 v[176:179], v46 offset:41216
    ds_read_b128 v[180:183], v46 offset:41248
    ds_read_b128 v[184:187], v46 offset:41280
    ds_read_b128 v[188:191], v46 offset:41312
    ds_read_b128 v[192:195], v46 offset:41344
    ds_read_b128 v[196:199], v46 offset:41376
    ds_read_b128 v[200:203], v46 offset:41408
    v_mov_b32 v52, v45
    v_mov_b32 v53, v45
    v_mov_b32 v45, v44
    v_mov_b32 v54, 0x358637bd
    v_mov_b32 v55, 0x358637bd
    v_mov_b32 v56, 0x3fb8aa3b
    v_mov_b32 v57, 0x3fb8aa3b
    s_waitcnt lgkmcnt(14)
    v_pk_fma_f32 v[144:145], v[144:145], v[52:53], v[54:55]
    v_pk_fma_f32 v[146:147], v[146:147], v[52:53], v[54:55]
    v_pk_fma_f32 v[64:65], v[64:65], v[44:45], v[144:145]
    v_pk_fma_f32 v[66:67], v[66:67], v[44:45], v[146:147]
    s_waitcnt lgkmcnt(13)
    v_pk_fma_f32 v[148:149], v[148:149], v[52:53], v[54:55]
    v_pk_fma_f32 v[150:151], v[150:151], v[52:53], v[54:55]
    v_pk_fma_f32 v[68:69], v[68:69], v[44:45], v[148:149]
    v_pk_fma_f32 v[70:71], v[70:71], v[44:45], v[150:151]
    s_waitcnt lgkmcnt(12)
    v_pk_fma_f32 v[152:153], v[152:153], v[52:53], v[54:55]
    v_pk_fma_f32 v[154:155], v[154:155], v[52:53], v[54:55]
    v_pk_fma_f32 v[72:73], v[72:73], v[44:45], v[152:153]
    v_pk_fma_f32 v[74:75], v[74:75], v[44:45], v[154:155]
    s_waitcnt lgkmcnt(11)
    v_pk_fma_f32 v[156:157], v[156:157], v[52:53], v[54:55]
    v_pk_fma_f32 v[158:159], v[158:159], v[52:53], v[54:55]
    v_pk_fma_f32 v[76:77], v[76:77], v[44:45], v[156:157]
    v_pk_fma_f32 v[78:79], v[78:79], v[44:45], v[158:159]
    s_waitcnt lgkmcnt(10)
    v_pk_fma_f32 v[160:161], v[160:161], v[52:53], v[54:55]
    v_pk_fma_f32 v[162:163], v[162:163], v[52:53], v[54:55]
    v_pk_fma_f32 v[80:81], v[80:81], v[44:45], v[160:161]
    v_pk_fma_f32 v[82:83], v[82:83], v[44:45], v[162:163]
    s_waitcnt lgkmcnt(9)
    v_pk_fma_f32 v[164:165], v[164:165], v[52:53], v[54:55]
    v_pk_fma_f32 v[166:167], v[166:167], v[52:53], v[54:55]
    v_pk_fma_f32 v[84:85], v[84:85], v[44:45], v[164:165]
    v_pk_fma_f32 v[86:87], v[86:87], v[44:45], v[166:167]
    s_waitcnt lgkmcnt(8)
    v_pk_fma_f32 v[168:169], v[168:169], v[52:53], v[54:55]
    v_pk_fma_f32 v[170:171], v[170:171], v[52:53], v[54:55]
    v_pk_fma_f32 v[88:89], v[88:89], v[44:45], v[168:169]
    v_pk_fma_f32 v[90:91], v[90:91], v[44:45], v[170:171]
    s_waitcnt lgkmcnt(7)
    v_pk_fma_f32 v[172:173], v[172:173], v[52:53], v[54:55]
    v_pk_fma_f32 v[174:175], v[174:175], v[52:53], v[54:55]
    v_pk_fma_f32 v[92:93], v[92:93], v[44:45], v[172:173]
    v_pk_fma_f32 v[94:95], v[94:95], v[44:45], v[174:175]
    s_waitcnt lgkmcnt(6)
    v_pk_fma_f32 v[176:177], v[176:177], v[52:53], v[54:55]
    v_pk_fma_f32 v[178:179], v[178:179], v[52:53], v[54:55]
    v_pk_fma_f32 v[96:97], v[96:97], v[44:45], v[176:177]
    v_pk_fma_f32 v[98:99], v[98:99], v[44:45], v[178:179]
    s_waitcnt lgkmcnt(5)
    v_pk_fma_f32 v[180:181], v[180:181], v[52:53], v[54:55]
    v_pk_fma_f32 v[182:183], v[182:183], v[52:53], v[54:55]
    v_pk_fma_f32 v[100:101], v[100:101], v[44:45], v[180:181]
    v_pk_fma_f32 v[102:103], v[102:103], v[44:45], v[182:183]
    s_waitcnt lgkmcnt(4)
    v_pk_mul_f32 v[184:185], v[184:185], v[52:53]
    v_pk_mul_f32 v[186:187], v[186:187], v[52:53]
    v_pk_fma_f32 v[104:105], v[104:105], v[44:45], v[184:185]
    v_pk_fma_f32 v[106:107], v[106:107], v[44:45], v[186:187]
    s_waitcnt lgkmcnt(3)
    v_pk_mul_f32 v[188:189], v[188:189], v[52:53]
    v_pk_mul_f32 v[190:191], v[190:191], v[52:53]
    v_pk_fma_f32 v[108:109], v[108:109], v[44:45], v[188:189]
    v_pk_fma_f32 v[110:111], v[110:111], v[44:45], v[190:191]
    s_waitcnt lgkmcnt(2)
    v_pk_mul_f32 v[192:193], v[192:193], v[52:53]
    v_pk_mul_f32 v[194:195], v[194:195], v[52:53]
    v_pk_fma_f32 v[112:113], v[112:113], v[44:45], v[192:193]
    v_pk_fma_f32 v[114:115], v[114:115], v[44:45], v[194:195]
    s_waitcnt lgkmcnt(1)
    v_pk_mul_f32 v[196:197], v[196:197], v[52:53]
    v_pk_mul_f32 v[198:199], v[198:199], v[52:53]
    v_pk_fma_f32 v[116:117], v[116:117], v[44:45], v[196:197]
    v_pk_fma_f32 v[118:119], v[118:119], v[44:45], v[198:199]
    s_waitcnt lgkmcnt(0)
    v_pk_mul_f32 v[200:201], v[200:201], v[52:53]
    v_pk_mul_f32 v[202:203], v[202:203], v[52:53]
    v_pk_fma_f32 v[120:121], v[120:121], v[44:45], v[200:201]
    v_pk_fma_f32 v[122:123], v[122:123], v[44:45], v[202:203]
    v_min_f32 v144, 0, v64
    v_min_f32 v145, 0, v65
    v_min_f32 v146, 0, v66
    v_min_f32 v147, 0, v67
    v_min_f32 v148, 0, v68
    v_min_f32 v149, 0, v69
    v_min_f32 v150, 0, v70
    v_min_f32 v151, 0, v71
    v_min_f32 v152, 0, v72
    v_min_f32 v153, 0, v73
    v_min_f32 v154, 0, v74
    v_min_f32 v155, 0, v75
    v_min_f32 v156, 0, v76
    v_min_f32 v157, 0, v77
    v_min_f32 v158, 0, v78
    v_min_f32 v159, 0, v79
    v_min_f32 v160, 0, v80
    v_min_f32 v161, 0, v81
    v_min_f32 v162, 0, v82
    v_min_f32 v163, 0, v83
    v_min_f32 v164, 0, v84
    v_min_f32 v165, 0, v85
    v_min_f32 v166, 0, v86
    v_min_f32 v167, 0, v87
    v_min_f32 v168, 0, v88
    v_min_f32 v169, 0, v89
    v_min_f32 v170, 0, v90
    v_min_f32 v171, 0, v91
    v_min_f32 v172, 0, v92
    v_min_f32 v173, 0, v93
    v_min_f32 v174, 0, v94
    v_min_f32 v175, 0, v95
    v_min_f32 v176, 0, v96
    v_min_f32 v177, 0, v97
    v_min_f32 v178, 0, v98
    v_min_f32 v179, 0, v99
    v_min_f32 v180, 0, v100
    v_min_f32 v181, 0, v101
    v_min_f32 v182, 0, v102
    v_min_f32 v183, 0, v103
    v_pk_mul_f32 v[144:145], v[144:145], v[56:57]
    v_pk_mul_f32 v[146:147], v[146:147], v[56:57]
    v_pk_mul_f32 v[148:149], v[148:149], v[56:57]
    v_pk_mul_f32 v[150:151], v[150:151], v[56:57]
    v_pk_mul_f32 v[152:153], v[152:153], v[56:57]
    v_pk_mul_f32 v[154:155], v[154:155], v[56:57]
    v_pk_mul_f32 v[156:157], v[156:157], v[56:57]
    v_pk_mul_f32 v[158:159], v[158:159], v[56:57]
    v_pk_mul_f32 v[160:161], v[160:161], v[56:57]
    v_pk_mul_f32 v[162:163], v[162:163], v[56:57]
    v_pk_mul_f32 v[164:165], v[164:165], v[56:57]
    v_pk_mul_f32 v[166:167], v[166:167], v[56:57]
    v_pk_mul_f32 v[168:169], v[168:169], v[56:57]
    v_pk_mul_f32 v[170:171], v[170:171], v[56:57]
    v_pk_mul_f32 v[172:173], v[172:173], v[56:57]
    v_pk_mul_f32 v[174:175], v[174:175], v[56:57]
    v_pk_mul_f32 v[176:177], v[176:177], v[56:57]
    v_pk_mul_f32 v[178:179], v[178:179], v[56:57]
    v_pk_mul_f32 v[180:181], v[180:181], v[56:57]
    v_pk_mul_f32 v[182:183], v[182:183], v[56:57]
    v_exp_f32 v144, v144
    v_exp_f32 v145, v145
    v_exp_f32 v146, v146
    v_exp_f32 v147, v147
    v_exp_f32 v148, v148
    v_exp_f32 v149, v149
    v_exp_f32 v150, v150
    v_exp_f32 v151, v151
    v_exp_f32 v152, v152
    v_exp_f32 v153, v153
    v_exp_f32 v154, v154
    v_exp_f32 v155, v155
    v_exp_f32 v156, v156
    v_exp_f32 v157, v157
    v_exp_f32 v158, v158
    v_exp_f32 v159, v159
    v_exp_f32 v160, v160
    v_exp_f32 v161, v161
    v_exp_f32 v162, v162
    v_exp_f32 v163, v163
    v_exp_f32 v164, v164
    v_exp_f32 v165, v165
    v_exp_f32 v166, v166
    v_exp_f32 v167, v167
    v_exp_f32 v168, v168
    v_exp_f32 v169, v169
    v_exp_f32 v170, v170
    v_exp_f32 v171, v171
    v_exp_f32 v172, v172
    v_exp_f32 v173, v173
    v_exp_f32 v174, v174
    v_exp_f32 v175, v175
    v_exp_f32 v176, v176
    v_exp_f32 v177, v177
    v_exp_f32 v178, v178
    v_exp_f32 v179, v179
    v_exp_f32 v180, v180
    v_exp_f32 v181, v181
    v_exp_f32 v182, v182
    v_exp_f32 v183, v183
    v_max_f32 v64, v54, v64
    v_max_f32 v65, v54, v65
    v_max_f32 v66, v54, v66
    v_max_f32 v67, v54, v67
    v_max_f32 v68, v54, v68
    v_max_f32 v69, v54, v69
    v_max_f32 v70, v54, v70
    v_max_f32 v71, v54, v71
    v_max_f32 v72, v54, v72
    v_max_f32 v73, v54, v73
    v_max_f32 v74, v54, v74
    v_max_f32 v75, v54, v75
    v_max_f32 v76, v54, v76
    v_max_f32 v77, v54, v77
    v_max_f32 v78, v54, v78
    v_max_f32 v79, v54, v79
    v_max_f32 v80, v54, v80
    v_max_f32 v81, v54, v81
    v_max_f32 v82, v54, v82
    v_max_f32 v83, v54, v83
    v_max_f32 v84, v54, v84
    v_max_f32 v85, v54, v85
    v_max_f32 v86, v54, v86
    v_max_f32 v87, v54, v87
    v_max_f32 v88, v54, v88
    v_max_f32 v89, v54, v89
    v_max_f32 v90, v54, v90
    v_max_f32 v91, v54, v91
    v_max_f32 v92, v54, v92
    v_max_f32 v93, v54, v93
    v_max_f32 v94, v54, v94
    v_max_f32 v95, v54, v95
    v_max_f32 v96, v54, v96
    v_max_f32 v97, v54, v97
    v_max_f32 v98, v54, v98
    v_max_f32 v99, v54, v99
    v_max_f32 v100, v54, v100
    v_max_f32 v101, v54, v101
    v_max_f32 v102, v54, v102
    v_max_f32 v103, v54, v103
    v_pk_add_f32 v[64:65], v[64:65], v[144:145]
    v_pk_add_f32 v[66:67], v[66:67], v[146:147]
    v_pk_add_f32 v[68:69], v[68:69], v[148:149]
    v_pk_add_f32 v[70:71], v[70:71], v[150:151]
    v_pk_add_f32 v[72:73], v[72:73], v[152:153]
    v_pk_add_f32 v[74:75], v[74:75], v[154:155]
    v_pk_add_f32 v[76:77], v[76:77], v[156:157]
    v_pk_add_f32 v[78:79], v[78:79], v[158:159]
    v_pk_add_f32 v[80:81], v[80:81], v[160:161]
    v_pk_add_f32 v[82:83], v[82:83], v[162:163]
    v_pk_add_f32 v[84:85], v[84:85], v[164:165]
    v_pk_add_f32 v[86:87], v[86:87], v[166:167]
    v_pk_add_f32 v[88:89], v[88:89], v[168:169]
    v_pk_add_f32 v[90:91], v[90:91], v[170:171]
    v_pk_add_f32 v[92:93], v[92:93], v[172:173]
    v_pk_add_f32 v[94:95], v[94:95], v[174:175]
    v_pk_add_f32 v[96:97], v[96:97], v[176:177]
    v_pk_add_f32 v[98:99], v[98:99], v[178:179]
    v_pk_add_f32 v[100:101], v[100:101], v[180:181]
    v_pk_add_f32 v[102:103], v[102:103], v[182:183]
    v_cvt_pk_bf16_f32 v184, v64, v65
    v_cvt_pk_bf16_f32 v185, v66, v67
    v_cvt_pk_bf16_f32 v186, v68, v69
    v_cvt_pk_bf16_f32 v187, v70, v71
    v_cvt_pk_bf16_f32 v188, v72, v73
    v_cvt_pk_bf16_f32 v189, v74, v75
    v_cvt_pk_bf16_f32 v190, v76, v77
    v_cvt_pk_bf16_f32 v191, v78, v79
    v_cvt_pk_bf16_f32 v192, v80, v81
    v_cvt_pk_bf16_f32 v193, v82, v83
    v_cvt_pk_bf16_f32 v194, v84, v85
    v_cvt_pk_bf16_f32 v195, v86, v87
    v_cvt_pk_bf16_f32 v196, v88, v89
    v_cvt_pk_bf16_f32 v197, v90, v91
    v_cvt_pk_bf16_f32 v198, v92, v93
    v_cvt_pk_bf16_f32 v199, v94, v95
    v_cvt_pk_bf16_f32 v200, v96, v97
    v_cvt_pk_bf16_f32 v201, v98, v99
    v_cvt_pk_bf16_f32 v202, v100, v101
    v_cvt_pk_bf16_f32 v203, v102, v103
    v_cvt_pk_bf16_f32 v204, v104, v105
    v_cvt_pk_bf16_f32 v205, v106, v107
    v_cvt_pk_bf16_f32 v206, v108, v109
    v_cvt_pk_bf16_f32 v207, v110, v111
    v_cvt_pk_bf16_f32 v208, v112, v113
    v_cvt_pk_bf16_f32 v209, v114, v115
    v_cvt_pk_bf16_f32 v210, v116, v117
    v_cvt_pk_bf16_f32 v211, v118, v119
    v_cvt_pk_bf16_f32 v212, v120, v121
    v_cvt_pk_bf16_f32 v213, v122, v123
    v_add_u32 v30, s33, v2
    v_mul_u32_u24 v30, 264, v30
    v_lshl_add_u32 v31, v3, 3, v30
    ds_write_b32 v31, v194 offset:0
    ds_write_b32 v31, v195 offset:4
    ds_write_b32 v31, v196 offset:16
    ds_write_b32 v31, v197 offset:20
    v_mov_b32 v47, 36
    v_mad_i32_i24 v47, v3, v47, v30
    ds_write_b32 v47, v198 offset:32
    ds_write_b32 v31, v199 offset:64
    ds_write_b32 v31, v200 offset:76
    ds_write_b32 v31, v201 offset:80
    v_mov_b32 v48, -32
    v_mad_i32_i24 v48, v3, v48, v30
    ds_write_b32 v48, v202 offset:92
    v_mov_b32 v49, -36
    v_mad_i32_i24 v49, v3, v49, v30
    ds_write_b32 v49, v203 offset:96
    ds_write_b32 v31, v204 offset:128
    ds_write_b32 v31, v205 offset:132
    ds_write_b32 v31, v206 offset:144
    ds_write_b32 v31, v207 offset:148
    v_mov_b32 v50, 36
    v_mad_i32_i24 v50, v3, v50, v30
    ds_write_b32 v50, v208 offset:160
    ds_write_b32 v31, v209 offset:192
    ds_write_b32 v31, v210 offset:204
    ds_write_b32 v31, v211 offset:208
    v_mov_b32 v47, -160
    v_mad_i32_i24 v47, v3, v47, v30
    ds_write_b32 v47, v212 offset:220
    v_mov_b32 v48, -164
    v_mad_i32_i24 v48, v3, v48, v30
    ds_write_b32 v48, v213 offset:224
    v_lshl_add_u32 v51, v3, 6, v30
    v_mov_b32 v52, 0x3f80
    ds_write_b32 v51, v52 offset:164
    s_mul_i32 s45, s25, 72
    v_add_u32 v53, s32, v2
    v_mul_u32_u24 v53, 1168, v53
    v_lshl_add_u32 v54, v3, 3, v53
    v_add_u32 v55, s45, v54
    v_mov_b32 v57, 2146435072
    v_cmp_eq_u32 s[48:49], 0, v3
    s_nop 1
    v_cndmask_b32 v56, v57, v55, s[48:49]
    s_waitcnt lgkmcnt(0)
    s_barrier
    s_cmp_ge_u32 s3, 2
    s_cbranch_scc1 L_k1_stores
    v_lshl_add_u32 v15, v3, 3, v13
    v_mul_u32_u24 v15, 264, v15
    v_lshl_add_u32 v15, v14, 5, v15
    v_lshl_add_u32 v15, v12, 3, v15
    s_lshl_b32 s50, s3, 6
    v_add_u32 v15, s50, v15
    ds_read_b64_tr_b16 v[64:65], v15 offset:128
    ds_read_b64_tr_b16 v[66:67], v15 offset:1184
    ds_read_b64_tr_b16 v[68:69], v15 offset:0
    ds_read_b64_tr_b16 v[70:71], v15 offset:1056
    ds_read_b64_tr_b16 v[72:73], v15 offset:4352
    ds_read_b64_tr_b16 v[74:75], v15 offset:5408
    ds_read_b64_tr_b16 v[76:77], v15 offset:4224
    ds_read_b64_tr_b16 v[78:79], v15 offset:5280
    ds_read_b64_tr_b16 v[80:81], v15 offset:8576
    ds_read_b64_tr_b16 v[82:83], v15 offset:9632
    ds_read_b64_tr_b16 v[84:85], v15 offset:8448
    ds_read_b64_tr_b16 v[86:87], v15 offset:9504
    s_waitcnt lgkmcnt(8)
    v_mfma_f32_32x32x16_bf16 v[128:143], v[64:67], v[68:71], 0
    ds_read_b64_tr_b16 v[88:89], v15 offset:12800
    ds_read_b64_tr_b16 v[90:91], v15 offset:13856
    ds_read_b64_tr_b16 v[92:93], v15 offset:12672
    ds_read_b64_tr_b16 v[94:95], v15 offset:13728
    s_waitcnt lgkmcnt(8)
    v_mfma_f32_32x32x16_bf16 v[128:143], v[72:75], v[76:79], v[128:143]
    ds_read_b64_tr_b16 v[96:97], v15 offset:17024
    ds_read_b64_tr_b16 v[98:99], v15 offset:18080
    ds_read_b64_tr_b16 v[100:101], v15 offset:16896
    ds_read_b64_tr_b16 v[102:103], v15 offset:17952
    s_waitcnt lgkmcnt(8)
    v_mfma_f32_32x32x16_bf16 v[128:143], v[80:83], v[84:87], v[128:143]
    ds_read_b64_tr_b16 v[104:105], v15 offset:21248
    ds_read_b64_tr_b16 v[106:107], v15 offset:22304
    ds_read_b64_tr_b16 v[108:109], v15 offset:21120
    ds_read_b64_tr_b16 v[110:111], v15 offset:22176
    s_waitcnt lgkmcnt(8)
    v_mfma_f32_32x32x16_bf16 v[128:143], v[88:91], v[92:95], v[128:143]
    ds_read_b64_tr_b16 v[112:113], v15 offset:25472
    ds_read_b64_tr_b16 v[114:115], v15 offset:26528
    ds_read_b64_tr_b16 v[116:117], v15 offset:25344
    ds_read_b64_tr_b16 v[118:119], v15 offset:26400
    s_waitcnt lgkmcnt(8)
    v_mfma_f32_32x32x16_bf16 v[128:143], v[96:99], v[100:103], v[128:143]
    ds_read_b64_tr_b16 v[120:121], v15 offset:29696
    ds_read_b64_tr_b16 v[122:123], v15 offset:30752
    ds_read_b64_tr_b16 v[124:125], v15 offset:29568
    ds_read_b64_tr_b16 v[126:127], v15 offset:30624
    s_waitcnt lgkmcnt(8)
    v_mfma_f32_32x32x16_bf16 v[128:143], v[104:107], v[108:111], v[128:143]
    s_lshl_b32 s50, s25, 1
    s_add_u32 s50, s50, s3
    s_mul_i32 s50, s50, 1824
    v_mul_u32_u24 v18, 384, v3
    v_lshl_add_u32 v18, v2, 2, v18
    v_cmp_gt_u32 vcc, 18, v2
    s_nop 1
    v_cndmask_b32 v18, v57, v18, vcc
    v_cndmask_b32 v19, v57, v18, s[48:49]
    s_waitcnt lgkmcnt(4)
    v_mfma_f32_32x32x16_bf16 v[128:143], v[112:115], v[116:119], v[128:143]
    s_waitcnt lgkmcnt(0)
    v_mfma_f32_32x32x16_bf16 v[128:143], v[120:123], v[124:127], v[128:143]
    s_waitcnt vmcnt(3)
L_k1_poll:
    v_readfirstlane_b32 s51, v59
    s_nop 0
    s_cmp_lg_u32 s51, 0
    s_cbranch_scc1 L_k1_go
    s_sleep 2
    buffer_load_dword v59, v58, s[40:43], s37 offen offset:64 sc0 sc1
    s_waitcnt vmcnt(0)
    s_branch L_k1_poll
L_k1_go:
    s_nop 7
    s_nop 3
    buffer_atomic_add_f32 v128, v18, s[20:23], s50 offen offset:0
    buffer_atomic_add_f32 v129, v18, s[20:23], s50 offen offset:96
    buffer_atomic_add_f32 v130, v18, s[20:23], s50 offen offset:192
    buffer_atomic_add_f32 v131, v18, s[20:23], s50 offen offset:288
    buffer_atomic_add_f32 v132, v18, s[20:23], s50 offen offset:768
    buffer_atomic_add_f32 v133, v18, s[20:23], s50 offen offset:864
    buffer_atomic_add_f32 v134, v18, s[20:23], s50 offen offset:960
    buffer_atomic_add_f32 v135, v18, s[20:23], s50 offen offset:1056
    buffer_atomic_add_f32 v136, v19, s[20:23], s50 offen offset:1536
    buffer_atomic_add_f32 v137, v19, s[20:23], s50 offen offset:1632
    buffer_atomic_add_f32 v138, v19, s[20:23], s50 offen offset:1728
L_k1_stores:
    buffer_store_dwordx2 v[184:185], v55, s[16:19], 0 offen offset:0
    buffer_store_dwordx2 v[186:187], v55, s[16:19], 0 offen offset:16
    buffer_store_dwordx2 v[188:189], v55, s[16:19], 0 offen offset:32
    buffer_store_dwordx2 v[190:191], v55, s[16:19], 0 offen offset:48
    buffer_store_dwordx2 v[192:193], v56, s[16:19], 0 offen offset:64
    s_cmp_lg_u32 s25, 15
    s_cbranch_scc1 L_k1_fin
    v_mov_b32 v60, 0
    v_mov_b32 v61, 0
    buffer_store_dwordx2 v[60:61], v54, s[16:19], 0 offen offset:1152
L_k1_fin:
L_k1_done:
    s_endpgm
.section .rodata,"a"
.p2align 6
.amdhsa_kernel qkv_kernel
  .amdhsa_next_free_vgpr 256
  .amdhsa_next_free_sgpr 102
  .amdhsa_accum_offset 256
  .amdhsa_group_segment_fixed_size 0
  .amdhsa_kernarg_size 80
  .amdhsa_user_sgpr_count 2
  .amdhsa_user_sgpr_kernarg_segment_ptr 1
  .amdhsa_system_sgpr_workgroup_id_x 1
.end_amdhsa_kernel
.text
.globl attn_kernel
.p2align 8
.type attn_kernel,@function
attn_kernel:

    s_cmp_ge_u32 s2, 256
    s_cbranch_scc1 L_k2_done
    s_load_dwordx2 s[4:5], s[0:1], 0
    s_load_dwordx2 s[6:7], s[0:1], 16
    s_load_dwordx2 s[30:31], s[0:1], 72
    s_load_dwordx4 s[84:87], s[0:1], 40
    v_lshrrev_b32 v1, 6, v0
    s_nop 0
    v_readfirstlane_b32 s3, v1
    v_and_b32 v1, 63, v0
    s_and_b32 s24, s2, 7
    s_lshl_b32 s24, s24, 2
    s_lshr_b32 s25, s2, 3
    s_and_b32 s26, s25, 3
    s_add_u32 s24, s24, s26
    s_lshr_b32 s25, s25, 2
    v_and_b32 v2, 15, v1
    v_lshrrev_b32 v3, 4, v1
    v_mov_b32 v6, 2146435072
    v_min_u32 v5, 2, v3
    v_lshlrev_b32 v5, 5, v5
    s_lshl_b32 s28, s3, 13
    s_add_u32 s28, s28, 74752
    v_add_u32 v5, s28, v5
    v_mul_u32_u24 v4, 96, v2
    v_add_u32 v4, v4, v5
    v_cmp_gt_u32 s[60:61], 3, v3
    v_and_b32 v8, 3, v2
    v_cmp_eq_u32 s[44:45], 2, v8
    v_and_b32 v7, 1, v2
    s_nop 0
    v_cndmask_b32 v7, v7, 2, s[44:45]
    v_mul_u32_u24 v7, 96, v7
    v_add3_u32 v7, v7, v5, 0
    v_add_u32 v7, 1536, v7
    v_cmp_gt_u32 s[46:47], 2, v2
    s_nop 0
    s_or_b64 s[44:45], s[44:45], s[46:47]
    s_and_b64 s[62:63], s[44:45], s[60:61]
    s_mul_i32 s27, s3, 7296
    v_lshlrev_b32 v8, 4, v1
    v_lshlrev_b32 v9, 4, v0
    s_mul_i32 s29, s24, 74752
    s_lshl_b32 s33, s3, 10
    v_mul_u32_u24 v10, 57, v1
    v_lshrrev_b32 v10, 9, v10
    v_mul_u32_u24 v11, 9, v10
    v_sub_u32 v11, v1, v11
    v_mul_u32_u24 v10, 1152, v10
    v_lshl_add_u32 v10, v11, 4, v10
    s_mul_i32 s34, s25, 144
    s_mul_i32 s35, s3, 6912
    s_add_u32 s35, s35, s34
    v_add_u32 v10, s35, v10
    s_mul_i32 s48, s3, 864
    s_lshr_b32 s56, s2, 3
    s_mul_i32 s57, s56, 73
    s_and_b32 s58, s2, 7
    s_mul_i32 s58, s58, 2336
    s_add_u32 s57, s57, s58
    v_add_u32 v24, s57, v0
    v_lshlrev_b32 v24, 7, v24
    v_cmp_gt_u32 vcc, 73, v0
    s_nop 1
    v_cndmask_b32 v24, v6, v24, vcc
    s_mul_i32 s57, s56, 15
    v_subrev_u32 v25, 128, v0
    v_cmp_gt_u32 vcc, 15, v25
    v_add_u32 v25, s57, v25
    v_lshlrev_b32 v25, 7, v25
    v_cndmask_b32 v25, v6, v25, vcc
    s_waitcnt lgkmcnt(0)
    s_add_u32 s20, s30, 0
    s_addc_u32 s21, s31, 0
    s_and_b32 s21, s21, 0xffff
    s_mov_b32 s22, 58368
    s_mov_b32 s23, 0x00020000
    s_add_u32 s16, s30, 131072
    s_addc_u32 s17, s31, 0
    s_and_b32 s17, s17, 0xffff
    s_mov_b32 s18, 2392064
    s_mov_b32 s19, 0x00020000
    buffer_load_dword v26, v24, s[16:19], 0 offen
    buffer_load_dword v27, v25, s[20:23], 0 offen
    s_mov_b32 m0, s28
    s_nop 0
    buffer_load_dwordx4 v8, s[20:23], s27 offen offset:0 lds
    buffer_load_dwordx4 v8, s[20:23], s27 offen offset:1024 lds
    buffer_load_dwordx4 v8, s[20:23], s27 offen offset:2048 lds
    buffer_load_dwordx4 v8, s[20:23], s27 offen offset:3072 lds
    s_add_u32 m0, m0, 0x1000
    s_add_u32 s27, s27, 0x1000
    buffer_load_dwordx4 v8, s[20:23], s27 offen offset:0 lds
    buffer_load_dwordx4 v8, s[20:23], s27 offen offset:1024 lds
    buffer_load_dwordx4 v8, s[20:23], s27 offen offset:2048 lds
    buffer_load_dwordx4 v8, s[20:23], s27 offen offset:3072 lds
    s_mov_b32 m0, s33
    s_nop 0
    buffer_load_dwordx4 v9, s[16:19], s29 offen lds
    s_add_u32 m0, m0, 0x2000
    s_add_u32 s29, s29, 0x2000
    buffer_load_dwordx4 v9, s[16:19], s29 offen lds
    s_add_u32 m0, m0, 0x2000
    s_add_u32 s29, s29, 0x2000
    buffer_load_dwordx4 v9, s[16:19], s29 offen lds
    s_add_u32 m0, m0, 0x2000
    s_add_u32 s29, s29, 0x2000
    buffer_load_dwordx4 v9, s[16:19], s29 offen lds
    s_add_u32 m0, m0, 0x2000
    s_add_u32 s29, s29, 0x2000
    buffer_load_dwordx4 v9, s[16:19], s29 offen lds
    s_add_u32 m0, m0, 0x2000
    s_add_u32 s29, s29, 0x2000
    buffer_load_dwordx4 v9, s[16:19], s29 offen lds
    s_add_u32 m0, m0, 0x2000
    s_add_u32 s29, s29, 0x2000
    buffer_load_dwordx4 v9, s[16:19], s29 offen lds
    s_add_u32 m0, m0, 0x2000
    s_add_u32 s29, s29, 0x2000
    buffer_load_dwordx4 v9, s[16:19], s29 offen lds
    s_add_u32 m0, m0, 0x2000
    s_add_u32 s29, s29, 0x2000
    buffer_load_dwordx4 v9, s[16:19], s29 offen lds
    s_add_u32 m0, m0, 0x2000
    s_add_u32 s29, s29, 0x2000
    s_cmp_lg_u32 s3, 0
    s_cbranch_scc1 L_k2_skip_pq
    buffer_load_dwordx4 v9, s[16:19], s29 offen lds
L_k2_skip_pq:
    s_waitcnt vmcnt(9)
    ds_read_b128 v[64:67], v4 offset:0
    ds_read_b128 v[68:71], v4 offset:16
    ds_read_b128 v[72:75], v7 offset:0
    ds_read_b128 v[76:79], v7 offset:16
    ds_read_b64 v[80:81], v4 offset:1816
    ds_read_b64 v[82:83], v4 offset:1824
    ds_read_b64 v[84:85], v4 offset:1832
    ds_read_b64 v[86:87], v4 offset:1840
    ds_read_b64 v[88:89], v7 offset:1816
    ds_read_b64 v[90:91], v7 offset:1824
    ds_read_b64 v[92:93], v7 offset:1832
    ds_read_b64 v[94:95], v7 offset:1840
    ds_read_b128 v[96:99], v4 offset:3632
    ds_read_b128 v[100:103], v4 offset:3648
    ds_read_b128 v[104:107], v7 offset:3632
    ds_read_b128 v[108:111], v7 offset:3648
    ds_read_b64 v[112:113], v4 offset:5448
    ds_read_b64 v[114:115], v4 offset:5456
    ds_read_b64 v[116:117], v4 offset:5464
    ds_read_b64 v[118:119], v4 offset:5472
    ds_read_b64 v[120:121], v7 offset:5448
    ds_read_b64 v[122:123], v7 offset:5456
    ds_read_b64 v[124:125], v7 offset:5464
    ds_read_b64 v[126:127], v7 offset:5472
    s_waitcnt lgkmcnt(0)
    v_mul_u32_u24 v14, 1168, v2
    s_mul_i32 s57, s3, 144
    v_add_u32 v14, s57, v14
    v_lshl_add_u32 v15, v3, 3, v14
    v_min_u32 v16, 2, v3
    v_lshl_add_u32 v14, v16, 4, v14
    v_cmp_eq_u32 s[58:59], 0, v3
    v_cvt_pk_bf16_f32 v128, v64, v65
    v_cvt_pk_bf16_f32 v129, v66, v67
    v_cvt_pk_bf16_f32 v130, v68, v69
    v_cvt_pk_bf16_f32 v131, v70, v71
    v_cndmask_b32 v128, 0, v128, s[60:61]
    v_cndmask_b32 v129, 0, v129, s[60:61]
    v_cndmask_b32 v130, 0, v130, s[60:61]
    v_cndmask_b32 v131, 0, v131, s[60:61]
    v_cvt_pk_bf16_f32 v132, v72, v73
    v_cvt_pk_bf16_f32 v133, v74, v75
    v_cvt_pk_bf16_f32 v134, v76, v77
    v_cvt_pk_bf16_f32 v135, v78, v79
    v_cndmask_b32 v132, 0, v132, s[62:63]
    v_cndmask_b32 v133, 0, v133, s[62:63]
    v_cndmask_b32 v134, 0, v134, s[62:63]
    v_cndmask_b32 v135, 0, v135, s[62:63]
    v_cvt_pk_bf16_f32 v136, v80, v81
    v_cvt_pk_bf16_f32 v137, v82, v83
    v_cvt_pk_bf16_f32 v138, v84, v85
    v_cvt_pk_bf16_f32 v139, v86, v87
    v_cndmask_b32 v136, 0, v136, s[60:61]
    v_cndmask_b32 v137, 0, v137, s[60:61]
    v_cndmask_b32 v138, 0, v138, s[60:61]
    v_cndmask_b32 v139, 0, v139, s[60:61]
    v_cvt_pk_bf16_f32 v140, v88, v89
    v_cvt_pk_bf16_f32 v141, v90, v91
    v_cvt_pk_bf16_f32 v142, v92, v93
    v_cvt_pk_bf16_f32 v143, v94, v95
    v_cndmask_b32 v140, 0, v140, s[62:63]
    v_cndmask_b32 v141, 0, v141, s[62:63]
    v_cndmask_b32 v142, 0, v142, s[62:63]
    v_cndmask_b32 v143, 0, v143, s[62:63]
    v_cvt_pk_bf16_f32 v144, v96, v97
    v_cvt_pk_bf16_f32 v145, v98, v99
    v_cvt_pk_bf16_f32 v146, v100, v101
    v_cvt_pk_bf16_f32 v147, v102, v103
    v_cndmask_b32 v144, 0, v144, s[60:61]
    v_cndmask_b32 v145, 0, v145, s[60:61]
    v_cndmask_b32 v146, 0, v146, s[60:61]
    v_cndmask_b32 v147, 0, v147, s[60:61]
    v_cvt_pk_bf16_f32 v148, v104, v105
    v_cvt_pk_bf16_f32 v149, v106, v107
    v_cvt_pk_bf16_f32 v150, v108, v109
    v_cvt_pk_bf16_f32 v151, v110, v111
    v_cndmask_b32 v148, 0, v148, s[62:63]
    v_cndmask_b32 v149, 0, v149, s[62:63]
    v_cndmask_b32 v150, 0, v150, s[62:63]
    v_cndmask_b32 v151, 0, v151, s[62:63]
    v_cvt_pk_bf16_f32 v152, v112, v113
    v_cvt_pk_bf16_f32 v153, v114, v115
    v_cvt_pk_bf16_f32 v154, v116, v117
    v_cvt_pk_bf16_f32 v155, v118, v119
    v_cndmask_b32 v152, 0, v152, s[60:61]
    v_cndmask_b32 v153, 0, v153, s[60:61]
    v_cndmask_b32 v154, 0, v154, s[60:61]
    v_cndmask_b32 v155, 0, v155, s[60:61]
    v_cvt_pk_bf16_f32 v156, v120, v121
    v_cvt_pk_bf16_f32 v157, v122, v123
    v_cvt_pk_bf16_f32 v158, v124, v125
    v_cvt_pk_bf16_f32 v159, v126, v127
    v_cndmask_b32 v156, 0, v156, s[62:63]
    v_cndmask_b32 v157, 0, v157, s[62:63]
    v_cndmask_b32 v158, 0, v158, s[62:63]
    v_cndmask_b32 v159, 0, v159, s[62:63]
    s_waitcnt vmcnt(0)
    s_barrier
    ds_read_b128 v[64:67], v14 offset:0
    ds_read_b128 v[68:71], v14 offset:32
    ds_read_b128 v[72:75], v14 offset:64
    ds_read_b128 v[76:79], v14 offset:96
    ds_read_b128 v[80:83], v14 offset:18688
    ds_read_b128 v[84:87], v14 offset:18720
    ds_read_b128 v[88:91], v14 offset:18752
    ds_read_b128 v[92:95], v14 offset:18784
    ds_read_b128 v[96:99], v14 offset:37376
    ds_read_b128 v[100:103], v14 offset:37408
    ds_read_b128 v[104:107], v14 offset:37440
    ds_read_b128 v[108:111], v14 offset:37472
    ds_read_b128 v[112:115], v14 offset:56064
    ds_read_b128 v[116:119], v14 offset:56096
    ds_read_b128 v[120:123], v14 offset:56128
    ds_read_b128 v[124:127], v14 offset:56160
    s_mov_b32 s12, s6
    s_and_b32 s13, s7, 0xffff
    s_mov_b32 s14, 663552
    s_mov_b32 s15, 0x00020000
    s_mov_b32 s8, s4
    s_and_b32 s9, s5, 0xffff
    s_mov_b32 s10, 2359296
    s_mov_b32 s11, 0x00020000
    s_add_u32 m0, s48, 74752
    s_mov_b32 s49, 0
    s_mov_b32 s50, -1
    s_mov_b32 s51, 0x3fffff
    s_mov_b64 exec, s[50:51]
    buffer_load_dwordx4 v10, s[12:15], s49 offen lds
    s_add_u32 m0, m0, 6912
    s_add_u32 s49, s49, 55296
    buffer_load_dwordx4 v10, s[12:15], s49 offen lds
    s_add_u32 m0, m0, 6912
    s_add_u32 s49, s49, 55296
    buffer_load_dwordx4 v10, s[12:15], s49 offen lds
    s_add_u32 m0, m0, 6912
    s_add_u32 s49, s49, 55296
    buffer_load_dwordx4 v10, s[12:15], s49 offen lds
    s_add_u32 m0, m0, 6912
    s_add_u32 s49, s49, 55296
    buffer_load_dwordx4 v10, s[12:15], s49 offen lds
    s_add_u32 m0, m0, 6912
    s_add_u32 s49, s49, 55296
    buffer_load_dwordx4 v10, s[12:15], s49 offen lds
    s_add_u32 m0, m0, 6912
    s_add_u32 s49, s49, 55296
    buffer_load_dwordx4 v10, s[12:15], s49 offen lds
    s_add_u32 m0, m0, 6912
    s_add_u32 s49, s49, 55296
    buffer_load_dwordx4 v10, s[12:15], s49 offen lds
    s_add_u32 m0, m0, 6912
    s_add_u32 s49, s49, 55296
    buffer_load_dwordx4 v10, s[12:15], s49 offen lds
    s_add_u32 m0, m0, 6912
    s_add_u32 s49, s49, 55296
    buffer_load_dwordx4 v10, s[12:15], s49 offen lds
    s_add_u32 m0, m0, 6912
    s_add_u32 s49, s49, 55296
    buffer_load_dwordx4 v10, s[12:15], s49 offen lds
    s_add_u32 m0, m0, 6912
    s_add_u32 s49, s49, 55296
    buffer_load_dwordx4 v10, s[12:15], s49 offen lds
    s_mov_b64 exec, -1
    s_and_b32 s52, s3, 3
    s_lshr_b32 s53, s3, 2
    s_lshl_b32 s35, s24, 6
    s_lshl_b32 s54, s52, 4
    s_add_u32 s35, s35, s54
    v_add_u32 v12, s35, v2
    v_mul_u32_u24 v13, 1152, v12
    v_lshl_add_u32 v13, v3, 3, v13
    s_mul_i32 s55, s53, 96
    s_add_u32 s56, s55, s34
    v_add_u32 v13, s56, v13
    buffer_load_dwordx2 v[40:41], v13, s[8:11], 0 offen offset:0
    buffer_load_dwordx2 v[42:43], v13, s[8:11], 0 offen offset:32
    buffer_load_dwordx2 v[44:45], v13, s[8:11], 0 offen offset:64
    s_lshr_b32 s82, s2, 3
    s_lshl_b32 s82, s82, 3
    s_add_u32 s82, s82, s3
    s_mul_i32 s82, s82, 21
    s_add_u32 s83, s2, 0
    s_and_b32 s83, s83, 7
    s_mul_i32 s83, s83, 5184
    v_min_u32 v46, 20, v1
    v_add_u32 v46, s82, v46
    v_min_u32 v46, 5183, v46
    v_add_u32 v46, s83, v46
    v_lshlrev_b32 v46, 7, v46
    global_load_dword v47, v46, s[86:87]
    s_add_u32 s36, s30, 2555904
    s_addc_u32 s37, s31, 0
    s_and_b32 s37, s37, 0xffff
    s_mov_b32 s38, 2359296
    s_mov_b32 s39, 0x00020000
    s_add_u32 s40, s30, 42663936
    s_addc_u32 s41, s31, 0
    s_and_b32 s41, s41, 0xffff
    s_mov_b32 s42, 262144
    s_mov_b32 s43, 0x00020000
    s_waitcnt lgkmcnt(15)
    v_mfma_f32_16x16x32_bf16 v[160:163], v[128:131], v[64:67], 0
    v_mfma_f32_16x16x32_bf16 v[164:167], v[132:135], v[64:67], 0
    s_waitcnt lgkmcnt(14)
    v_mfma_f32_16x16x32_bf16 v[168:171], v[136:139], v[68:71], 0
    v_mfma_f32_16x16x32_bf16 v[172:175], v[140:143], v[68:71], 0
    s_waitcnt lgkmcnt(13)
    v_mfma_f32_16x16x32_bf16 v[176:179], v[144:147], v[72:75], 0
    v_mfma_f32_16x16x32_bf16 v[180:183], v[148:151], v[72:75], 0
    s_waitcnt lgkmcnt(12)
    v_mfma_f32_16x16x32_bf16 v[184:187], v[152:155], v[76:79], 0
    v_mfma_f32_16x16x32_bf16 v[188:191], v[156:159], v[76:79], 0
    s_waitcnt lgkmcnt(11)
    v_mfma_f32_16x16x32_bf16 v[192:195], v[128:131], v[80:83], 0
    v_mfma_f32_16x16x32_bf16 v[196:199], v[132:135], v[80:83], 0
    s_waitcnt lgkmcnt(10)
    v_mfma_f32_16x16x32_bf16 v[200:203], v[136:139], v[84:87], 0
    v_mfma_f32_16x16x32_bf16 v[204:207], v[140:143], v[84:87], 0
    s_waitcnt lgkmcnt(9)
    v_mfma_f32_16x16x32_bf16 v[208:211], v[144:147], v[88:91], 0
    v_mfma_f32_16x16x32_bf16 v[212:215], v[148:151], v[88:91], 0
    s_waitcnt lgkmcnt(8)
    v_mfma_f32_16x16x32_bf16 v[216:219], v[152:155], v[92:95], 0
    v_mfma_f32_16x16x32_bf16 v[220:223], v[156:159], v[92:95], 0
    v_add_f32 v166, 0x358637bd, v166
    v_add_f32 v174, 0x358637bd, v174
    v_add_f32 v182, 0x358637bd, v182
    v_add_f32 v190, 0x358637bd, v190
    v_add_f32 v198, 0x358637bd, v198
    v_add_f32 v206, 0x358637bd, v206
    v_add_f32 v214, 0x358637bd, v214
    s_nop 0
    v_add_f32 v222, 0x358637bd, v222
    v_rcp_f32 v166, v166
    v_rcp_f32 v174, v174
    v_rcp_f32 v182, v182
    v_rcp_f32 v190, v190
    v_rcp_f32 v198, v198
    v_rcp_f32 v206, v206
    v_rcp_f32 v214, v214
    v_rcp_f32 v222, v222
    v_mul_f32 v160, v160, v166
    v_mul_f32 v168, v168, v174
    v_mul_f32 v176, v176, v182
    v_mul_f32 v184, v184, v190
    v_mul_f32 v192, v192, v198
    v_mul_f32 v200, v200, v206
    v_mul_f32 v208, v208, v214
    v_mul_f32 v216, v216, v222
    v_mul_f32 v161, v161, v166
    v_mul_f32 v169, v169, v174
    v_mul_f32 v177, v177, v182
    v_mul_f32 v185, v185, v190
    v_mul_f32 v193, v193, v198
    v_mul_f32 v201, v201, v206
    v_mul_f32 v209, v209, v214
    v_mul_f32 v217, v217, v222
    v_mul_f32 v162, v162, v166
    v_mul_f32 v170, v170, v174
    v_mul_f32 v178, v178, v182
    v_mul_f32 v186, v186, v190
    v_mul_f32 v194, v194, v198
    v_mul_f32 v202, v202, v206
    v_mul_f32 v210, v210, v214
    v_mul_f32 v218, v218, v222
    v_mul_f32 v163, v163, v166
    v_mul_f32 v171, v171, v174
    v_mul_f32 v179, v179, v182
    v_mul_f32 v187, v187, v190
    v_mul_f32 v195, v195, v198
    v_mul_f32 v203, v203, v206
    v_mul_f32 v211, v211, v214
    v_mul_f32 v219, v219, v222
    v_mul_f32 v164, v164, v166
    v_mul_f32 v172, v172, v174
    v_mul_f32 v180, v180, v182
    v_mul_f32 v188, v188, v190
    v_mul_f32 v196, v196, v198
    v_mul_f32 v204, v204, v206
    v_mul_f32 v212, v212, v214
    v_mul_f32 v220, v220, v222
    v_mul_f32 v165, v165, v166
    v_mul_f32 v173, v173, v174
    v_mul_f32 v181, v181, v182
    v_mul_f32 v189, v189, v190
    v_mul_f32 v197, v197, v198
    v_mul_f32 v205, v205, v206
    v_mul_f32 v213, v213, v214
    v_mul_f32 v221, v221, v222
    v_cvt_pk_bf16_f32 v160, v160, v161
    v_cvt_pk_bf16_f32 v161, v162, v163
    v_cvt_pk_bf16_f32 v162, v164, v165
    v_cvt_pk_bf16_f32 v168, v168, v169
    v_cvt_pk_bf16_f32 v169, v170, v171
    v_cvt_pk_bf16_f32 v170, v172, v173
    v_cvt_pk_bf16_f32 v176, v176, v177
    v_cvt_pk_bf16_f32 v177, v178, v179
    v_cvt_pk_bf16_f32 v178, v180, v181
    v_cvt_pk_bf16_f32 v184, v184, v185
    v_cvt_pk_bf16_f32 v185, v186, v187
    v_cvt_pk_bf16_f32 v186, v188, v189
    v_cvt_pk_bf16_f32 v192, v192, v193
    v_cvt_pk_bf16_f32 v193, v194, v195
    v_cvt_pk_bf16_f32 v194, v196, v197
    v_cvt_pk_bf16_f32 v200, v200, v201
    v_cvt_pk_bf16_f32 v201, v202, v203
    v_cvt_pk_bf16_f32 v202, v204, v205
    v_cvt_pk_bf16_f32 v208, v208, v209
    v_cvt_pk_bf16_f32 v209, v210, v211
    v_cvt_pk_bf16_f32 v210, v212, v213
    v_cvt_pk_bf16_f32 v216, v216, v217
    v_cvt_pk_bf16_f32 v217, v218, v219
    v_cvt_pk_bf16_f32 v218, v220, v221
    v_add_u32 v21, 18688, v15
    ds_write_b64 v15, v[160:161] offset:0
    ds_write2_b32 v15, v168, v169 offset0:9 offset1:10
    ds_write_b64 v15, v[176:177] offset:72
    ds_write2_b32 v15, v184, v185 offset0:27 offset1:28
    ds_write_b64 v21, v[192:193] offset:0
    ds_write2_b32 v21, v200, v201 offset0:9 offset1:10
    ds_write_b64 v21, v[208:209] offset:72
    ds_write2_b32 v21, v216, v217 offset0:27 offset1:28
    s_mov_b64 exec, s[58:59]
    ds_write_b32 v15, v162 offset:32
    ds_write_b32 v15, v170 offset:68
    ds_write_b32 v15, v178 offset:104
    ds_write_b32 v15, v186 offset:140
    ds_write_b32 v15, v194 offset:18720
    ds_write_b32 v15, v202 offset:18756
    ds_write_b32 v15, v210 offset:18792
    ds_write_b32 v15, v218 offset:18828
    s_mov_b64 exec, -1
    s_waitcnt lgkmcnt(15)
    v_mfma_f32_16x16x32_bf16 v[160:163], v[128:131], v[96:99], 0
    v_mfma_f32_16x16x32_bf16 v[164:167], v[132:135], v[96:99], 0
    s_waitcnt lgkmcnt(15)
    v_mfma_f32_16x16x32_bf16 v[168:171], v[136:139], v[100:103], 0
    v_mfma_f32_16x16x32_bf16 v[172:175], v[140:143], v[100:103], 0
    s_waitcnt lgkmcnt(15)
    v_mfma_f32_16x16x32_bf16 v[176:179], v[144:147], v[104:107], 0
    v_mfma_f32_16x16x32_bf16 v[180:183], v[148:151], v[104:107], 0
    s_waitcnt lgkmcnt(15)
    v_mfma_f32_16x16x32_bf16 v[184:187], v[152:155], v[108:111], 0
    v_mfma_f32_16x16x32_bf16 v[188:191], v[156:159], v[108:111], 0
    s_waitcnt lgkmcnt(15)
    v_mfma_f32_16x16x32_bf16 v[192:195], v[128:131], v[112:115], 0
    v_mfma_f32_16x16x32_bf16 v[196:199], v[132:135], v[112:115], 0
    s_waitcnt lgkmcnt(15)
    v_mfma_f32_16x16x32_bf16 v[200:203], v[136:139], v[116:119], 0
    v_mfma_f32_16x16x32_bf16 v[204:207], v[140:143], v[116:119], 0
    s_waitcnt lgkmcnt(15)
    v_mfma_f32_16x16x32_bf16 v[208:211], v[144:147], v[120:123], 0
    v_mfma_f32_16x16x32_bf16 v[212:215], v[148:151], v[120:123], 0
    s_waitcnt lgkmcnt(15)
    v_mfma_f32_16x16x32_bf16 v[216:219], v[152:155], v[124:127], 0
    v_mfma_f32_16x16x32_bf16 v[220:223], v[156:159], v[124:127], 0
    v_add_f32 v166, 0x358637bd, v166
    v_add_f32 v174, 0x358637bd, v174
    v_add_f32 v182, 0x358637bd, v182
    v_add_f32 v190, 0x358637bd, v190
    v_add_f32 v198, 0x358637bd, v198
    v_add_f32 v206, 0x358637bd, v206
    v_add_f32 v214, 0x358637bd, v214
    s_nop 0
    v_add_f32 v222, 0x358637bd, v222
    v_rcp_f32 v166, v166
    v_rcp_f32 v174, v174
    v_rcp_f32 v182, v182
    v_rcp_f32 v190, v190
    v_rcp_f32 v198, v198
    v_rcp_f32 v206, v206
    v_rcp_f32 v214, v214
    v_rcp_f32 v222, v222
    v_mul_f32 v160, v160, v166
    v_mul_f32 v168, v168, v174
    v_mul_f32 v176, v176, v182
    v_mul_f32 v184, v184, v190
    v_mul_f32 v192, v192, v198
    v_mul_f32 v200, v200, v206
    v_mul_f32 v208, v208, v214
    v_mul_f32 v216, v216, v222
    v_mul_f32 v161, v161, v166
    v_mul_f32 v169, v169, v174
    v_mul_f32 v177, v177, v182
    v_mul_f32 v185, v185, v190
    v_mul_f32 v193, v193, v198
    v_mul_f32 v201, v201, v206
    v_mul_f32 v209, v209, v214
    v_mul_f32 v217, v217, v222
    v_mul_f32 v162, v162, v166
    v_mul_f32 v170, v170, v174
    v_mul_f32 v178, v178, v182
    v_mul_f32 v186, v186, v190
    v_mul_f32 v194, v194, v198
    v_mul_f32 v202, v202, v206
    v_mul_f32 v210, v210, v214
    v_mul_f32 v218, v218, v222
    v_mul_f32 v163, v163, v166
    v_mul_f32 v171, v171, v174
    v_mul_f32 v179, v179, v182
    v_mul_f32 v187, v187, v190
    v_mul_f32 v195, v195, v198
    v_mul_f32 v203, v203, v206
    v_mul_f32 v211, v211, v214
    v_mul_f32 v219, v219, v222
    v_mul_f32 v164, v164, v166
    v_mul_f32 v172, v172, v174
    v_mul_f32 v180, v180, v182
    v_mul_f32 v188, v188, v190
    v_mul_f32 v196, v196, v198
    v_mul_f32 v204, v204, v206
    v_mul_f32 v212, v212, v214
    v_mul_f32 v220, v220, v222
    v_mul_f32 v165, v165, v166
    v_mul_f32 v173, v173, v174
    v_mul_f32 v181, v181, v182
    v_mul_f32 v189, v189, v190
    v_mul_f32 v197, v197, v198
    v_mul_f32 v205, v205, v206
    v_mul_f32 v213, v213, v214
    v_mul_f32 v221, v221, v222
    v_cvt_pk_bf16_f32 v160, v160, v161
    v_cvt_pk_bf16_f32 v161, v162, v163
    v_cvt_pk_bf16_f32 v162, v164, v165
    v_cvt_pk_bf16_f32 v168, v168, v169
    v_cvt_pk_bf16_f32 v169, v170, v171
    v_cvt_pk_bf16_f32 v170, v172, v173
    v_cvt_pk_bf16_f32 v176, v176, v177
    v_cvt_pk_bf16_f32 v177, v178, v179
    v_cvt_pk_bf16_f32 v178, v180, v181
    v_cvt_pk_bf16_f32 v184, v184, v185
    v_cvt_pk_bf16_f32 v185, v186, v187
    v_cvt_pk_bf16_f32 v186, v188, v189
    v_cvt_pk_bf16_f32 v192, v192, v193
    v_cvt_pk_bf16_f32 v193, v194, v195
    v_cvt_pk_bf16_f32 v194, v196, v197
    v_cvt_pk_bf16_f32 v200, v200, v201
    v_cvt_pk_bf16_f32 v201, v202, v203
    v_cvt_pk_bf16_f32 v202, v204, v205
    v_cvt_pk_bf16_f32 v208, v208, v209
    v_cvt_pk_bf16_f32 v209, v210, v211
    v_cvt_pk_bf16_f32 v210, v212, v213
    v_cvt_pk_bf16_f32 v216, v216, v217
    v_cvt_pk_bf16_f32 v217, v218, v219
    v_cvt_pk_bf16_f32 v218, v220, v221
    v_add_u32 v22, 37376, v15
    v_add_u32 v23, 56064, v15
    ds_write_b64 v22, v[160:161] offset:0
    ds_write2_b32 v22, v168, v169 offset0:9 offset1:10
    ds_write_b64 v22, v[176:177] offset:72
    ds_write2_b32 v22, v184, v185 offset0:27 offset1:28
    ds_write_b64 v23, v[192:193] offset:0
    ds_write2_b32 v23, v200, v201 offset0:9 offset1:10
    ds_write_b64 v23, v[208:209] offset:72
    ds_write2_b32 v23, v216, v217 offset0:27 offset1:28
    s_mov_b64 exec, s[58:59]
    ds_write_b32 v15, v162 offset:37408
    ds_write_b32 v15, v170 offset:37444
    ds_write_b32 v15, v178 offset:37480
    ds_write_b32 v15, v186 offset:37516
    ds_write_b32 v15, v194 offset:56096
    ds_write_b32 v15, v202 offset:56132
    ds_write_b32 v15, v210 offset:56168
    ds_write_b32 v15, v218 offset:56204
    s_mov_b64 exec, -1
    s_mul_i32 s57, s52, 18688
    v_mul_u32_u24 v14, 1168, v2
    v_lshl_add_u32 v14, v3, 4, v14
    v_add_u32 v14, s57, v14
    v_and_b32 v18, 3, v1
    v_bfe_u32 v19, v1, 2, 2
    v_lshl_add_u32 v19, v3, 3, v19
    v_mul_u32_u24 v19, 144, v19
    v_lshl_add_u32 v19, v18, 3, v19
    s_add_u32 s57, s55, 74752
    v_add_u32 v19, s57, v19
    v_add_u32 v18, 41472, v19
    s_waitcnt vmcnt(4) lgkmcnt(0)
    s_barrier
    ds_read_b128 v[64:67], v14 offset:0
    ds_read_b64_tr_b16 v[68:69], v19 offset:0
    ds_read_b64_tr_b16 v[70:71], v19 offset:576
    ds_read_b64_tr_b16 v[72:73], v19 offset:32
    ds_read_b64_tr_b16 v[74:75], v19 offset:608
    ds_read_b64_tr_b16 v[76:77], v19 offset:64
    ds_read_b64_tr_b16 v[78:79], v19 offset:640
    ds_read_b128 v[80:83], v14 offset:64
    ds_read_b64_tr_b16 v[84:85], v19 offset:4608
    ds_read_b64_tr_b16 v[86:87], v19 offset:5184
    ds_read_b64_tr_b16 v[88:89], v19 offset:4640
    ds_read_b64_tr_b16 v[90:91], v19 offset:5216
    ds_read_b64_tr_b16 v[92:93], v19 offset:4672
    ds_read_b64_tr_b16 v[94:95], v19 offset:5248
    ds_read_b128 v[96:99], v14 offset:128
    ds_read_b64_tr_b16 v[100:101], v19 offset:9216
    ds_read_b64_tr_b16 v[102:103], v19 offset:9792
    ds_read_b64_tr_b16 v[104:105], v19 offset:9248
    ds_read_b64_tr_b16 v[106:107], v19 offset:9824
    ds_read_b64_tr_b16 v[108:109], v19 offset:9280
    ds_read_b64_tr_b16 v[110:111], v19 offset:9856
    s_waitcnt lgkmcnt(14)
    v_mfma_f32_16x16x32_bf16 v[128:131], v[68:71], v[64:67], 0
    v_mfma_f32_16x16x32_bf16 v[132:135], v[72:75], v[64:67], 0
    v_mfma_f32_16x16x32_bf16 v[136:139], v[76:79], v[64:67], 0
    ds_read_b128 v[64:67], v14 offset:192
    ds_read_b64_tr_b16 v[68:69], v19 offset:13824
    ds_read_b64_tr_b16 v[70:71], v19 offset:14400
    ds_read_b64_tr_b16 v[72:73], v19 offset:13856
    ds_read_b64_tr_b16 v[74:75], v19 offset:14432
    ds_read_b64_tr_b16 v[76:77], v19 offset:13888
    ds_read_b64_tr_b16 v[78:79], v19 offset:14464
    s_waitcnt lgkmcnt(14)
    v_mfma_f32_16x16x32_bf16 v[128:131], v[84:87], v[80:83], v[128:131]
    v_mfma_f32_16x16x32_bf16 v[132:135], v[88:91], v[80:83], v[132:135]
    v_mfma_f32_16x16x32_bf16 v[136:139], v[92:95], v[80:83], v[136:139]
    ds_read_b128 v[80:83], v14 offset:256
    ds_read_b64_tr_b16 v[84:85], v19 offset:18432
    ds_read_b64_tr_b16 v[86:87], v19 offset:19008
    ds_read_b64_tr_b16 v[88:89], v19 offset:18464
    ds_read_b64_tr_b16 v[90:91], v19 offset:19040
    ds_read_b64_tr_b16 v[92:93], v19 offset:18496
    ds_read_b64_tr_b16 v[94:95], v19 offset:19072
    s_waitcnt lgkmcnt(14)
    v_mfma_f32_16x16x32_bf16 v[128:131], v[100:103], v[96:99], v[128:131]
    v_mfma_f32_16x16x32_bf16 v[132:135], v[104:107], v[96:99], v[132:135]
    v_mfma_f32_16x16x32_bf16 v[136:139], v[108:111], v[96:99], v[136:139]
    ds_read_b128 v[96:99], v14 offset:320
    ds_read_b64_tr_b16 v[100:101], v19 offset:23040
    ds_read_b64_tr_b16 v[102:103], v19 offset:23616
    ds_read_b64_tr_b16 v[104:105], v19 offset:23072
    ds_read_b64_tr_b16 v[106:107], v19 offset:23648
    ds_read_b64_tr_b16 v[108:109], v19 offset:23104
    ds_read_b64_tr_b16 v[110:111], v19 offset:23680
    s_waitcnt lgkmcnt(14)
    v_mfma_f32_16x16x32_bf16 v[128:131], v[68:71], v[64:67], v[128:131]
    v_mfma_f32_16x16x32_bf16 v[132:135], v[72:75], v[64:67], v[132:135]
    v_mfma_f32_16x16x32_bf16 v[136:139], v[76:79], v[64:67], v[136:139]
    ds_read_b128 v[64:67], v14 offset:384
    ds_read_b64_tr_b16 v[68:69], v19 offset:27648
    ds_read_b64_tr_b16 v[70:71], v19 offset:28224
    ds_read_b64_tr_b16 v[72:73], v19 offset:27680
    ds_read_b64_tr_b16 v[74:75], v19 offset:28256
    ds_read_b64_tr_b16 v[76:77], v19 offset:27712
    ds_read_b64_tr_b16 v[78:79], v19 offset:28288
    s_waitcnt lgkmcnt(14)
    v_mfma_f32_16x16x32_bf16 v[128:131], v[84:87], v[80:83], v[128:131]
    v_mfma_f32_16x16x32_bf16 v[132:135], v[88:91], v[80:83], v[132:135]
    v_mfma_f32_16x16x32_bf16 v[136:139], v[92:95], v[80:83], v[136:139]
    ds_read_b128 v[80:83], v14 offset:448
    ds_read_b64_tr_b16 v[84:85], v19 offset:32256
    ds_read_b64_tr_b16 v[86:87], v19 offset:32832
    ds_read_b64_tr_b16 v[88:89], v19 offset:32288
    ds_read_b64_tr_b16 v[90:91], v19 offset:32864
    ds_read_b64_tr_b16 v[92:93], v19 offset:32320
    ds_read_b64_tr_b16 v[94:95], v19 offset:32896
    s_waitcnt lgkmcnt(14)
    v_mfma_f32_16x16x32_bf16 v[128:131], v[100:103], v[96:99], v[128:131]
    v_mfma_f32_16x16x32_bf16 v[132:135], v[104:107], v[96:99], v[132:135]
    v_mfma_f32_16x16x32_bf16 v[136:139], v[108:111], v[96:99], v[136:139]
    ds_read_b128 v[96:99], v14 offset:512
    ds_read_b64_tr_b16 v[100:101], v19 offset:36864
    ds_read_b64_tr_b16 v[102:103], v19 offset:37440
    ds_read_b64_tr_b16 v[104:105], v19 offset:36896
    ds_read_b64_tr_b16 v[106:107], v19 offset:37472
    ds_read_b64_tr_b16 v[108:109], v19 offset:36928
    ds_read_b64_tr_b16 v[110:111], v19 offset:37504
    s_waitcnt lgkmcnt(14)
    v_mfma_f32_16x16x32_bf16 v[128:131], v[68:71], v[64:67], v[128:131]
    v_mfma_f32_16x16x32_bf16 v[132:135], v[72:75], v[64:67], v[132:135]
    v_mfma_f32_16x16x32_bf16 v[136:139], v[76:79], v[64:67], v[136:139]
    ds_read_b128 v[64:67], v14 offset:576
    ds_read_b64_tr_b16 v[68:69], v18 offset:0
    ds_read_b64_tr_b16 v[70:71], v18 offset:576
    ds_read_b64_tr_b16 v[72:73], v18 offset:32
    ds_read_b64_tr_b16 v[74:75], v18 offset:608
    ds_read_b64_tr_b16 v[76:77], v18 offset:64
    ds_read_b64_tr_b16 v[78:79], v18 offset:640
    s_waitcnt lgkmcnt(14)
    v_mfma_f32_16x16x32_bf16 v[128:131], v[84:87], v[80:83], v[128:131]
    v_mfma_f32_16x16x32_bf16 v[132:135], v[88:91], v[80:83], v[132:135]
    v_mfma_f32_16x16x32_bf16 v[136:139], v[92:95], v[80:83], v[136:139]
    ds_read_b128 v[80:83], v14 offset:640
    ds_read_b64_tr_b16 v[84:85], v18 offset:4608
    ds_read_b64_tr_b16 v[86:87], v18 offset:5184
    ds_read_b64_tr_b16 v[88:89], v18 offset:4640
    ds_read_b64_tr_b16 v[90:91], v18 offset:5216
    ds_read_b64_tr_b16 v[92:93], v18 offset:4672
    ds_read_b64_tr_b16 v[94:95], v18 offset:5248
    s_waitcnt lgkmcnt(14)
    v_mfma_f32_16x16x32_bf16 v[128:131], v[100:103], v[96:99], v[128:131]
    v_mfma_f32_16x16x32_bf16 v[132:135], v[104:107], v[96:99], v[132:135]
    v_mfma_f32_16x16x32_bf16 v[136:139], v[108:111], v[96:99], v[136:139]
    ds_read_b128 v[96:99], v14 offset:704
    ds_read_b64_tr_b16 v[100:101], v18 offset:9216
    ds_read_b64_tr_b16 v[102:103], v18 offset:9792
    ds_read_b64_tr_b16 v[104:105], v18 offset:9248
    ds_read_b64_tr_b16 v[106:107], v18 offset:9824
    ds_read_b64_tr_b16 v[108:109], v18 offset:9280
    ds_read_b64_tr_b16 v[110:111], v18 offset:9856
    s_waitcnt lgkmcnt(14)
    v_mfma_f32_16x16x32_bf16 v[128:131], v[68:71], v[64:67], v[128:131]
    v_mfma_f32_16x16x32_bf16 v[132:135], v[72:75], v[64:67], v[132:135]
    v_mfma_f32_16x16x32_bf16 v[136:139], v[76:79], v[64:67], v[136:139]
    ds_read_b128 v[64:67], v14 offset:768
    ds_read_b64_tr_b16 v[68:69], v18 offset:13824
    ds_read_b64_tr_b16 v[70:71], v18 offset:14400
    ds_read_b64_tr_b16 v[72:73], v18 offset:13856
    ds_read_b64_tr_b16 v[74:75], v18 offset:14432
    ds_read_b64_tr_b16 v[76:77], v18 offset:13888
    ds_read_b64_tr_b16 v[78:79], v18 offset:14464
    s_waitcnt lgkmcnt(14)
    v_mfma_f32_16x16x32_bf16 v[128:131], v[84:87], v[80:83], v[128:131]
    v_mfma_f32_16x16x32_bf16 v[132:135], v[88:91], v[80:83], v[132:135]
    v_mfma_f32_16x16x32_bf16 v[136:139], v[92:95], v[80:83], v[136:139]
    ds_read_b128 v[80:83], v14 offset:832
    ds_read_b64_tr_b16 v[84:85], v18 offset:18432
    ds_read_b64_tr_b16 v[86:87], v18 offset:19008
    ds_read_b64_tr_b16 v[88:89], v18 offset:18464
    ds_read_b64_tr_b16 v[90:91], v18 offset:19040
    ds_read_b64_tr_b16 v[92:93], v18 offset:18496
    ds_read_b64_tr_b16 v[94:95], v18 offset:19072
    s_waitcnt lgkmcnt(14)
    v_mfma_f32_16x16x32_bf16 v[128:131], v[100:103], v[96:99], v[128:131]
    v_mfma_f32_16x16x32_bf16 v[132:135], v[104:107], v[96:99], v[132:135]
    v_mfma_f32_16x16x32_bf16 v[136:139], v[108:111], v[96:99], v[136:139]
    ds_read_b128 v[96:99], v14 offset:896
    ds_read_b64_tr_b16 v[100:101], v18 offset:23040
    ds_read_b64_tr_b16 v[102:103], v18 offset:23616
    ds_read_b64_tr_b16 v[104:105], v18 offset:23072
    ds_read_b64_tr_b16 v[106:107], v18 offset:23648
    ds_read_b64_tr_b16 v[108:109], v18 offset:23104
    ds_read_b64_tr_b16 v[110:111], v18 offset:23680
    s_waitcnt lgkmcnt(14)
    v_mfma_f32_16x16x32_bf16 v[128:131], v[68:71], v[64:67], v[128:131]
    v_mfma_f32_16x16x32_bf16 v[132:135], v[72:75], v[64:67], v[132:135]
    v_mfma_f32_16x16x32_bf16 v[136:139], v[76:79], v[64:67], v[136:139]
    ds_read_b128 v[64:67], v14 offset:960
    ds_read_b64_tr_b16 v[68:69], v18 offset:27648
    ds_read_b64_tr_b16 v[70:71], v18 offset:28224
    ds_read_b64_tr_b16 v[72:73], v18 offset:27680
    ds_read_b64_tr_b16 v[74:75], v18 offset:28256
    ds_read_b64_tr_b16 v[76:77], v18 offset:27712
    ds_read_b64_tr_b16 v[78:79], v18 offset:28288
    s_waitcnt lgkmcnt(14)
    v_mfma_f32_16x16x32_bf16 v[128:131], v[84:87], v[80:83], v[128:131]
    v_mfma_f32_16x16x32_bf16 v[132:135], v[88:91], v[80:83], v[132:135]
    v_mfma_f32_16x16x32_bf16 v[136:139], v[92:95], v[80:83], v[136:139]
    ds_read_b128 v[80:83], v14 offset:1024
    ds_read_b64_tr_b16 v[84:85], v18 offset:32256
    ds_read_b64_tr_b16 v[86:87], v18 offset:32832
    ds_read_b64_tr_b16 v[88:89], v18 offset:32288
    ds_read_b64_tr_b16 v[90:91], v18 offset:32864
    ds_read_b64_tr_b16 v[92:93], v18 offset:32320
    ds_read_b64_tr_b16 v[94:95], v18 offset:32896
    s_waitcnt lgkmcnt(14)
    v_mfma_f32_16x16x32_bf16 v[128:131], v[100:103], v[96:99], v[128:131]
    v_mfma_f32_16x16x32_bf16 v[132:135], v[104:107], v[96:99], v[132:135]
    v_mfma_f32_16x16x32_bf16 v[136:139], v[108:111], v[96:99], v[136:139]
    ds_read_b128 v[96:99], v14 offset:1088
    ds_read_b64_tr_b16 v[100:101], v18 offset:36864
    ds_read_b64_tr_b16 v[102:103], v18 offset:37440
    ds_read_b64_tr_b16 v[104:105], v18 offset:36896
    ds_read_b64_tr_b16 v[106:107], v18 offset:37472
    ds_read_b64_tr_b16 v[108:109], v18 offset:36928
    ds_read_b64_tr_b16 v[110:111], v18 offset:37504
    s_waitcnt lgkmcnt(14)
    v_mfma_f32_16x16x32_bf16 v[128:131], v[68:71], v[64:67], v[128:131]
    v_mfma_f32_16x16x32_bf16 v[132:135], v[72:75], v[64:67], v[132:135]
    v_mfma_f32_16x16x32_bf16 v[136:139], v[76:79], v[64:67], v[136:139]
    s_waitcnt lgkmcnt(7)
    v_mfma_f32_16x16x32_bf16 v[128:131], v[84:87], v[80:83], v[128:131]
    v_mfma_f32_16x16x32_bf16 v[132:135], v[88:91], v[80:83], v[132:135]
    v_mfma_f32_16x16x32_bf16 v[136:139], v[92:95], v[80:83], v[136:139]
    s_waitcnt lgkmcnt(0)
    v_mfma_f32_16x16x32_bf16 v[128:131], v[100:103], v[96:99], v[128:131]
    v_mfma_f32_16x16x32_bf16 v[132:135], v[104:107], v[96:99], v[132:135]
    v_mfma_f32_16x16x32_bf16 v[136:139], v[108:111], v[96:99], v[136:139]
    v_lshrrev_b32 v20, 4, v12
    v_mul_u32_u24 v20, 18432, v20
    v_lshl_add_u32 v20, v2, 4, v20
    s_mul_i32 s57, s25, 72
    s_mul_i32 s56, s53, 48
    s_add_u32 s57, s57, s56
    v_lshl_add_u32 v21, v3, 2, s57
    v_bfe_u32 v22, v21, 2, 2
    v_lshl_add_u32 v20, v22, 8, v20
    v_lshrrev_b32 v21, 4, v21
    v_add_u32 v22, 0, v21
    v_lshrrev_b32 v39, 1, v22
    v_lshl_add_u32 v51, v39, 10, v20
    v_and_b32 v22, 1, v22
    v_lshl_add_u32 v51, v22, 3, v51
    v_add_u32 v22, 1, v21
    v_lshrrev_b32 v39, 1, v22
    v_lshl_add_u32 v52, v39, 10, v20
    v_and_b32 v22, 1, v22
    v_lshl_add_u32 v52, v22, 3, v52
    v_add_u32 v22, 2, v21
    v_lshrrev_b32 v39, 1, v22
    v_lshl_add_u32 v53, v39, 10, v20
    v_and_b32 v22, 1, v22
    v_lshl_add_u32 v53, v22, 3, v53
    v_lshl_add_u32 v23, v3, 2, s56
    v_mov_b32 v30, 0
    v_mov_b32 v31, 0
    v_mov_b32 v28, 0x3f803f80
    s_waitcnt vmcnt(1)
    v_lshlrev_b32 v24, 16, v40
    v_and_b32 v25, 0xffff0000, v40
    v_lshlrev_b32 v26, 16, v41
    v_and_b32 v27, 0xffff0000, v41
    v_cmp_gt_u32 vcc, 72, v23
    v_add_f32 v128, v128, v24
    v_add_f32 v129, v129, v25
    v_add_f32 v130, v130, v26
    v_add_f32 v131, v131, v27
    v_cvt_pk_bf16_f32 v128, v128, v129
    v_cvt_pk_bf16_f32 v129, v130, v131
    v_cndmask_b32 v32, v6, v51, vcc
    buffer_store_dwordx2 v[128:129], v32, s[36:39], 0 offen
    v_cndmask_b32 v130, 0, v128, vcc
    v_cndmask_b32 v131, 0, v129, vcc
    v_dot2_f32_bf16 v30, v130, v28, v30
    v_dot2_f32_bf16 v31, v130, v130, v31
    v_dot2_f32_bf16 v30, v131, v28, v30
    v_dot2_f32_bf16 v31, v131, v131, v31
    v_lshlrev_b32 v24, 16, v42
    v_and_b32 v25, 0xffff0000, v42
    v_lshlrev_b32 v26, 16, v43
    v_and_b32 v27, 0xffff0000, v43
    v_cmp_gt_u32 vcc, 56, v23
    v_add_f32 v132, v132, v24
    v_add_f32 v133, v133, v25
    v_add_f32 v134, v134, v26
    v_add_f32 v135, v135, v27
    v_cvt_pk_bf16_f32 v132, v132, v133
    v_cvt_pk_bf16_f32 v133, v134, v135
    v_cndmask_b32 v33, v6, v52, vcc
    buffer_store_dwordx2 v[132:133], v33, s[36:39], 0 offen
    v_cndmask_b32 v134, 0, v132, vcc
    v_cndmask_b32 v135, 0, v133, vcc
    v_dot2_f32_bf16 v30, v134, v28, v30
    v_dot2_f32_bf16 v31, v134, v134, v31
    v_dot2_f32_bf16 v30, v135, v28, v30
    v_dot2_f32_bf16 v31, v135, v135, v31
    v_lshlrev_b32 v24, 16, v44
    v_and_b32 v25, 0xffff0000, v44
    v_lshlrev_b32 v26, 16, v45
    v_and_b32 v27, 0xffff0000, v45
    v_cmp_gt_u32 vcc, 40, v23
    v_add_f32 v136, v136, v24
    v_add_f32 v137, v137, v25
    v_add_f32 v138, v138, v26
    v_add_f32 v139, v139, v27
    v_cvt_pk_bf16_f32 v136, v136, v137
    v_cvt_pk_bf16_f32 v137, v138, v139
    v_cndmask_b32 v34, v6, v53, vcc
    buffer_store_dwordx2 v[136:137], v34, s[36:39], 0 offen
    v_cndmask_b32 v138, 0, v136, vcc
    v_cndmask_b32 v139, 0, v137, vcc
    v_dot2_f32_bf16 v30, v138, v28, v30
    v_dot2_f32_bf16 v31, v138, v138, v31
    v_dot2_f32_bf16 v30, v139, v28, v30
    v_dot2_f32_bf16 v31, v139, v139, v31
    s_nop 1
    v_mov_b32 v36, v30
    v_mov_b32 v37, v31
    s_nop 0
    v_permlane16_swap_b32 v30, v36
    v_permlane16_swap_b32 v31, v37
    v_add_f32 v30, v30, v36
    v_add_f32 v31, v31, v37
    v_mov_b32 v36, v30
    v_mov_b32 v37, v31
    s_nop 0
    v_permlane32_swap_b32 v30, v36
    v_permlane32_swap_b32 v31, v37
    v_add_f32 v30, v30, v36
    v_add_f32 v31, v31, v37
    v_lshrrev_b32 v38, 4, v12
    v_lshlrev_b32 v38, 11, v38
    v_lshl_add_u32 v38, v2, 4, v38
    s_and_b32 s54, s25, 1
    s_lshl_b32 s54, s54, 10
    s_lshr_b32 s56, s25, 1
    s_lshl_b32 s56, s56, 8
    s_add_u32 s54, s54, s56
    s_lshl_b32 s56, s53, 3
    s_add_u32 s54, s54, s56
    v_add_u32 v38, s54, v38
    v_cndmask_b32 v38, v6, v38, s[58:59]
    buffer_store_dwordx2 v[30:31], v38, s[40:43], 0 offen
L_k2_done:
    s_endpgm
.section .rodata,"a"
.p2align 6
.amdhsa_kernel attn_kernel
  .amdhsa_next_free_vgpr 224
  .amdhsa_next_free_sgpr 102
  .amdhsa_accum_offset 224
  .amdhsa_group_segment_fixed_size 0
  .amdhsa_kernarg_size 80
  .amdhsa_user_sgpr_count 2
  .amdhsa_user_sgpr_kernarg_segment_ptr 1
  .amdhsa_system_sgpr_workgroup_id_x 1
.end_amdhsa_kernel
.text
.globl ffn_kernel
.p2align 8
.type ffn_kernel,@function
ffn_kernel:

    s_cmp_ge_u32 s2, 256
    s_cbranch_scc1 L_k3_done
    s_load_dwordx4 s[4:7], s[0:1], 32
    s_load_dwordx2 s[28:29], s[0:1], 48
    s_load_dwordx2 s[30:31], s[0:1], 72
    v_lshrrev_b32 v1, 6, v0
    s_nop 0
    v_readfirstlane_b32 s3, v1
    v_and_b32 v1, 63, v0
    s_and_b32 s24, s2, 7
    s_lshl_b32 s24, s24, 1
    s_bfe_u32 s25, s2, 0x10003
    s_add_u32 s24, s24, s25
    s_lshr_b32 s25, s2, 4
    s_mov_b32 s34, -1
    s_mov_b32 s35, 0
    s_and_b32 s36, s3, 1
    s_lshr_b32 s37, s3, 1
    s_mul_i32 s26, s3, 4608
    s_mul_i32 s38, s36, 147456
    s_mul_i32 s39, s24, 576
    s_add_u32 s38, s38, s39
    s_mul_i32 s39, s36, 18432
    s_mul_i32 s40, s24, 331776
    s_add_u32 s39, s39, s40
    s_mul_i32 s40, s37, 288
    s_add_u32 s39, s39, s40
    s_movk_i32 s41, 9216
    s_movk_i32 s42, 1152
    s_lshl_b32 s43, s25, 2
    s_add_u32 s43, s43, s3
    s_mul_i32 s44, s43, 36864
    v_lshlrev_b32 v18, 4, v1
    v_add_u32 v18, s44, v18
    v_add_u32 v19, 18432, v18
    s_lshl_b32 s45, s43, 12
    v_lshl_add_u32 v22, v1, 4, s45
    v_add_u32 v24, 0, v1
    v_mul_u32_u24 v25, 3641, v24
    v_lshrrev_b32 v25, 16, v25
    v_mul_u32_u24 v26, 18, v25
    v_sub_u32 v26, v24, v26
    v_lshlrev_b32 v26, 4, v26
    v_mad_u32_u24 v2, v25, s41, v26
    v_add_u32 v2, s38, v2
    v_mad_u32_u24 v7, v25, s42, v26
    v_add_u32 v7, s39, v7
    v_add_u32 v24, 64, v1
    v_mul_u32_u24 v25, 3641, v24
    v_lshrrev_b32 v25, 16, v25
    v_mul_u32_u24 v26, 18, v25
    v_sub_u32 v26, v24, v26
    v_lshlrev_b32 v26, 4, v26
    v_subrev_u32 v26, 1024, v26
    v_mad_u32_u24 v3, v25, s41, v26
    v_add_u32 v3, s38, v3
    v_mad_u32_u24 v8, v25, s42, v26
    v_add_u32 v8, s39, v8
    v_add_u32 v24, 128, v1
    v_mul_u32_u24 v25, 3641, v24
    v_lshrrev_b32 v25, 16, v25
    v_mul_u32_u24 v26, 18, v25
    v_sub_u32 v26, v24, v26
    v_lshlrev_b32 v26, 4, v26
    v_subrev_u32 v26, 2048, v26
    v_mad_u32_u24 v4, v25, s41, v26
    v_add_u32 v4, s38, v4
    v_mad_u32_u24 v9, v25, s42, v26
    v_add_u32 v9, s39, v9
    v_add_u32 v24, 192, v1
    v_mul_u32_u24 v25, 3641, v24
    v_lshrrev_b32 v25, 16, v25
    v_mul_u32_u24 v26, 18, v25
    v_sub_u32 v26, v24, v26
    v_lshlrev_b32 v26, 4, v26
    v_subrev_u32 v26, 3072, v26
    v_mad_u32_u24 v5, v25, s41, v26
    v_add_u32 v5, s38, v5
    v_mad_u32_u24 v10, v25, s42, v26
    v_add_u32 v10, s39, v10
    v_add_u32 v24, 256, v1
    v_mul_u32_u24 v25, 3641, v24
    v_lshrrev_b32 v25, 16, v25
    v_mul_u32_u24 v26, 18, v25
    v_sub_u32 v26, v24, v26
    v_lshlrev_b32 v26, 4, v26
    v_subrev_u32 v26, 3072, v26
    v_mad_u32_u24 v6, v25, s41, v26
    v_add_u32 v6, s38, v6
    v_mad_u32_u24 v11, v25, s42, v26
    v_add_u32 v11, s39, v11
    v_cmp_gt_u32 vcc, 32, v1
    v_mov_b32 v24, 2146435072
    s_nop 0
    v_cndmask_b32 v6, v24, v6, vcc
    v_cndmask_b32 v11, v24, v11, vcc
    s_waitcnt lgkmcnt(0)
    s_cmp_eq_u32 s37, 0
    s_cselect_b32 s8, s4, s6
    s_cselect_b32 s9, s5, s7
    s_and_b32 s9, s9, 0xffff
    s_mov_b32 s10, 5308416
    s_mov_b32 s11, 0x00020000
    s_add_u32 s48, s30, 42663936
    s_addc_u32 s49, s31, 0
    s_and_b32 s49, s49, 0xffff
    s_mov_b32 s50, 262144
    s_mov_b32 s51, 0x00020000
    s_add_u32 s16, s30, 2555904
    s_addc_u32 s17, s31, 0
    s_and_b32 s17, s17, 0xffff
    s_mov_b32 s18, 2359296
    s_mov_b32 s19, 0x00020000
    buffer_load_dwordx4 v[64:67], v22, s[48:51], 0 offen offset:0
    buffer_load_dwordx4 v[68:71], v22, s[48:51], 0 offen offset:1024
    buffer_load_dwordx4 v[72:75], v22, s[48:51], 0 offen offset:2048
    buffer_load_dwordx4 v[76:79], v22, s[48:51], 0 offen offset:3072
    s_mov_b32 s32, 0
    s_mov_b32 s47, 0
    s_mov_b32 s52, s26
    s_lshl_b32 s53, s26, 1
    s_add_u32 s53, s53, 73984
    s_mov_b32 s54, 73984
    s_mov_b32 s46, 0xffff0000
    buffer_load_dwordx4 v[32:35], v18, s[16:19], s47 offen
    buffer_load_dwordx4 v[36:39], v19, s[16:19], s47 offen
    s_add_u32 s47, s47, 0x400
    s_add_u32 m0, s52, 0
    s_nop 0
    buffer_load_dwordx4 v2, s[8:11], s32 offen offset:0 lds
    buffer_load_dwordx4 v3, s[8:11], s32 offen offset:1024 lds
    buffer_load_dwordx4 v4, s[8:11], s32 offen offset:2048 lds
    buffer_load_dwordx4 v5, s[8:11], s32 offen offset:3072 lds
    s_add_u32 m0, m0, 0x400
    s_mov_b64 exec, s[34:35]
    buffer_load_dwordx4 v6, s[8:11], s32 offen offset:3072 lds
    s_mov_b64 exec, -1
    s_add_u32 s32, s32, 288
    s_mov_b32 s12, s28
    s_and_b32 s13, s29, 0xffff
    s_mov_b32 s14, 5308416
    s_mov_b32 s15, 0x00020000
    s_mul_i32 s45, s24, 2359296
    s_add_u32 s45, s45, 4915200
    s_add_u32 s20, s30, s45
    s_addc_u32 s21, s31, 0
    s_and_b32 s21, s21, 0xffff
    s_mov_b32 s22, 2359296
    s_mov_b32 s23, 0x00020000
    s_add_u32 m0, s52, 18496
    s_nop 0
    buffer_load_dwordx4 v2, s[8:11], s32 offen offset:0 lds
    buffer_load_dwordx4 v3, s[8:11], s32 offen offset:1024 lds
    buffer_load_dwordx4 v4, s[8:11], s32 offen offset:2048 lds
    buffer_load_dwordx4 v5, s[8:11], s32 offen offset:3072 lds
    s_add_u32 m0, m0, 0x400
    s_mov_b64 exec, s[34:35]
    buffer_load_dwordx4 v6, s[8:11], s32 offen offset:3072 lds
    s_mov_b64 exec, -1
    s_add_u32 s32, s32, 294624
    buffer_load_dwordx4 v[40:43], v18, s[16:19], s47 offen
    buffer_load_dwordx4 v[44:47], v19, s[16:19], s47 offen
    s_add_u32 s47, s47, 0x400
    s_add_u32 m0, s52, 36992
    s_nop 0
    buffer_load_dwordx4 v2, s[8:11], s32 offen offset:0 lds
    buffer_load_dwordx4 v3, s[8:11], s32 offen offset:1024 lds
    buffer_load_dwordx4 v4, s[8:11], s32 offen offset:2048 lds
    buffer_load_dwordx4 v5, s[8:11], s32 offen offset:3072 lds
    s_add_u32 m0, m0, 0x400
    s_mov_b64 exec, s[34:35]
    buffer_load_dwordx4 v6, s[8:11], s32 offen offset:3072 lds
    s_mov_b64 exec, -1
    s_add_u32 s32, s32, 288
    v_and_b32 v24, 3, v1
    v_lshrrev_b32 v25, 2, v1
    v_mul_u32_u24 v25, 288, v25
    v_lshl_add_u32 v12, v24, 3, v25
    v_add_u32 v13, 36992, v12
    s_waitcnt vmcnt(19)
    v_add_f32 v64, v64, v66
    v_add_f32 v65, v65, v67
    v_add_f32 v68, v68, v70
    v_add_f32 v69, v69, v71
    v_add_f32 v64, v64, v68
    v_add_f32 v65, v65, v69
    v_add_f32 v72, v72, v74
    v_add_f32 v73, v73, v75
    v_add_f32 v76, v76, v78
    v_add_f32 v77, v77, v79
    v_add_f32 v72, v72, v76
    v_add_f32 v73, v73, v77
    v_mov_b32 v66, v64
    v_mov_b32 v67, v65
    v_mov_b32 v74, v72
    v_mov_b32 v75, v73
    v_permlane16_swap_b32 v64, v66
    v_permlane16_swap_b32 v65, v67
    v_permlane16_swap_b32 v72, v74
    v_permlane16_swap_b32 v73, v75
    v_add_f32 v64, v64, v66
    v_add_f32 v65, v65, v67
    v_add_f32 v72, v72, v74
    v_add_f32 v73, v73, v75
    v_mov_b32 v66, v64
    v_mov_b32 v67, v65
    v_mov_b32 v74, v72
    v_mov_b32 v75, v73
    v_permlane32_swap_b32 v64, v66
    v_permlane32_swap_b32 v65, v67
    v_permlane32_swap_b32 v72, v74
    v_permlane32_swap_b32 v73, v75
    v_add_f32 v64, v64, v66
    v_add_f32 v65, v65, v67
    v_add_f32 v72, v72, v74
    v_add_f32 v73, v73, v75
    v_mul_f32 v64, 0x3ae38e39, v64
    v_mul_f32 v65, 0x3ae38e39, v65
    v_fma_f32 v65, -v64, v64, v65
    v_max_f32 v65, 0, v65
    v_add_f32 v65, 0x3727c5ac, v65
    v_rsq_f32 v20, v65
    s_nop 0
    v_mul_f32 v20, 0xbfb8aa3b, v20
    v_mul_f32 v22, v64, v20
    v_sub_f32 v22, 0, v22
    v_mov_b32 v21, v20
    v_mov_b32 v23, v22
    v_mul_f32 v72, 0x3ae38e39, v72
    v_mul_f32 v73, 0x3ae38e39, v73
    v_fma_f32 v73, -v72, v72, v73
    v_max_f32 v73, 0, v73
    v_add_f32 v73, 0x3727c5ac, v73
    v_rsq_f32 v14, v73
    s_nop 0
    v_mul_f32 v14, 0xbfb8aa3b, v14
    v_mul_f32 v16, v72, v14
    v_sub_f32 v16, 0, v16
    v_mov_b32 v15, v14
    v_mov_b32 v17, v16
    s_waitcnt vmcnt(17)
    v_lshlrev_b32 v24, 16, v32
    v_and_b32 v25, s46, v32
    v_fma_f32 v24, v24, v20, v22
    v_fma_f32 v25, v25, v20, v22
    v_cvt_pk_bf16_f32 v48, v24, v25
    v_lshlrev_b32 v26, 16, v33
    v_and_b32 v27, s46, v33
    v_fma_f32 v26, v26, v20, v22
    v_fma_f32 v27, v27, v20, v22
    v_cvt_pk_bf16_f32 v49, v26, v27
    v_lshlrev_b32 v24, 16, v34
    v_and_b32 v25, s46, v34
    v_fma_f32 v24, v24, v20, v22
    v_fma_f32 v25, v25, v20, v22
    v_cvt_pk_bf16_f32 v50, v24, v25
    v_lshlrev_b32 v26, 16, v35
    v_and_b32 v27, s46, v35
    v_fma_f32 v26, v26, v20, v22
    v_fma_f32 v27, v27, v20, v22
    v_cvt_pk_bf16_f32 v51, v26, v27
    v_lshlrev_b32 v24, 16, v36
    v_and_b32 v25, s46, v36
    v_fma_f32 v24, v24, v14, v16
    v_fma_f32 v25, v25, v14, v16
    v_cvt_pk_bf16_f32 v52, v24, v25
    v_lshlrev_b32 v26, 16, v37
    v_and_b32 v27, s46, v37
    v_fma_f32 v26, v26, v14, v16
    v_fma_f32 v27, v27, v14, v16
    v_cvt_pk_bf16_f32 v53, v26, v27
    v_lshlrev_b32 v24, 16, v38
    v_and_b32 v25, s46, v38
    v_fma_f32 v24, v24, v14, v16
    v_fma_f32 v25, v25, v14, v16
    v_cvt_pk_bf16_f32 v54, v24, v25
    v_lshlrev_b32 v26, 16, v39
    v_and_b32 v27, s46, v39
    v_fma_f32 v26, v26, v14, v16
    v_fma_f32 v27, v27, v14, v16
    v_cvt_pk_bf16_f32 v55, v26, v27
    s_waitcnt vmcnt(12)
    s_barrier
    ds_read_b64_tr_b16 a[224:225], v12 offset:0
    ds_read_b64_tr_b16 a[226:227], v12 offset:4608
    ds_read_b64_tr_b16 a[228:229], v12 offset:9216
    ds_read_b64_tr_b16 a[230:231], v12 offset:13824
    ds_read_b64_tr_b16 a[232:233], v12 offset:32
    ds_read_b64_tr_b16 a[234:235], v12 offset:4640
    ds_read_b64_tr_b16 a[236:237], v12 offset:9248
    ds_read_b64_tr_b16 a[238:239], v12 offset:13856
    ds_read_b64_tr_b16 a[240:241], v12 offset:64
    ds_read_b64_tr_b16 a[242:243], v12 offset:4672
    ds_read_b64_tr_b16 a[244:245], v12 offset:9280
    ds_read_b64_tr_b16 a[246:247], v12 offset:13888
    ds_read_b64_tr_b16 a[248:249], v12 offset:96
    s_waitcnt lgkmcnt(9)
    v_mfma_f32_16x16x32_bf16 v[64:67], a[224:227], v[48:51], 0
    ds_read_b64_tr_b16 a[250:251], v12 offset:4704
    s_add_u32 m0, s52, 55488
    s_nop 0
    buffer_load_dwordx4 v2, s[8:11], s32 offen offset:0 lds
    v_mfma_f32_16x16x32_bf16 v[72:75], a[224:227], v[52:55], 0
    ds_read_b64_tr_b16 a[252:253], v12 offset:9312
    v_mfma_f32_16x16x32_bf16 v[68:71], a[228:231], v[48:51], 0
    ds_read_b64_tr_b16 a[254:255], v12 offset:13920
    buffer_load_dwordx4 v3, s[8:11], s32 offen offset:1024 lds
    buffer_load_dwordx4 v[32:35], v18, s[16:19], s47 offen
    v_mfma_f32_16x16x32_bf16 v[76:79], a[228:231], v[52:55], 0
    ds_read_b64_tr_b16 a[224:225], v12 offset:128
    s_waitcnt lgkmcnt(9)
    v_mfma_f32_16x16x32_bf16 v[80:83], a[232:235], v[48:51], 0
    ds_read_b64_tr_b16 a[226:227], v12 offset:4736
    buffer_load_dwordx4 v4, s[8:11], s32 offen offset:2048 lds
    buffer_load_dwordx4 v[36:39], v19, s[16:19], s47 offen
    v_mfma_f32_16x16x32_bf16 v[88:91], a[232:235], v[52:55], 0
    ds_read_b64_tr_b16 a[228:229], v12 offset:9344
    v_mfma_f32_16x16x32_bf16 v[84:87], a[236:239], v[48:51], 0
    ds_read_b64_tr_b16 a[230:231], v12 offset:13952
    buffer_load_dwordx4 v5, s[8:11], s32 offen offset:3072 lds
    s_add_u32 s47, s47, 0x400
    v_mfma_f32_16x16x32_bf16 v[92:95], a[236:239], v[52:55], 0
    ds_read_b64_tr_b16 a[232:233], v12 offset:160
    s_waitcnt lgkmcnt(9)
    v_mfma_f32_16x16x32_bf16 v[96:99], a[240:243], v[48:51], 0
    ds_read_b64_tr_b16 a[234:235], v12 offset:4768
    s_add_u32 m0, m0, 0x400
    s_mov_b64 exec, s[34:35]
    buffer_load_dwordx4 v6, s[8:11], s32 offen offset:3072 lds
    s_mov_b64 exec, -1
    v_mfma_f32_16x16x32_bf16 v[104:107], a[240:243], v[52:55], 0
    ds_read_b64_tr_b16 a[236:237], v12 offset:9376
    v_mfma_f32_16x16x32_bf16 v[100:103], a[244:247], v[48:51], 0
    ds_read_b64_tr_b16 a[238:239], v12 offset:13984
    s_add_u32 s32, s32, 294624
    s_sub_u32 s52, s53, s52
    s_add_u32 m0, s52, 0
    s_nop 0
    buffer_load_dwordx4 v2, s[8:11], s32 offen offset:0 lds
    v_mfma_f32_16x16x32_bf16 v[108:111], a[244:247], v[52:55], 0
    ds_read_b64_tr_b16 a[240:241], v12 offset:192
    s_waitcnt lgkmcnt(9)
    v_mfma_f32_16x16x32_bf16 v[112:115], a[248:251], v[48:51], 0
    ds_read_b64_tr_b16 a[242:243], v12 offset:4800
    buffer_load_dwordx4 v3, s[8:11], s32 offen offset:1024 lds
    s_waitcnt vmcnt(14)
    v_mfma_f32_16x16x32_bf16 v[120:123], a[248:251], v[52:55], 0
    ds_read_b64_tr_b16 a[244:245], v12 offset:9408
    v_mfma_f32_16x16x32_bf16 v[116:119], a[252:255], v[48:51], 0
    ds_read_b64_tr_b16 a[246:247], v12 offset:14016
    buffer_load_dwordx4 v4, s[8:11], s32 offen offset:2048 lds
    v_lshlrev_b32 v24, 16, v40
    v_mfma_f32_16x16x32_bf16 v[124:127], a[252:255], v[52:55], 0
    ds_read_b64_tr_b16 a[248:249], v12 offset:224
    s_waitcnt lgkmcnt(9)
    v_mfma_f32_16x16x32_bf16 v[128:131], a[224:227], v[48:51], 0
    ds_read_b64_tr_b16 a[250:251], v12 offset:4832
    buffer_load_dwordx4 v5, s[8:11], s32 offen offset:3072 lds
    v_and_b32 v25, s46, v40
    v_mfma_f32_16x16x32_bf16 v[136:139], a[224:227], v[52:55], 0
    ds_read_b64_tr_b16 a[252:253], v12 offset:9440
    v_mfma_f32_16x16x32_bf16 v[132:135], a[228:231], v[48:51], 0
    ds_read_b64_tr_b16 a[254:255], v12 offset:14048
    s_add_u32 m0, m0, 0x400
    s_mov_b64 exec, s[34:35]
    buffer_load_dwordx4 v6, s[8:11], s32 offen offset:3072 lds
    s_mov_b64 exec, -1
    v_mfma_f32_16x16x32_bf16 v[140:143], a[228:231], v[52:55], 0
    ds_read_b64_tr_b16 a[224:225], v12 offset:256
    s_waitcnt lgkmcnt(9)
    v_mfma_f32_16x16x32_bf16 v[144:147], a[232:235], v[48:51], 0
    ds_read_b64_tr_b16 a[226:227], v12 offset:4864
    s_add_u32 s32, s32, 288
    s_add_u32 m0, s52, 18496
    s_nop 0
    buffer_load_dwordx4 v2, s[8:11], s32 offen offset:0 lds
    v_mfma_f32_16x16x32_bf16 v[152:155], a[232:235], v[52:55], 0
    ds_read_b64_tr_b16 a[228:229], v12 offset:9472
    v_mfma_f32_16x16x32_bf16 v[148:151], a[236:239], v[48:51], 0
    ds_read_b64_tr_b16 a[230:231], v12 offset:14080
    buffer_load_dwordx4 v3, s[8:11], s32 offen offset:1024 lds
    v_fma_f32 v24, v24, v20, v22
    v_mfma_f32_16x16x32_bf16 v[156:159], a[236:239], v[52:55], 0
    s_barrier
    ds_read_b64_tr_b16 a[232:233], v12 offset:18496
    s_waitcnt lgkmcnt(9)
    v_mfma_f32_16x16x32_bf16 v[160:163], a[240:243], v[48:51], 0
    ds_read_b64_tr_b16 a[234:235], v12 offset:23104
    buffer_load_dwordx4 v4, s[8:11], s32 offen offset:2048 lds
    v_fma_f32 v25, v25, v20, v22
    v_mfma_f32_16x16x32_bf16 v[168:171], a[240:243], v[52:55], 0
    ds_read_b64_tr_b16 a[236:237], v12 offset:27712
    v_mfma_f32_16x16x32_bf16 v[164:167], a[244:247], v[48:51], 0
    ds_read_b64_tr_b16 a[238:239], v12 offset:32320
    buffer_load_dwordx4 v5, s[8:11], s32 offen offset:3072 lds
    v_cvt_pk_bf16_f32 v56, v24, v25
    v_mfma_f32_16x16x32_bf16 v[172:175], a[244:247], v[52:55], 0
    ds_read_b64_tr_b16 a[240:241], v12 offset:18528
    s_waitcnt lgkmcnt(9)
    v_mfma_f32_16x16x32_bf16 v[176:179], a[248:251], v[48:51], 0
    ds_read_b64_tr_b16 a[242:243], v12 offset:23136
    s_add_u32 m0, m0, 0x400
    s_mov_b64 exec, s[34:35]
    buffer_load_dwordx4 v6, s[8:11], s32 offen offset:3072 lds
    s_mov_b64 exec, -1
    v_mfma_f32_16x16x32_bf16 v[184:187], a[248:251], v[52:55], 0
    ds_read_b64_tr_b16 a[244:245], v12 offset:27744
    v_mfma_f32_16x16x32_bf16 v[180:183], a[252:255], v[48:51], 0
    ds_read_b64_tr_b16 a[246:247], v12 offset:32352
    s_add_u32 s32, s32, 294624
    s_add_u32 m0, s52, 36992
    s_nop 0
    buffer_load_dwordx4 v2, s[8:11], s32 offen offset:0 lds
    v_mfma_f32_16x16x32_bf16 v[188:191], a[252:255], v[52:55], 0
    ds_read_b64_tr_b16 a[248:249], v12 offset:18560
    s_waitcnt lgkmcnt(9)
    v_mfma_f32_16x16x32_bf16 v[192:195], a[224:227], v[48:51], 0
    ds_read_b64_tr_b16 a[250:251], v12 offset:23168
    buffer_load_dwordx4 v3, s[8:11], s32 offen offset:1024 lds
    v_lshlrev_b32 v26, 16, v41
    v_mfma_f32_16x16x32_bf16 v[200:203], a[224:227], v[52:55], 0
    ds_read_b64_tr_b16 a[252:253], v12 offset:27776
    v_mfma_f32_16x16x32_bf16 v[196:199], a[228:231], v[48:51], 0
    ds_read_b64_tr_b16 a[254:255], v12 offset:32384
    buffer_load_dwordx4 v4, s[8:11], s32 offen offset:2048 lds
    v_and_b32 v27, s46, v41
    v_mfma_f32_16x16x32_bf16 v[204:207], a[228:231], v[52:55], 0
    ds_read_b64_tr_b16 a[224:225], v12 offset:18592
    s_waitcnt lgkmcnt(9)
    v_mfma_f32_16x16x32_bf16 v[208:211], a[232:235], v[48:51], 0
    ds_read_b64_tr_b16 a[226:227], v12 offset:23200
    buffer_load_dwordx4 v5, s[8:11], s32 offen offset:3072 lds
    v_fma_f32 v26, v26, v20, v22
    v_mfma_f32_16x16x32_bf16 v[216:219], a[232:235], v[52:55], 0
    ds_read_b64_tr_b16 a[228:229], v12 offset:27808
    v_mfma_f32_16x16x32_bf16 v[212:215], a[236:239], v[48:51], 0
    ds_read_b64_tr_b16 a[230:231], v12 offset:32416
    s_add_u32 m0, m0, 0x400
    s_mov_b64 exec, s[34:35]
    buffer_load_dwordx4 v6, s[8:11], s32 offen offset:3072 lds
    s_mov_b64 exec, -1
    v_mfma_f32_16x16x32_bf16 v[220:223], a[236:239], v[52:55], 0
    ds_read_b64_tr_b16 a[232:233], v12 offset:18624
    s_waitcnt lgkmcnt(9)
    v_mfma_f32_16x16x32_bf16 v[224:227], a[240:243], v[48:51], 0
    ds_read_b64_tr_b16 a[234:235], v12 offset:23232
    s_add_u32 s32, s32, 288
    s_add_u32 m0, s52, 55488
    s_nop 0
    buffer_load_dwordx4 v2, s[8:11], s32 offen offset:0 lds
    v_mfma_f32_16x16x32_bf16 v[232:235], a[240:243], v[52:55], 0
    ds_read_b64_tr_b16 a[236:237], v12 offset:27840
    v_mfma_f32_16x16x32_bf16 v[228:231], a[244:247], v[48:51], 0
    ds_read_b64_tr_b16 a[238:239], v12 offset:32448
    buffer_load_dwordx4 v3, s[8:11], s32 offen offset:1024 lds
    v_fma_f32 v27, v27, v20, v22
    v_mfma_f32_16x16x32_bf16 v[236:239], a[244:247], v[52:55], 0
    ds_read_b64_tr_b16 a[240:241], v12 offset:18656
    s_waitcnt lgkmcnt(9)
    v_mfma_f32_16x16x32_bf16 v[240:243], a[248:251], v[48:51], 0
    ds_read_b64_tr_b16 a[242:243], v12 offset:23264
    buffer_load_dwordx4 v4, s[8:11], s32 offen offset:2048 lds
    v_cvt_pk_bf16_f32 v57, v26, v27
    v_mfma_f32_16x16x32_bf16 v[248:251], a[248:251], v[52:55], 0
    ds_read_b64_tr_b16 a[244:245], v12 offset:27872
    v_mfma_f32_16x16x32_bf16 v[244:247], a[252:255], v[48:51], 0
    ds_read_b64_tr_b16 a[246:247], v12 offset:32480
    buffer_load_dwordx4 v5, s[8:11], s32 offen offset:3072 lds
    v_lshlrev_b32 v24, 16, v42
    v_mfma_f32_16x16x32_bf16 v[252:255], a[252:255], v[52:55], 0
    ds_read_b64_tr_b16 a[248:249], v12 offset:18688
    s_waitcnt lgkmcnt(9)
    v_mfma_f32_16x16x32_bf16 a[0:3], a[224:227], v[48:51], 0
    ds_read_b64_tr_b16 a[250:251], v12 offset:23296
    s_add_u32 m0, m0, 0x400
    s_mov_b64 exec, s[34:35]
    buffer_load_dwordx4 v6, s[8:11], s32 offen offset:3072 lds
    s_mov_b64 exec, -1
    v_mfma_f32_16x16x32_bf16 a[8:11], a[224:227], v[52:55], 0
    ds_read_b64_tr_b16 a[252:253], v12 offset:27904
    v_mfma_f32_16x16x32_bf16 a[4:7], a[228:231], v[48:51], 0
    ds_read_b64_tr_b16 a[254:255], v12 offset:32512
    s_add_u32 s32, s32, 294624
    v_and_b32 v25, s46, v42
    v_mfma_f32_16x16x32_bf16 a[12:15], a[228:231], v[52:55], 0
    ds_read_b64_tr_b16 a[224:225], v12 offset:18720
    s_waitcnt lgkmcnt(9)
    v_mfma_f32_16x16x32_bf16 a[16:19], a[232:235], v[48:51], 0
    ds_read_b64_tr_b16 a[226:227], v12 offset:23328
    v_fma_f32 v24, v24, v20, v22
    v_fma_f32 v25, v25, v20, v22
    v_mfma_f32_16x16x32_bf16 a[24:27], a[232:235], v[52:55], 0
    ds_read_b64_tr_b16 a[228:229], v12 offset:27936
    v_mfma_f32_16x16x32_bf16 a[20:23], a[236:239], v[48:51], 0
    ds_read_b64_tr_b16 a[230:231], v12 offset:32544
    v_cvt_pk_bf16_f32 v58, v24, v25
    v_lshlrev_b32 v26, 16, v43
    v_mfma_f32_16x16x32_bf16 a[28:31], a[236:239], v[52:55], 0
    ds_read_b64_tr_b16 a[232:233], v12 offset:18752
    s_waitcnt lgkmcnt(9)
    v_mfma_f32_16x16x32_bf16 a[32:35], a[240:243], v[48:51], 0
    ds_read_b64_tr_b16 a[234:235], v12 offset:23360
    v_and_b32 v27, s46, v43
    v_fma_f32 v26, v26, v20, v22
    v_mfma_f32_16x16x32_bf16 a[40:43], a[240:243], v[52:55], 0
    ds_read_b64_tr_b16 a[236:237], v12 offset:27968
    v_mfma_f32_16x16x32_bf16 a[36:39], a[244:247], v[48:51], 0
    ds_read_b64_tr_b16 a[238:239], v12 offset:32576
    v_fma_f32 v27, v27, v20, v22
    v_cvt_pk_bf16_f32 v59, v26, v27
    v_mfma_f32_16x16x32_bf16 a[44:47], a[244:247], v[52:55], 0
    s_waitcnt vmcnt(27)
    s_barrier
    ds_read_b64_tr_b16 a[240:241], v13 offset:0
    s_waitcnt lgkmcnt(9)
    v_mfma_f32_16x16x32_bf16 a[48:51], a[248:251], v[48:51], 0
    ds_read_b64_tr_b16 a[242:243], v13 offset:4608
    s_sub_u32 s52, s53, s52
    s_add_u32 m0, s52, 0
    s_nop 0
    buffer_load_dwordx4 v2, s[8:11], s32 offen offset:0 lds
    v_mfma_f32_16x16x32_bf16 a[56:59], a[248:251], v[52:55], 0
    ds_read_b64_tr_b16 a[244:245], v13 offset:9216
    v_mfma_f32_16x16x32_bf16 a[52:55], a[252:255], v[48:51], 0
    ds_read_b64_tr_b16 a[246:247], v13 offset:13824
    buffer_load_dwordx4 v3, s[8:11], s32 offen offset:1024 lds
    v_lshlrev_b32 v24, 16, v44
    v_mfma_f32_16x16x32_bf16 a[60:63], a[252:255], v[52:55], 0
    ds_read_b64_tr_b16 a[248:249], v13 offset:32
    s_waitcnt lgkmcnt(9)
    v_mfma_f32_16x16x32_bf16 a[64:67], a[224:227], v[48:51], 0
    ds_read_b64_tr_b16 a[250:251], v13 offset:4640
    buffer_load_dwordx4 v4, s[8:11], s32 offen offset:2048 lds
    v_and_b32 v25, s46, v44
    v_mfma_f32_16x16x32_bf16 a[72:75], a[224:227], v[52:55], 0
    ds_read_b64_tr_b16 a[252:253], v13 offset:9248
    v_mfma_f32_16x16x32_bf16 a[68:71], a[228:231], v[48:51], 0
    ds_read_b64_tr_b16 a[254:255], v13 offset:13856
    buffer_load_dwordx4 v5, s[8:11], s32 offen offset:3072 lds
    v_fma_f32 v24, v24, v14, v16
    v_mfma_f32_16x16x32_bf16 a[76:79], a[228:231], v[52:55], 0
    ds_read_b64_tr_b16 a[224:225], v13 offset:64
    s_waitcnt lgkmcnt(9)
    v_mfma_f32_16x16x32_bf16 a[80:83], a[232:235], v[48:51], 0
    ds_read_b64_tr_b16 a[226:227], v13 offset:4672
    s_add_u32 m0, m0, 0x400
    s_mov_b64 exec, s[34:35]
    buffer_load_dwordx4 v6, s[8:11], s32 offen offset:3072 lds
    s_mov_b64 exec, -1
    v_mfma_f32_16x16x32_bf16 a[88:91], a[232:235], v[52:55], 0
    ds_read_b64_tr_b16 a[228:229], v13 offset:9280
    v_mfma_f32_16x16x32_bf16 a[84:87], a[236:239], v[48:51], 0
    ds_read_b64_tr_b16 a[230:231], v13 offset:13888
    s_add_u32 s32, s32, 288
    v_fma_f32 v25, v25, v14, v16
    v_mfma_f32_16x16x32_bf16 a[92:95], a[236:239], v[52:55], 0
    v_cvt_pk_bf16_f32 v60, v24, v25
    v_lshlrev_b32 v26, 16, v45
    v_and_b32 v27, s46, v45
    v_fma_f32 v26, v26, v14, v16
    v_fma_f32 v27, v27, v14, v16
    v_cvt_pk_bf16_f32 v61, v26, v27
    v_lshlrev_b32 v24, 16, v46
    v_and_b32 v25, s46, v46
    v_fma_f32 v24, v24, v14, v16
    v_fma_f32 v25, v25, v14, v16
    v_cvt_pk_bf16_f32 v62, v24, v25
    v_lshlrev_b32 v26, 16, v47
    v_and_b32 v27, s46, v47
    v_fma_f32 v26, v26, v14, v16
    v_fma_f32 v27, v27, v14, v16
    v_cvt_pk_bf16_f32 v63, v26, v27
    buffer_load_dwordx4 v[40:43], v18, s[16:19], s47 offen
    buffer_load_dwordx4 v[44:47], v19, s[16:19], s47 offen
    s_add_u32 s47, s47, 0x400
    ds_read_b64_tr_b16 a[232:233], v13 offset:96
    s_waitcnt lgkmcnt(9)
    v_mfma_f32_16x16x32_bf16 v[64:67], a[240:243], v[56:59], v[64:67]
    ds_read_b64_tr_b16 a[234:235], v13 offset:4704
    s_waitcnt vmcnt(29)
    v_lshlrev_b32 v24, 16, v32
    v_mfma_f32_16x16x32_bf16 v[72:75], a[240:243], v[60:63], v[72:75]
    ds_read_b64_tr_b16 a[236:237], v13 offset:9312
    v_mfma_f32_16x16x32_bf16 v[68:71], a[244:247], v[56:59], v[68:71]
    ds_read_b64_tr_b16 a[238:239], v13 offset:13920
    v_and_b32 v25, s46, v32
    v_fma_f32 v24, v24, v20, v22
    v_mfma_f32_16x16x32_bf16 v[76:79], a[244:247], v[60:63], v[76:79]
    ds_read_b64_tr_b16 a[240:241], v13 offset:128
    s_waitcnt lgkmcnt(9)
    v_mfma_f32_16x16x32_bf16 v[80:83], a[248:251], v[56:59], v[80:83]
    ds_read_b64_tr_b16 a[242:243], v13 offset:4736
    v_fma_f32 v25, v25, v20, v22
    v_cvt_pk_bf16_f32 v48, v24, v25
    v_mfma_f32_16x16x32_bf16 v[88:91], a[248:251], v[60:63], v[88:91]
    ds_read_b64_tr_b16 a[244:245], v13 offset:9344
    v_mfma_f32_16x16x32_bf16 v[84:87], a[252:255], v[56:59], v[84:87]
    ds_read_b64_tr_b16 a[246:247], v13 offset:13952
    v_lshlrev_b32 v26, 16, v33
    v_and_b32 v27, s46, v33
    v_mfma_f32_16x16x32_bf16 v[92:95], a[252:255], v[60:63], v[92:95]
    ds_read_b64_tr_b16 a[248:249], v13 offset:160
    s_waitcnt lgkmcnt(9)
    v_mfma_f32_16x16x32_bf16 v[96:99], a[224:227], v[56:59], v[96:99]
    ds_read_b64_tr_b16 a[250:251], v13 offset:4768
    v_fma_f32 v26, v26, v20, v22
    v_fma_f32 v27, v27, v20, v22
    v_mfma_f32_16x16x32_bf16 v[104:107], a[224:227], v[60:63], v[104:107]
    ds_read_b64_tr_b16 a[252:253], v13 offset:9376
    v_mfma_f32_16x16x32_bf16 v[100:103], a[228:231], v[56:59], v[100:103]
    ds_read_b64_tr_b16 a[254:255], v13 offset:13984
    v_cvt_pk_bf16_f32 v49, v26, v27
    v_lshlrev_b32 v24, 16, v34
    v_mfma_f32_16x16x32_bf16 v[108:111], a[228:231], v[60:63], v[108:111]
    ds_read_b64_tr_b16 a[224:225], v13 offset:192
    s_waitcnt lgkmcnt(9)
    v_mfma_f32_16x16x32_bf16 v[112:115], a[232:235], v[56:59], v[112:115]
    ds_read_b64_tr_b16 a[226:227], v13 offset:4800
    v_and_b32 v25, s46, v34
    v_fma_f32 v24, v24, v20, v22
    v_mfma_f32_16x16x32_bf16 v[120:123], a[232:235], v[60:63], v[120:123]
    ds_read_b64_tr_b16 a[228:229], v13 offset:9408
    v_mfma_f32_16x16x32_bf16 v[116:119], a[236:239], v[56:59], v[116:119]
    ds_read_b64_tr_b16 a[230:231], v13 offset:14016
    v_fma_f32 v25, v25, v20, v22
    v_cvt_pk_bf16_f32 v50, v24, v25
    v_mfma_f32_16x16x32_bf16 v[124:127], a[236:239], v[60:63], v[124:127]
    ds_read_b64_tr_b16 a[232:233], v13 offset:224
    s_waitcnt lgkmcnt(9)
    v_mfma_f32_16x16x32_bf16 v[128:131], a[240:243], v[56:59], v[128:131]
    ds_read_b64_tr_b16 a[234:235], v13 offset:4832
    v_lshlrev_b32 v26, 16, v35
    v_and_b32 v27, s46, v35
    v_mfma_f32_16x16x32_bf16 v[136:139], a[240:243], v[60:63], v[136:139]
    ds_read_b64_tr_b16 a[236:237], v13 offset:9440
    v_mfma_f32_16x16x32_bf16 v[132:135], a[244:247], v[56:59], v[132:135]
    ds_read_b64_tr_b16 a[238:239], v13 offset:14048
    v_fma_f32 v26, v26, v20, v22
    v_fma_f32 v27, v27, v20, v22
    v_mfma_f32_16x16x32_bf16 v[140:143], a[244:247], v[60:63], v[140:143]
    ds_read_b64_tr_b16 a[240:241], v13 offset:256
    s_waitcnt lgkmcnt(9)
    v_mfma_f32_16x16x32_bf16 v[144:147], a[248:251], v[56:59], v[144:147]
    ds_read_b64_tr_b16 a[242:243], v13 offset:4864
    v_cvt_pk_bf16_f32 v51, v26, v27
    v_lshlrev_b32 v24, 16, v36
    v_mfma_f32_16x16x32_bf16 v[152:155], a[248:251], v[60:63], v[152:155]
    ds_read_b64_tr_b16 a[244:245], v13 offset:9472
    v_mfma_f32_16x16x32_bf16 v[148:151], a[252:255], v[56:59], v[148:151]
    ds_read_b64_tr_b16 a[246:247], v13 offset:14080
    v_and_b32 v25, s46, v36
    v_fma_f32 v24, v24, v14, v16
    v_mfma_f32_16x16x32_bf16 v[156:159], a[252:255], v[60:63], v[156:159]
    s_waitcnt vmcnt(27)
    s_barrier
    ds_read_b64_tr_b16 a[248:249], v13 offset:18496
    s_waitcnt lgkmcnt(9)
    v_mfma_f32_16x16x32_bf16 v[160:163], a[224:227], v[56:59], v[160:163]
    ds_read_b64_tr_b16 a[250:251], v13 offset:23104
    s_add_u32 m0, s52, 18496
    s_nop 0
    buffer_load_dwordx4 v2, s[8:11], s32 offen offset:0 lds
    v_mfma_f32_16x16x32_bf16 v[168:171], a[224:227], v[60:63], v[168:171]
    ds_read_b64_tr_b16 a[252:253], v13 offset:27712
    v_mfma_f32_16x16x32_bf16 v[164:167], a[228:231], v[56:59], v[164:167]
    ds_read_b64_tr_b16 a[254:255], v13 offset:32320
    buffer_load_dwordx4 v3, s[8:11], s32 offen offset:1024 lds
    v_fma_f32 v25, v25, v14, v16
    v_mfma_f32_16x16x32_bf16 v[172:175], a[228:231], v[60:63], v[172:175]
    ds_read_b64_tr_b16 a[224:225], v13 offset:18528
    s_waitcnt lgkmcnt(9)
    v_mfma_f32_16x16x32_bf16 v[176:179], a[232:235], v[56:59], v[176:179]
    ds_read_b64_tr_b16 a[226:227], v13 offset:23136
    buffer_load_dwordx4 v4, s[8:11], s32 offen offset:2048 lds
    v_cvt_pk_bf16_f32 v52, v24, v25
    v_mfma_f32_16x16x32_bf16 v[184:187], a[232:235], v[60:63], v[184:187]
    ds_read_b64_tr_b16 a[228:229], v13 offset:27744
    v_mfma_f32_16x16x32_bf16 v[180:183], a[236:239], v[56:59], v[180:183]
    ds_read_b64_tr_b16 a[230:231], v13 offset:32352
    buffer_load_dwordx4 v5, s[8:11], s32 offen offset:3072 lds
    v_lshlrev_b32 v26, 16, v37
    v_mfma_f32_16x16x32_bf16 v[188:191], a[236:239], v[60:63], v[188:191]
    ds_read_b64_tr_b16 a[232:233], v13 offset:18560
    s_waitcnt lgkmcnt(9)
    v_mfma_f32_16x16x32_bf16 v[192:195], a[240:243], v[56:59], v[192:195]
    ds_read_b64_tr_b16 a[234:235], v13 offset:23168
    s_add_u32 m0, m0, 0x400
    s_mov_b64 exec, s[34:35]
    buffer_load_dwordx4 v6, s[8:11], s32 offen offset:3072 lds
    s_mov_b64 exec, -1
    v_mfma_f32_16x16x32_bf16 v[200:203], a[240:243], v[60:63], v[200:203]
    ds_read_b64_tr_b16 a[236:237], v13 offset:27776
    v_mfma_f32_16x16x32_bf16 v[196:199], a[244:247], v[56:59], v[196:199]
    ds_read_b64_tr_b16 a[238:239], v13 offset:32384
    s_add_u32 s32, s32, 294624
    v_and_b32 v27, s46, v37
    v_mfma_f32_16x16x32_bf16 v[204:207], a[244:247], v[60:63], v[204:207]
    ds_read_b64_tr_b16 a[240:241], v13 offset:18592
    s_waitcnt lgkmcnt(9)
    v_mfma_f32_16x16x32_bf16 v[208:211], a[248:251], v[56:59], v[208:211]
    ds_read_b64_tr_b16 a[242:243], v13 offset:23200
    v_fma_f32 v26, v26, v14, v16
    v_fma_f32 v27, v27, v14, v16
    v_mfma_f32_16x16x32_bf16 v[216:219], a[248:251], v[60:63], v[216:219]
    ds_read_b64_tr_b16 a[244:245], v13 offset:27808
    v_mfma_f32_16x16x32_bf16 v[212:215], a[252:255], v[56:59], v[212:215]
    ds_read_b64_tr_b16 a[246:247], v13 offset:32416
    v_cvt_pk_bf16_f32 v53, v26, v27
    v_lshlrev_b32 v24, 16, v38
    v_mfma_f32_16x16x32_bf16 v[220:223], a[252:255], v[60:63], v[220:223]
    ds_read_b64_tr_b16 a[248:249], v13 offset:18624
    s_waitcnt lgkmcnt(9)
    v_mfma_f32_16x16x32_bf16 v[224:227], a[224:227], v[56:59], v[224:227]
    ds_read_b64_tr_b16 a[250:251], v13 offset:23232
    v_and_b32 v25, s46, v38
    v_fma_f32 v24, v24, v14, v16
    v_mfma_f32_16x16x32_bf16 v[232:235], a[224:227], v[60:63], v[232:235]
    ds_read_b64_tr_b16 a[252:253], v13 offset:27840
    v_mfma_f32_16x16x32_bf16 v[228:231], a[228:231], v[56:59], v[228:231]
    ds_read_b64_tr_b16 a[254:255], v13 offset:32448
    v_fma_f32 v25, v25, v14, v16
    v_cvt_pk_bf16_f32 v54, v24, v25
    v_mfma_f32_16x16x32_bf16 v[236:239], a[228:231], v[60:63], v[236:239]
    ds_read_b64_tr_b16 a[224:225], v13 offset:18656
    s_waitcnt lgkmcnt(9)
    v_mfma_f32_16x16x32_bf16 v[240:243], a[232:235], v[56:59], v[240:243]
    ds_read_b64_tr_b16 a[226:227], v13 offset:23264
    v_lshlrev_b32 v26, 16, v39
    v_and_b32 v27, s46, v39
    v_mfma_f32_16x16x32_bf16 v[248:251], a[232:235], v[60:63], v[248:251]
    ds_read_b64_tr_b16 a[228:229], v13 offset:27872
    v_mfma_f32_16x16x32_bf16 v[244:247], a[236:239], v[56:59], v[244:247]
    ds_read_b64_tr_b16 a[230:231], v13 offset:32480
    v_fma_f32 v26, v26, v14, v16
    v_fma_f32 v27, v27, v14, v16
    v_mfma_f32_16x16x32_bf16 v[252:255], a[236:239], v[60:63], v[252:255]
    ds_read_b64_tr_b16 a[232:233], v13 offset:18688
    s_waitcnt lgkmcnt(9)
    v_mfma_f32_16x16x32_bf16 a[0:3], a[240:243], v[56:59], a[0:3]
    ds_read_b64_tr_b16 a[234:235], v13 offset:23296
    v_cvt_pk_bf16_f32 v55, v26, v27
    buffer_load_dwordx4 v[32:35], v18, s[16:19], s47 offen
    v_mfma_f32_16x16x32_bf16 a[8:11], a[240:243], v[60:63], a[8:11]
    ds_read_b64_tr_b16 a[236:237], v13 offset:27904
    v_mfma_f32_16x16x32_bf16 a[4:7], a[244:247], v[56:59], a[4:7]
    ds_read_b64_tr_b16 a[238:239], v13 offset:32512
    buffer_load_dwordx4 v[36:39], v19, s[16:19], s47 offen
    s_add_u32 s47, s47, 0x400
    v_mfma_f32_16x16x32_bf16 a[12:15], a[244:247], v[60:63], a[12:15]
    ds_read_b64_tr_b16 a[240:241], v13 offset:18720
    s_waitcnt lgkmcnt(9)
    v_mfma_f32_16x16x32_bf16 a[16:19], a[248:251], v[56:59], a[16:19]
    ds_read_b64_tr_b16 a[242:243], v13 offset:23328
    v_mfma_f32_16x16x32_bf16 a[24:27], a[248:251], v[60:63], a[24:27]
    ds_read_b64_tr_b16 a[244:245], v13 offset:27936
    v_mfma_f32_16x16x32_bf16 a[20:23], a[252:255], v[56:59], a[20:23]
    ds_read_b64_tr_b16 a[246:247], v13 offset:32544
    v_mfma_f32_16x16x32_bf16 a[28:31], a[252:255], v[60:63], a[28:31]
    ds_read_b64_tr_b16 a[248:249], v13 offset:18752
    s_waitcnt lgkmcnt(9)
    v_mfma_f32_16x16x32_bf16 a[32:35], a[224:227], v[56:59], a[32:35]
    ds_read_b64_tr_b16 a[250:251], v13 offset:23360
    v_mfma_f32_16x16x32_bf16 a[40:43], a[224:227], v[60:63], a[40:43]
    ds_read_b64_tr_b16 a[252:253], v13 offset:27968
    v_mfma_f32_16x16x32_bf16 a[36:39], a[228:231], v[56:59], a[36:39]
    ds_read_b64_tr_b16 a[254:255], v13 offset:32576
    v_mfma_f32_16x16x32_bf16 a[44:47], a[228:231], v[60:63], a[44:47]
    s_waitcnt vmcnt(29)
    s_barrier
    v_add_u32 v12, s54, v12
    v_add_u32 v13, s54, v13
    s_sub_u32 s54, 0, s54
    ds_read_b64_tr_b16 a[224:225], v12 offset:0
    s_waitcnt lgkmcnt(9)
    v_mfma_f32_16x16x32_bf16 a[48:51], a[232:235], v[56:59], a[48:51]
    ds_read_b64_tr_b16 a[226:227], v12 offset:4608
    s_add_u32 m0, s52, 36992
    s_nop 0
    buffer_load_dwordx4 v2, s[8:11], s32 offen offset:0 lds
    v_mfma_f32_16x16x32_bf16 a[56:59], a[232:235], v[60:63], a[56:59]
    ds_read_b64_tr_b16 a[228:229], v12 offset:9216
    v_mfma_f32_16x16x32_bf16 a[52:55], a[236:239], v[56:59], a[52:55]
    ds_read_b64_tr_b16 a[230:231], v12 offset:13824
    buffer_load_dwordx4 v3, s[8:11], s32 offen offset:1024 lds
    v_mfma_f32_16x16x32_bf16 a[60:63], a[236:239], v[60:63], a[60:63]
    ds_read_b64_tr_b16 a[232:233], v12 offset:32
    s_waitcnt lgkmcnt(9)
    v_mfma_f32_16x16x32_bf16 a[64:67], a[240:243], v[56:59], a[64:67]
    ds_read_b64_tr_b16 a[234:235], v12 offset:4640
    buffer_load_dwordx4 v4, s[8:11], s32 offen offset:2048 lds
    v_mfma_f32_16x16x32_bf16 a[72:75], a[240:243], v[60:63], a[72:75]
    ds_read_b64_tr_b16 a[236:237], v12 offset:9248
    v_mfma_f32_16x16x32_bf16 a[68:71], a[244:247], v[56:59], a[68:71]
    ds_read_b64_tr_b16 a[238:239], v12 offset:13856
    buffer_load_dwordx4 v5, s[8:11], s32 offen offset:3072 lds
    v_mfma_f32_16x16x32_bf16 a[76:79], a[244:247], v[60:63], a[76:79]
    ds_read_b64_tr_b16 a[240:241], v12 offset:64
    s_waitcnt lgkmcnt(9)
    v_mfma_f32_16x16x32_bf16 a[80:83], a[248:251], v[56:59], a[80:83]
    ds_read_b64_tr_b16 a[242:243], v12 offset:4672
    s_add_u32 m0, m0, 0x400
    s_mov_b64 exec, s[34:35]
    buffer_load_dwordx4 v6, s[8:11], s32 offen offset:3072 lds
    s_mov_b64 exec, -1
    v_mfma_f32_16x16x32_bf16 a[88:91], a[248:251], v[60:63], a[88:91]
    ds_read_b64_tr_b16 a[244:245], v12 offset:9280
    v_mfma_f32_16x16x32_bf16 a[84:87], a[252:255], v[56:59], a[84:87]
    ds_read_b64_tr_b16 a[246:247], v12 offset:13888
    s_add_u32 s32, s32, 288
    v_mfma_f32_16x16x32_bf16 a[92:95], a[252:255], v[60:63], a[92:95]
    ds_read_b64_tr_b16 a[248:249], v12 offset:96
    s_waitcnt lgkmcnt(9)
    v_mfma_f32_16x16x32_bf16 v[64:67], a[224:227], v[48:51], v[64:67]
    ds_read_b64_tr_b16 a[250:251], v12 offset:4704
    s_waitcnt vmcnt(12)
    v_lshlrev_b32 v24, 16, v40
    v_mfma_f32_16x16x32_bf16 v[72:75], a[224:227], v[52:55], v[72:75]
    ds_read_b64_tr_b16 a[252:253], v12 offset:9312
    v_mfma_f32_16x16x32_bf16 v[68:71], a[228:231], v[48:51], v[68:71]
    ds_read_b64_tr_b16 a[254:255], v12 offset:13920
    v_and_b32 v25, s46, v40
    v_fma_f32 v24, v24, v20, v22
    v_mfma_f32_16x16x32_bf16 v[76:79], a[228:231], v[52:55], v[76:79]
    ds_read_b64_tr_b16 a[224:225], v12 offset:128
    s_waitcnt lgkmcnt(9)
    v_mfma_f32_16x16x32_bf16 v[80:83], a[232:235], v[48:51], v[80:83]
    ds_read_b64_tr_b16 a[226:227], v12 offset:4736
    v_fma_f32 v25, v25, v20, v22
    v_cvt_pk_bf16_f32 v56, v24, v25
    v_mfma_f32_16x16x32_bf16 v[88:91], a[232:235], v[52:55], v[88:91]
    ds_read_b64_tr_b16 a[228:229], v12 offset:9344
    v_mfma_f32_16x16x32_bf16 v[84:87], a[236:239], v[48:51], v[84:87]
    ds_read_b64_tr_b16 a[230:231], v12 offset:13952
    v_lshlrev_b32 v26, 16, v41
    v_and_b32 v27, s46, v41
    v_mfma_f32_16x16x32_bf16 v[92:95], a[236:239], v[52:55], v[92:95]
    ds_read_b64_tr_b16 a[232:233], v12 offset:160
    s_waitcnt lgkmcnt(9)
    v_mfma_f32_16x16x32_bf16 v[96:99], a[240:243], v[48:51], v[96:99]
    ds_read_b64_tr_b16 a[234:235], v12 offset:4768
    v_fma_f32 v26, v26, v20, v22
    v_fma_f32 v27, v27, v20, v22
    v_mfma_f32_16x16x32_bf16 v[104:107], a[240:243], v[52:55], v[104:107]
    ds_read_b64_tr_b16 a[236:237], v12 offset:9376
    v_mfma_f32_16x16x32_bf16 v[100:103], a[244:247], v[48:51], v[100:103]
    ds_read_b64_tr_b16 a[238:239], v12 offset:13984
    v_cvt_pk_bf16_f32 v57, v26, v27
    v_lshlrev_b32 v24, 16, v42
    v_mfma_f32_16x16x32_bf16 v[108:111], a[244:247], v[52:55], v[108:111]
    ds_read_b64_tr_b16 a[240:241], v12 offset:192
    s_waitcnt lgkmcnt(9)
    v_mfma_f32_16x16x32_bf16 v[112:115], a[248:251], v[48:51], v[112:115]
    ds_read_b64_tr_b16 a[242:243], v12 offset:4800
    v_and_b32 v25, s46, v42
    v_fma_f32 v24, v24, v20, v22
    v_mfma_f32_16x16x32_bf16 v[120:123], a[248:251], v[52:55], v[120:123]
    ds_read_b64_tr_b16 a[244:245], v12 offset:9408
    v_mfma_f32_16x16x32_bf16 v[116:119], a[252:255], v[48:51], v[116:119]
    ds_read_b64_tr_b16 a[246:247], v12 offset:14016
    v_fma_f32 v25, v25, v20, v22
    v_cvt_pk_bf16_f32 v58, v24, v25
    v_mfma_f32_16x16x32_bf16 v[124:127], a[252:255], v[52:55], v[124:127]
    ds_read_b64_tr_b16 a[248:249], v12 offset:224
    s_waitcnt lgkmcnt(9)
    v_mfma_f32_16x16x32_bf16 v[128:131], a[224:227], v[48:51], v[128:131]
    ds_read_b64_tr_b16 a[250:251], v12 offset:4832
    v_lshlrev_b32 v26, 16, v43
    v_and_b32 v27, s46, v43
    v_mfma_f32_16x16x32_bf16 v[136:139], a[224:227], v[52:55], v[136:139]
    ds_read_b64_tr_b16 a[252:253], v12 offset:9440
    v_mfma_f32_16x16x32_bf16 v[132:135], a[228:231], v[48:51], v[132:135]
    ds_read_b64_tr_b16 a[254:255], v12 offset:14048
    v_fma_f32 v26, v26, v20, v22
    v_fma_f32 v27, v27, v20, v22
    v_mfma_f32_16x16x32_bf16 v[140:143], a[228:231], v[52:55], v[140:143]
    ds_read_b64_tr_b16 a[224:225], v12 offset:256
    s_waitcnt lgkmcnt(9)
    v_mfma_f32_16x16x32_bf16 v[144:147], a[232:235], v[48:51], v[144:147]
    ds_read_b64_tr_b16 a[226:227], v12 offset:4864
    v_cvt_pk_bf16_f32 v59, v26, v27
    v_lshlrev_b32 v24, 16, v44
    v_mfma_f32_16x16x32_bf16 v[152:155], a[232:235], v[52:55], v[152:155]
    ds_read_b64_tr_b16 a[228:229], v12 offset:9472
    v_mfma_f32_16x16x32_bf16 v[148:151], a[236:239], v[48:51], v[148:151]
    ds_read_b64_tr_b16 a[230:231], v12 offset:14080
    v_and_b32 v25, s46, v44
    v_fma_f32 v24, v24, v14, v16
    v_mfma_f32_16x16x32_bf16 v[156:159], a[236:239], v[52:55], v[156:159]
    s_barrier
    ds_read_b64_tr_b16 a[232:233], v12 offset:18496
    s_waitcnt lgkmcnt(9)
    v_mfma_f32_16x16x32_bf16 v[160:163], a[240:243], v[48:51], v[160:163]
    ds_read_b64_tr_b16 a[234:235], v12 offset:23104
    s_add_u32 m0, s52, 55488
    s_nop 0
    buffer_load_dwordx4 v2, s[8:11], s32 offen offset:0 lds
    v_mfma_f32_16x16x32_bf16 v[168:171], a[240:243], v[52:55], v[168:171]
    ds_read_b64_tr_b16 a[236:237], v12 offset:27712
    v_mfma_f32_16x16x32_bf16 v[164:167], a[244:247], v[48:51], v[164:167]
    ds_read_b64_tr_b16 a[238:239], v12 offset:32320
    buffer_load_dwordx4 v3, s[8:11], s32 offen offset:1024 lds
    v_fma_f32 v25, v25, v14, v16
    v_mfma_f32_16x16x32_bf16 v[172:175], a[244:247], v[52:55], v[172:175]
    ds_read_b64_tr_b16 a[240:241], v12 offset:18528
    s_waitcnt lgkmcnt(9)
    v_mfma_f32_16x16x32_bf16 v[176:179], a[248:251], v[48:51], v[176:179]
    ds_read_b64_tr_b16 a[242:243], v12 offset:23136
    buffer_load_dwordx4 v4, s[8:11], s32 offen offset:2048 lds
    v_cvt_pk_bf16_f32 v60, v24, v25
    v_mfma_f32_16x16x32_bf16 v[184:187], a[248:251], v[52:55], v[184:187]
    ds_read_b64_tr_b16 a[244:245], v12 offset:27744
    v_mfma_f32_16x16x32_bf16 v[180:183], a[252:255], v[48:51], v[180:183]
    ds_read_b64_tr_b16 a[246:247], v12 offset:32352
    buffer_load_dwordx4 v5, s[8:11], s32 offen offset:3072 lds
    v_lshlrev_b32 v26, 16, v45
    v_mfma_f32_16x16x32_bf16 v[188:191], a[252:255], v[52:55], v[188:191]
    ds_read_b64_tr_b16 a[248:249], v12 offset:18560
    s_waitcnt lgkmcnt(9)
    v_mfma_f32_16x16x32_bf16 v[192:195], a[224:227], v[48:51], v[192:195]
    ds_read_b64_tr_b16 a[250:251], v12 offset:23168
    s_add_u32 m0, m0, 0x400
    s_mov_b64 exec, s[34:35]
    buffer_load_dwordx4 v6, s[8:11], s32 offen offset:3072 lds
    s_mov_b64 exec, -1
    v_mfma_f32_16x16x32_bf16 v[200:203], a[224:227], v[52:55], v[200:203]
    ds_read_b64_tr_b16 a[252:253], v12 offset:27776
    v_mfma_f32_16x16x32_bf16 v[196:199], a[228:231], v[48:51], v[196:199]
    ds_read_b64_tr_b16 a[254:255], v12 offset:32384
    s_add_u32 s32, s32, 294624
    v_and_b32 v27, s46, v45
    v_mfma_f32_16x16x32_bf16 v[204:207], a[228:231], v[52:55], v[204:207]
    s_mov_b32 s55, 4
L_k3_loop:
    ds_read_b64_tr_b16 a[224:225], v12 offset:18592
    s_waitcnt lgkmcnt(9)
    v_mfma_f32_16x16x32_bf16 v[208:211], a[232:235], v[48:51], v[208:211]
    ds_read_b64_tr_b16 a[226:227], v12 offset:23200
    v_fma_f32 v26, v26, v14, v16
    v_fma_f32 v27, v27, v14, v16
    v_mfma_f32_16x16x32_bf16 v[216:219], a[232:235], v[52:55], v[216:219]
    ds_read_b64_tr_b16 a[228:229], v12 offset:27808
    v_mfma_f32_16x16x32_bf16 v[212:215], a[236:239], v[48:51], v[212:215]
    ds_read_b64_tr_b16 a[230:231], v12 offset:32416
    v_cvt_pk_bf16_f32 v61, v26, v27
    v_lshlrev_b32 v24, 16, v46
    v_mfma_f32_16x16x32_bf16 v[220:223], a[236:239], v[52:55], v[220:223]
    ds_read_b64_tr_b16 a[232:233], v12 offset:18624
    s_waitcnt lgkmcnt(9)
    v_mfma_f32_16x16x32_bf16 v[224:227], a[240:243], v[48:51], v[224:227]
    ds_read_b64_tr_b16 a[234:235], v12 offset:23232
    v_and_b32 v25, s46, v46
    v_fma_f32 v24, v24, v14, v16
    v_mfma_f32_16x16x32_bf16 v[232:235], a[240:243], v[52:55], v[232:235]
    ds_read_b64_tr_b16 a[236:237], v12 offset:27840
    v_mfma_f32_16x16x32_bf16 v[228:231], a[244:247], v[48:51], v[228:231]
    ds_read_b64_tr_b16 a[238:239], v12 offset:32448
    v_fma_f32 v25, v25, v14, v16
    v_cvt_pk_bf16_f32 v62, v24, v25
    v_mfma_f32_16x16x32_bf16 v[236:239], a[244:247], v[52:55], v[236:239]
    ds_read_b64_tr_b16 a[240:241], v12 offset:18656
    s_waitcnt lgkmcnt(9)
    v_mfma_f32_16x16x32_bf16 v[240:243], a[248:251], v[48:51], v[240:243]
    ds_read_b64_tr_b16 a[242:243], v12 offset:23264
    v_lshlrev_b32 v26, 16, v47
    v_and_b32 v27, s46, v47
    v_mfma_f32_16x16x32_bf16 v[248:251], a[248:251], v[52:55], v[248:251]
    ds_read_b64_tr_b16 a[244:245], v12 offset:27872
    v_mfma_f32_16x16x32_bf16 v[244:247], a[252:255], v[48:51], v[244:247]
    ds_read_b64_tr_b16 a[246:247], v12 offset:32480
    v_fma_f32 v26, v26, v14, v16
    v_fma_f32 v27, v27, v14, v16
    v_mfma_f32_16x16x32_bf16 v[252:255], a[252:255], v[52:55], v[252:255]
    ds_read_b64_tr_b16 a[248:249], v12 offset:18688
    s_waitcnt lgkmcnt(9)
    v_mfma_f32_16x16x32_bf16 a[0:3], a[224:227], v[48:51], a[0:3]
    ds_read_b64_tr_b16 a[250:251], v12 offset:23296
    v_cvt_pk_bf16_f32 v63, v26, v27
    buffer_load_dwordx4 v[40:43], v18, s[16:19], s47 offen
    v_mfma_f32_16x16x32_bf16 a[8:11], a[224:227], v[52:55], a[8:11]
    ds_read_b64_tr_b16 a[252:253], v12 offset:27904
    v_mfma_f32_16x16x32_bf16 a[4:7], a[228:231], v[48:51], a[4:7]
    ds_read_b64_tr_b16 a[254:255], v12 offset:32512
    buffer_load_dwordx4 v[44:47], v19, s[16:19], s47 offen
    s_add_u32 s47, s47, 0x400
    v_mfma_f32_16x16x32_bf16 a[12:15], a[228:231], v[52:55], a[12:15]
    ds_read_b64_tr_b16 a[224:225], v12 offset:18720
    s_waitcnt lgkmcnt(9)
    v_mfma_f32_16x16x32_bf16 a[16:19], a[232:235], v[48:51], a[16:19]
    ds_read_b64_tr_b16 a[226:227], v12 offset:23328
    v_mfma_f32_16x16x32_bf16 a[24:27], a[232:235], v[52:55], a[24:27]
    ds_read_b64_tr_b16 a[228:229], v12 offset:27936
    v_mfma_f32_16x16x32_bf16 a[20:23], a[236:239], v[48:51], a[20:23]
    ds_read_b64_tr_b16 a[230:231], v12 offset:32544
    v_mfma_f32_16x16x32_bf16 a[28:31], a[236:239], v[52:55], a[28:31]
    ds_read_b64_tr_b16 a[232:233], v12 offset:18752
    s_waitcnt lgkmcnt(9)
    v_mfma_f32_16x16x32_bf16 a[32:35], a[240:243], v[48:51], a[32:35]
    ds_read_b64_tr_b16 a[234:235], v12 offset:23360
    v_mfma_f32_16x16x32_bf16 a[40:43], a[240:243], v[52:55], a[40:43]
    ds_read_b64_tr_b16 a[236:237], v12 offset:27968
    v_mfma_f32_16x16x32_bf16 a[36:39], a[244:247], v[48:51], a[36:39]
    ds_read_b64_tr_b16 a[238:239], v12 offset:32576
    v_mfma_f32_16x16x32_bf16 a[44:47], a[244:247], v[52:55], a[44:47]
    s_barrier
    ds_read_b64_tr_b16 a[240:241], v13 offset:0
    s_waitcnt lgkmcnt(9)
    v_mfma_f32_16x16x32_bf16 a[48:51], a[248:251], v[48:51], a[48:51]
    ds_read_b64_tr_b16 a[242:243], v13 offset:4608
    s_sub_u32 s52, s53, s52
    s_add_u32 m0, s52, 0
    s_nop 0
    buffer_load_dwordx4 v2, s[8:11], s32 offen offset:0 lds
    v_mfma_f32_16x16x32_bf16 a[56:59], a[248:251], v[52:55], a[56:59]
    ds_read_b64_tr_b16 a[244:245], v13 offset:9216
    v_mfma_f32_16x16x32_bf16 a[52:55], a[252:255], v[48:51], a[52:55]
    ds_read_b64_tr_b16 a[246:247], v13 offset:13824
    buffer_load_dwordx4 v3, s[8:11], s32 offen offset:1024 lds
    v_mfma_f32_16x16x32_bf16 a[60:63], a[252:255], v[52:55], a[60:63]
    ds_read_b64_tr_b16 a[248:249], v13 offset:32
    s_waitcnt lgkmcnt(9)
    v_mfma_f32_16x16x32_bf16 a[64:67], a[224:227], v[48:51], a[64:67]
    ds_read_b64_tr_b16 a[250:251], v13 offset:4640
    buffer_load_dwordx4 v4, s[8:11], s32 offen offset:2048 lds
    v_mfma_f32_16x16x32_bf16 a[72:75], a[224:227], v[52:55], a[72:75]
    ds_read_b64_tr_b16 a[252:253], v13 offset:9248
    v_mfma_f32_16x16x32_bf16 a[68:71], a[228:231], v[48:51], a[68:71]
    ds_read_b64_tr_b16 a[254:255], v13 offset:13856
    buffer_load_dwordx4 v5, s[8:11], s32 offen offset:3072 lds
    v_mfma_f32_16x16x32_bf16 a[76:79], a[228:231], v[52:55], a[76:79]
    ds_read_b64_tr_b16 a[224:225], v13 offset:64
    s_waitcnt lgkmcnt(9)
    v_mfma_f32_16x16x32_bf16 a[80:83], a[232:235], v[48:51], a[80:83]
    ds_read_b64_tr_b16 a[226:227], v13 offset:4672
    s_add_u32 m0, m0, 0x400
    s_mov_b64 exec, s[34:35]
    buffer_load_dwordx4 v6, s[8:11], s32 offen offset:3072 lds
    s_mov_b64 exec, -1
    v_mfma_f32_16x16x32_bf16 a[88:91], a[232:235], v[52:55], a[88:91]
    ds_read_b64_tr_b16 a[228:229], v13 offset:9280
    v_mfma_f32_16x16x32_bf16 a[84:87], a[236:239], v[48:51], a[84:87]
    ds_read_b64_tr_b16 a[230:231], v13 offset:13888
    s_add_u32 s32, s32, 288
    v_mfma_f32_16x16x32_bf16 a[92:95], a[236:239], v[52:55], a[92:95]
    ds_read_b64_tr_b16 a[232:233], v13 offset:96
    s_waitcnt lgkmcnt(9)
    v_mfma_f32_16x16x32_bf16 v[64:67], a[240:243], v[56:59], v[64:67]
    ds_read_b64_tr_b16 a[234:235], v13 offset:4704
    s_waitcnt vmcnt(17)
    v_lshlrev_b32 v24, 16, v32
    v_mfma_f32_16x16x32_bf16 v[72:75], a[240:243], v[60:63], v[72:75]
    ds_read_b64_tr_b16 a[236:237], v13 offset:9312
    v_mfma_f32_16x16x32_bf16 v[68:71], a[244:247], v[56:59], v[68:71]
    ds_read_b64_tr_b16 a[238:239], v13 offset:13920
    v_and_b32 v25, s46, v32
    v_fma_f32 v24, v24, v20, v22
    v_mfma_f32_16x16x32_bf16 v[76:79], a[244:247], v[60:63], v[76:79]
    ds_read_b64_tr_b16 a[240:241], v13 offset:128
    s_waitcnt lgkmcnt(9)
    v_mfma_f32_16x16x32_bf16 v[80:83], a[248:251], v[56:59], v[80:83]
    ds_read_b64_tr_b16 a[242:243], v13 offset:4736
    v_fma_f32 v25, v25, v20, v22
    v_cvt_pk_bf16_f32 v48, v24, v25
    v_mfma_f32_16x16x32_bf16 v[88:91], a[248:251], v[60:63], v[88:91]
    ds_read_b64_tr_b16 a[244:245], v13 offset:9344
    v_mfma_f32_16x16x32_bf16 v[84:87], a[252:255], v[56:59], v[84:87]
    ds_read_b64_tr_b16 a[246:247], v13 offset:13952
    v_lshlrev_b32 v26, 16, v33
    v_and_b32 v27, s46, v33
    v_mfma_f32_16x16x32_bf16 v[92:95], a[252:255], v[60:63], v[92:95]
    ds_read_b64_tr_b16 a[248:249], v13 offset:160
    s_waitcnt lgkmcnt(9)
    v_mfma_f32_16x16x32_bf16 v[96:99], a[224:227], v[56:59], v[96:99]
    ds_read_b64_tr_b16 a[250:251], v13 offset:4768
    v_fma_f32 v26, v26, v20, v22
    v_fma_f32 v27, v27, v20, v22
    v_mfma_f32_16x16x32_bf16 v[104:107], a[224:227], v[60:63], v[104:107]
    ds_read_b64_tr_b16 a[252:253], v13 offset:9376
    v_mfma_f32_16x16x32_bf16 v[100:103], a[228:231], v[56:59], v[100:103]
    ds_read_b64_tr_b16 a[254:255], v13 offset:13984
    v_cvt_pk_bf16_f32 v49, v26, v27
    v_lshlrev_b32 v24, 16, v34
    v_mfma_f32_16x16x32_bf16 v[108:111], a[228:231], v[60:63], v[108:111]
    ds_read_b64_tr_b16 a[224:225], v13 offset:192
    s_waitcnt lgkmcnt(9)
    v_mfma_f32_16x16x32_bf16 v[112:115], a[232:235], v[56:59], v[112:115]
    ds_read_b64_tr_b16 a[226:227], v13 offset:4800
    v_and_b32 v25, s46, v34
    v_fma_f32 v24, v24, v20, v22
    v_mfma_f32_16x16x32_bf16 v[120:123], a[232:235], v[60:63], v[120:123]
    ds_read_b64_tr_b16 a[228:229], v13 offset:9408
    v_mfma_f32_16x16x32_bf16 v[116:119], a[236:239], v[56:59], v[116:119]
    ds_read_b64_tr_b16 a[230:231], v13 offset:14016
    v_fma_f32 v25, v25, v20, v22
    v_cvt_pk_bf16_f32 v50, v24, v25
    v_mfma_f32_16x16x32_bf16 v[124:127], a[236:239], v[60:63], v[124:127]
    ds_read_b64_tr_b16 a[232:233], v13 offset:224
    s_waitcnt lgkmcnt(9)
    v_mfma_f32_16x16x32_bf16 v[128:131], a[240:243], v[56:59], v[128:131]
    ds_read_b64_tr_b16 a[234:235], v13 offset:4832
    v_lshlrev_b32 v26, 16, v35
    v_and_b32 v27, s46, v35
    v_mfma_f32_16x16x32_bf16 v[136:139], a[240:243], v[60:63], v[136:139]
    ds_read_b64_tr_b16 a[236:237], v13 offset:9440
    v_mfma_f32_16x16x32_bf16 v[132:135], a[244:247], v[56:59], v[132:135]
    ds_read_b64_tr_b16 a[238:239], v13 offset:14048
    v_fma_f32 v26, v26, v20, v22
    v_fma_f32 v27, v27, v20, v22
    v_mfma_f32_16x16x32_bf16 v[140:143], a[244:247], v[60:63], v[140:143]
    ds_read_b64_tr_b16 a[240:241], v13 offset:256
    s_waitcnt lgkmcnt(9)
    v_mfma_f32_16x16x32_bf16 v[144:147], a[248:251], v[56:59], v[144:147]
    ds_read_b64_tr_b16 a[242:243], v13 offset:4864
    v_cvt_pk_bf16_f32 v51, v26, v27
    v_lshlrev_b32 v24, 16, v36
    v_mfma_f32_16x16x32_bf16 v[152:155], a[248:251], v[60:63], v[152:155]
    ds_read_b64_tr_b16 a[244:245], v13 offset:9472
    v_mfma_f32_16x16x32_bf16 v[148:151], a[252:255], v[56:59], v[148:151]
    ds_read_b64_tr_b16 a[246:247], v13 offset:14080
    v_and_b32 v25, s46, v36
    v_fma_f32 v24, v24, v14, v16
    v_mfma_f32_16x16x32_bf16 v[156:159], a[252:255], v[60:63], v[156:159]
    s_barrier
    ds_read_b64_tr_b16 a[248:249], v13 offset:18496
    s_waitcnt lgkmcnt(9)
    v_mfma_f32_16x16x32_bf16 v[160:163], a[224:227], v[56:59], v[160:163]
    ds_read_b64_tr_b16 a[250:251], v13 offset:23104
    s_add_u32 m0, s52, 18496
    s_nop 0
    buffer_load_dwordx4 v2, s[8:11], s32 offen offset:0 lds
    v_mfma_f32_16x16x32_bf16 v[168:171], a[224:227], v[60:63], v[168:171]
    ds_read_b64_tr_b16 a[252:253], v13 offset:27712
    v_mfma_f32_16x16x32_bf16 v[164:167], a[228:231], v[56:59], v[164:167]
    ds_read_b64_tr_b16 a[254:255], v13 offset:32320
    buffer_load_dwordx4 v3, s[8:11], s32 offen offset:1024 lds
    v_fma_f32 v25, v25, v14, v16
    v_mfma_f32_16x16x32_bf16 v[172:175], a[228:231], v[60:63], v[172:175]
    ds_read_b64_tr_b16 a[224:225], v13 offset:18528
    s_waitcnt lgkmcnt(9)
    v_mfma_f32_16x16x32_bf16 v[176:179], a[232:235], v[56:59], v[176:179]
    ds_read_b64_tr_b16 a[226:227], v13 offset:23136
    buffer_load_dwordx4 v4, s[8:11], s32 offen offset:2048 lds
    v_cvt_pk_bf16_f32 v52, v24, v25
    v_mfma_f32_16x16x32_bf16 v[184:187], a[232:235], v[60:63], v[184:187]
    ds_read_b64_tr_b16 a[228:229], v13 offset:27744
    v_mfma_f32_16x16x32_bf16 v[180:183], a[236:239], v[56:59], v[180:183]
    ds_read_b64_tr_b16 a[230:231], v13 offset:32352
    buffer_load_dwordx4 v5, s[8:11], s32 offen offset:3072 lds
    v_lshlrev_b32 v26, 16, v37
    v_mfma_f32_16x16x32_bf16 v[188:191], a[236:239], v[60:63], v[188:191]
    ds_read_b64_tr_b16 a[232:233], v13 offset:18560
    s_waitcnt lgkmcnt(9)
    v_mfma_f32_16x16x32_bf16 v[192:195], a[240:243], v[56:59], v[192:195]
    ds_read_b64_tr_b16 a[234:235], v13 offset:23168
    s_add_u32 m0, m0, 0x400
    s_mov_b64 exec, s[34:35]
    buffer_load_dwordx4 v6, s[8:11], s32 offen offset:3072 lds
    s_mov_b64 exec, -1
    v_mfma_f32_16x16x32_bf16 v[200:203], a[240:243], v[60:63], v[200:203]
    ds_read_b64_tr_b16 a[236:237], v13 offset:27776
    v_mfma_f32_16x16x32_bf16 v[196:199], a[244:247], v[56:59], v[196:199]
    ds_read_b64_tr_b16 a[238:239], v13 offset:32384
    s_add_u32 s32, s32, 294624
    v_and_b32 v27, s46, v37
    v_mfma_f32_16x16x32_bf16 v[204:207], a[244:247], v[60:63], v[204:207]
    ds_read_b64_tr_b16 a[240:241], v13 offset:18592
    s_waitcnt lgkmcnt(9)
    v_mfma_f32_16x16x32_bf16 v[208:211], a[248:251], v[56:59], v[208:211]
    ds_read_b64_tr_b16 a[242:243], v13 offset:23200
    v_fma_f32 v26, v26, v14, v16
    v_fma_f32 v27, v27, v14, v16
    v_mfma_f32_16x16x32_bf16 v[216:219], a[248:251], v[60:63], v[216:219]
    ds_read_b64_tr_b16 a[244:245], v13 offset:27808
    v_mfma_f32_16x16x32_bf16 v[212:215], a[252:255], v[56:59], v[212:215]
    ds_read_b64_tr_b16 a[246:247], v13 offset:32416
    v_cvt_pk_bf16_f32 v53, v26, v27
    v_lshlrev_b32 v24, 16, v38
    v_mfma_f32_16x16x32_bf16 v[220:223], a[252:255], v[60:63], v[220:223]
    ds_read_b64_tr_b16 a[248:249], v13 offset:18624
    s_waitcnt lgkmcnt(9)
    v_mfma_f32_16x16x32_bf16 v[224:227], a[224:227], v[56:59], v[224:227]
    ds_read_b64_tr_b16 a[250:251], v13 offset:23232
    v_and_b32 v25, s46, v38
    v_fma_f32 v24, v24, v14, v16
    v_mfma_f32_16x16x32_bf16 v[232:235], a[224:227], v[60:63], v[232:235]
    ds_read_b64_tr_b16 a[252:253], v13 offset:27840
    v_mfma_f32_16x16x32_bf16 v[228:231], a[228:231], v[56:59], v[228:231]
    ds_read_b64_tr_b16 a[254:255], v13 offset:32448
    v_fma_f32 v25, v25, v14, v16
    v_cvt_pk_bf16_f32 v54, v24, v25
    v_mfma_f32_16x16x32_bf16 v[236:239], a[228:231], v[60:63], v[236:239]
    ds_read_b64_tr_b16 a[224:225], v13 offset:18656
    s_waitcnt lgkmcnt(9)
    v_mfma_f32_16x16x32_bf16 v[240:243], a[232:235], v[56:59], v[240:243]
    ds_read_b64_tr_b16 a[226:227], v13 offset:23264
    v_lshlrev_b32 v26, 16, v39
    v_and_b32 v27, s46, v39
    v_mfma_f32_16x16x32_bf16 v[248:251], a[232:235], v[60:63], v[248:251]
    ds_read_b64_tr_b16 a[228:229], v13 offset:27872
    v_mfma_f32_16x16x32_bf16 v[244:247], a[236:239], v[56:59], v[244:247]
    ds_read_b64_tr_b16 a[230:231], v13 offset:32480
    v_fma_f32 v26, v26, v14, v16
    v_fma_f32 v27, v27, v14, v16
    v_mfma_f32_16x16x32_bf16 v[252:255], a[236:239], v[60:63], v[252:255]
    ds_read_b64_tr_b16 a[232:233], v13 offset:18688
    s_waitcnt lgkmcnt(9)
    v_mfma_f32_16x16x32_bf16 a[0:3], a[240:243], v[56:59], a[0:3]
    ds_read_b64_tr_b16 a[234:235], v13 offset:23296
    v_cvt_pk_bf16_f32 v55, v26, v27
    buffer_load_dwordx4 v[32:35], v18, s[16:19], s47 offen
    v_mfma_f32_16x16x32_bf16 a[8:11], a[240:243], v[60:63], a[8:11]
    ds_read_b64_tr_b16 a[236:237], v13 offset:27904
    v_mfma_f32_16x16x32_bf16 a[4:7], a[244:247], v[56:59], a[4:7]
    ds_read_b64_tr_b16 a[238:239], v13 offset:32512
    buffer_load_dwordx4 v[36:39], v19, s[16:19], s47 offen
    s_add_u32 s47, s47, 0x400
    v_mfma_f32_16x16x32_bf16 a[12:15], a[244:247], v[60:63], a[12:15]
    ds_read_b64_tr_b16 a[240:241], v13 offset:18720
    s_waitcnt lgkmcnt(9)
    v_mfma_f32_16x16x32_bf16 a[16:19], a[248:251], v[56:59], a[16:19]
    ds_read_b64_tr_b16 a[242:243], v13 offset:23328
    v_mfma_f32_16x16x32_bf16 a[24:27], a[248:251], v[60:63], a[24:27]
    ds_read_b64_tr_b16 a[244:245], v13 offset:27936
    v_mfma_f32_16x16x32_bf16 a[20:23], a[252:255], v[56:59], a[20:23]
    ds_read_b64_tr_b16 a[246:247], v13 offset:32544
    v_mfma_f32_16x16x32_bf16 a[28:31], a[252:255], v[60:63], a[28:31]
    ds_read_b64_tr_b16 a[248:249], v13 offset:18752
    s_waitcnt lgkmcnt(9)
    v_mfma_f32_16x16x32_bf16 a[32:35], a[224:227], v[56:59], a[32:35]
    ds_read_b64_tr_b16 a[250:251], v13 offset:23360
    v_mfma_f32_16x16x32_bf16 a[40:43], a[224:227], v[60:63], a[40:43]
    ds_read_b64_tr_b16 a[252:253], v13 offset:27968
    v_mfma_f32_16x16x32_bf16 a[36:39], a[228:231], v[56:59], a[36:39]
    ds_read_b64_tr_b16 a[254:255], v13 offset:32576
    v_mfma_f32_16x16x32_bf16 a[44:47], a[228:231], v[60:63], a[44:47]
    s_barrier
    v_add_u32 v12, s54, v12
    v_add_u32 v13, s54, v13
    s_sub_u32 s54, 0, s54
    ds_read_b64_tr_b16 a[224:225], v12 offset:0
    s_waitcnt lgkmcnt(9)
    v_mfma_f32_16x16x32_bf16 a[48:51], a[232:235], v[56:59], a[48:51]
    ds_read_b64_tr_b16 a[226:227], v12 offset:4608
    s_add_u32 m0, s52, 36992
    s_nop 0
    buffer_load_dwordx4 v2, s[8:11], s32 offen offset:0 lds
    v_mfma_f32_16x16x32_bf16 a[56:59], a[232:235], v[60:63], a[56:59]
    ds_read_b64_tr_b16 a[228:229], v12 offset:9216
    v_mfma_f32_16x16x32_bf16 a[52:55], a[236:239], v[56:59], a[52:55]
    ds_read_b64_tr_b16 a[230:231], v12 offset:13824
    buffer_load_dwordx4 v3, s[8:11], s32 offen offset:1024 lds
    v_mfma_f32_16x16x32_bf16 a[60:63], a[236:239], v[60:63], a[60:63]
    ds_read_b64_tr_b16 a[232:233], v12 offset:32
    s_waitcnt lgkmcnt(9)
    v_mfma_f32_16x16x32_bf16 a[64:67], a[240:243], v[56:59], a[64:67]
    ds_read_b64_tr_b16 a[234:235], v12 offset:4640
    buffer_load_dwordx4 v4, s[8:11], s32 offen offset:2048 lds
    v_mfma_f32_16x16x32_bf16 a[72:75], a[240:243], v[60:63], a[72:75]
    ds_read_b64_tr_b16 a[236:237], v12 offset:9248
    v_mfma_f32_16x16x32_bf16 a[68:71], a[244:247], v[56:59], a[68:71]
    ds_read_b64_tr_b16 a[238:239], v12 offset:13856
    buffer_load_dwordx4 v5, s[8:11], s32 offen offset:3072 lds
    v_mfma_f32_16x16x32_bf16 a[76:79], a[244:247], v[60:63], a[76:79]
    ds_read_b64_tr_b16 a[240:241], v12 offset:64
    s_waitcnt lgkmcnt(9)
    v_mfma_f32_16x16x32_bf16 a[80:83], a[248:251], v[56:59], a[80:83]
    ds_read_b64_tr_b16 a[242:243], v12 offset:4672
    s_add_u32 m0, m0, 0x400
    s_mov_b64 exec, s[34:35]
    buffer_load_dwordx4 v6, s[8:11], s32 offen offset:3072 lds
    s_mov_b64 exec, -1
    v_mfma_f32_16x16x32_bf16 a[88:91], a[248:251], v[60:63], a[88:91]
    ds_read_b64_tr_b16 a[244:245], v12 offset:9280
    v_mfma_f32_16x16x32_bf16 a[84:87], a[252:255], v[56:59], a[84:87]
    ds_read_b64_tr_b16 a[246:247], v12 offset:13888
    s_add_u32 s32, s32, 288
    v_mfma_f32_16x16x32_bf16 a[92:95], a[252:255], v[60:63], a[92:95]
    ds_read_b64_tr_b16 a[248:249], v12 offset:96
    s_waitcnt lgkmcnt(9)
    v_mfma_f32_16x16x32_bf16 v[64:67], a[224:227], v[48:51], v[64:67]
    ds_read_b64_tr_b16 a[250:251], v12 offset:4704
    s_waitcnt vmcnt(17)
    v_lshlrev_b32 v24, 16, v40
    v_mfma_f32_16x16x32_bf16 v[72:75], a[224:227], v[52:55], v[72:75]
    ds_read_b64_tr_b16 a[252:253], v12 offset:9312
    v_mfma_f32_16x16x32_bf16 v[68:71], a[228:231], v[48:51], v[68:71]
    ds_read_b64_tr_b16 a[254:255], v12 offset:13920
    v_and_b32 v25, s46, v40
    v_fma_f32 v24, v24, v20, v22
    v_mfma_f32_16x16x32_bf16 v[76:79], a[228:231], v[52:55], v[76:79]
    ds_read_b64_tr_b16 a[224:225], v12 offset:128
    s_waitcnt lgkmcnt(9)
    v_mfma_f32_16x16x32_bf16 v[80:83], a[232:235], v[48:51], v[80:83]
    ds_read_b64_tr_b16 a[226:227], v12 offset:4736
    v_fma_f32 v25, v25, v20, v22
    v_cvt_pk_bf16_f32 v56, v24, v25
    v_mfma_f32_16x16x32_bf16 v[88:91], a[232:235], v[52:55], v[88:91]
    ds_read_b64_tr_b16 a[228:229], v12 offset:9344
    v_mfma_f32_16x16x32_bf16 v[84:87], a[236:239], v[48:51], v[84:87]
    ds_read_b64_tr_b16 a[230:231], v12 offset:13952
    v_lshlrev_b32 v26, 16, v41
    v_and_b32 v27, s46, v41
    v_mfma_f32_16x16x32_bf16 v[92:95], a[236:239], v[52:55], v[92:95]
    ds_read_b64_tr_b16 a[232:233], v12 offset:160
    s_waitcnt lgkmcnt(9)
    v_mfma_f32_16x16x32_bf16 v[96:99], a[240:243], v[48:51], v[96:99]
    ds_read_b64_tr_b16 a[234:235], v12 offset:4768
    v_fma_f32 v26, v26, v20, v22
    v_fma_f32 v27, v27, v20, v22
    v_mfma_f32_16x16x32_bf16 v[104:107], a[240:243], v[52:55], v[104:107]
    ds_read_b64_tr_b16 a[236:237], v12 offset:9376
    v_mfma_f32_16x16x32_bf16 v[100:103], a[244:247], v[48:51], v[100:103]
    ds_read_b64_tr_b16 a[238:239], v12 offset:13984
    v_cvt_pk_bf16_f32 v57, v26, v27
    v_lshlrev_b32 v24, 16, v42
    v_mfma_f32_16x16x32_bf16 v[108:111], a[244:247], v[52:55], v[108:111]
    ds_read_b64_tr_b16 a[240:241], v12 offset:192
    s_waitcnt lgkmcnt(9)
    v_mfma_f32_16x16x32_bf16 v[112:115], a[248:251], v[48:51], v[112:115]
    ds_read_b64_tr_b16 a[242:243], v12 offset:4800
    v_and_b32 v25, s46, v42
    v_fma_f32 v24, v24, v20, v22
    v_mfma_f32_16x16x32_bf16 v[120:123], a[248:251], v[52:55], v[120:123]
    ds_read_b64_tr_b16 a[244:245], v12 offset:9408
    v_mfma_f32_16x16x32_bf16 v[116:119], a[252:255], v[48:51], v[116:119]
    ds_read_b64_tr_b16 a[246:247], v12 offset:14016
    v_fma_f32 v25, v25, v20, v22
    v_cvt_pk_bf16_f32 v58, v24, v25
    v_mfma_f32_16x16x32_bf16 v[124:127], a[252:255], v[52:55], v[124:127]
    ds_read_b64_tr_b16 a[248:249], v12 offset:224
    s_waitcnt lgkmcnt(9)
    v_mfma_f32_16x16x32_bf16 v[128:131], a[224:227], v[48:51], v[128:131]
    ds_read_b64_tr_b16 a[250:251], v12 offset:4832
    v_lshlrev_b32 v26, 16, v43
    v_and_b32 v27, s46, v43
    v_mfma_f32_16x16x32_bf16 v[136:139], a[224:227], v[52:55], v[136:139]
    ds_read_b64_tr_b16 a[252:253], v12 offset:9440
    v_mfma_f32_16x16x32_bf16 v[132:135], a[228:231], v[48:51], v[132:135]
    ds_read_b64_tr_b16 a[254:255], v12 offset:14048
    v_fma_f32 v26, v26, v20, v22
    v_fma_f32 v27, v27, v20, v22
    v_mfma_f32_16x16x32_bf16 v[140:143], a[228:231], v[52:55], v[140:143]
    ds_read_b64_tr_b16 a[224:225], v12 offset:256
    s_waitcnt lgkmcnt(9)
    v_mfma_f32_16x16x32_bf16 v[144:147], a[232:235], v[48:51], v[144:147]
    ds_read_b64_tr_b16 a[226:227], v12 offset:4864
    v_cvt_pk_bf16_f32 v59, v26, v27
    v_lshlrev_b32 v24, 16, v44
    v_mfma_f32_16x16x32_bf16 v[152:155], a[232:235], v[52:55], v[152:155]
    ds_read_b64_tr_b16 a[228:229], v12 offset:9472
    v_mfma_f32_16x16x32_bf16 v[148:151], a[236:239], v[48:51], v[148:151]
    ds_read_b64_tr_b16 a[230:231], v12 offset:14080
    v_and_b32 v25, s46, v44
    v_fma_f32 v24, v24, v14, v16
    v_mfma_f32_16x16x32_bf16 v[156:159], a[236:239], v[52:55], v[156:159]
    s_barrier
    ds_read_b64_tr_b16 a[232:233], v12 offset:18496
    s_waitcnt lgkmcnt(9)
    v_mfma_f32_16x16x32_bf16 v[160:163], a[240:243], v[48:51], v[160:163]
    ds_read_b64_tr_b16 a[234:235], v12 offset:23104
    s_add_u32 m0, s52, 55488
    s_nop 0
    buffer_load_dwordx4 v2, s[8:11], s32 offen offset:0 lds
    v_mfma_f32_16x16x32_bf16 v[168:171], a[240:243], v[52:55], v[168:171]
    ds_read_b64_tr_b16 a[236:237], v12 offset:27712
    v_mfma_f32_16x16x32_bf16 v[164:167], a[244:247], v[48:51], v[164:167]
    ds_read_b64_tr_b16 a[238:239], v12 offset:32320
    buffer_load_dwordx4 v3, s[8:11], s32 offen offset:1024 lds
    v_fma_f32 v25, v25, v14, v16
    v_mfma_f32_16x16x32_bf16 v[172:175], a[244:247], v[52:55], v[172:175]
    ds_read_b64_tr_b16 a[240:241], v12 offset:18528
    s_waitcnt lgkmcnt(9)
    v_mfma_f32_16x16x32_bf16 v[176:179], a[248:251], v[48:51], v[176:179]
    ds_read_b64_tr_b16 a[242:243], v12 offset:23136
    buffer_load_dwordx4 v4, s[8:11], s32 offen offset:2048 lds
    v_cvt_pk_bf16_f32 v60, v24, v25
    v_mfma_f32_16x16x32_bf16 v[184:187], a[248:251], v[52:55], v[184:187]
    ds_read_b64_tr_b16 a[244:245], v12 offset:27744
    v_mfma_f32_16x16x32_bf16 v[180:183], a[252:255], v[48:51], v[180:183]
    ds_read_b64_tr_b16 a[246:247], v12 offset:32352
    buffer_load_dwordx4 v5, s[8:11], s32 offen offset:3072 lds
    v_lshlrev_b32 v26, 16, v45
    v_mfma_f32_16x16x32_bf16 v[188:191], a[252:255], v[52:55], v[188:191]
    ds_read_b64_tr_b16 a[248:249], v12 offset:18560
    s_waitcnt lgkmcnt(9)
    v_mfma_f32_16x16x32_bf16 v[192:195], a[224:227], v[48:51], v[192:195]
    ds_read_b64_tr_b16 a[250:251], v12 offset:23168
    s_add_u32 m0, m0, 0x400
    s_mov_b64 exec, s[34:35]
    buffer_load_dwordx4 v6, s[8:11], s32 offen offset:3072 lds
    s_mov_b64 exec, -1
    v_mfma_f32_16x16x32_bf16 v[200:203], a[224:227], v[52:55], v[200:203]
    ds_read_b64_tr_b16 a[252:253], v12 offset:27776
    v_mfma_f32_16x16x32_bf16 v[196:199], a[228:231], v[48:51], v[196:199]
    ds_read_b64_tr_b16 a[254:255], v12 offset:32384
    s_add_u32 s32, s32, 294624
    v_and_b32 v27, s46, v45
    v_mfma_f32_16x16x32_bf16 v[204:207], a[228:231], v[52:55], v[204:207]
    s_sub_u32 s55, s55, 1
    s_cbranch_scc0 L_k3_loop
    ds_read_b64_tr_b16 a[224:225], v12 offset:18592
    s_waitcnt lgkmcnt(9)
    v_mfma_f32_16x16x32_bf16 v[208:211], a[232:235], v[48:51], v[208:211]
    ds_read_b64_tr_b16 a[226:227], v12 offset:23200
    v_fma_f32 v26, v26, v14, v16
    v_fma_f32 v27, v27, v14, v16
    v_mfma_f32_16x16x32_bf16 v[216:219], a[232:235], v[52:55], v[216:219]
    ds_read_b64_tr_b16 a[228:229], v12 offset:27808
    v_mfma_f32_16x16x32_bf16 v[212:215], a[236:239], v[48:51], v[212:215]
    ds_read_b64_tr_b16 a[230:231], v12 offset:32416
    v_cvt_pk_bf16_f32 v61, v26, v27
    v_lshlrev_b32 v24, 16, v46
    v_mfma_f32_16x16x32_bf16 v[220:223], a[236:239], v[52:55], v[220:223]
    ds_read_b64_tr_b16 a[232:233], v12 offset:18624
    s_waitcnt lgkmcnt(9)
    v_mfma_f32_16x16x32_bf16 v[224:227], a[240:243], v[48:51], v[224:227]
    ds_read_b64_tr_b16 a[234:235], v12 offset:23232
    v_and_b32 v25, s46, v46
    v_fma_f32 v24, v24, v14, v16
    v_mfma_f32_16x16x32_bf16 v[232:235], a[240:243], v[52:55], v[232:235]
    ds_read_b64_tr_b16 a[236:237], v12 offset:27840
    v_mfma_f32_16x16x32_bf16 v[228:231], a[244:247], v[48:51], v[228:231]
    ds_read_b64_tr_b16 a[238:239], v12 offset:32448
    v_fma_f32 v25, v25, v14, v16
    v_cvt_pk_bf16_f32 v62, v24, v25
    v_mfma_f32_16x16x32_bf16 v[236:239], a[244:247], v[52:55], v[236:239]
    ds_read_b64_tr_b16 a[240:241], v12 offset:18656
    s_waitcnt lgkmcnt(9)
    v_mfma_f32_16x16x32_bf16 v[240:243], a[248:251], v[48:51], v[240:243]
    ds_read_b64_tr_b16 a[242:243], v12 offset:23264
    v_lshlrev_b32 v26, 16, v47
    v_and_b32 v27, s46, v47
    v_mfma_f32_16x16x32_bf16 v[248:251], a[248:251], v[52:55], v[248:251]
    ds_read_b64_tr_b16 a[244:245], v12 offset:27872
    v_mfma_f32_16x16x32_bf16 v[244:247], a[252:255], v[48:51], v[244:247]
    ds_read_b64_tr_b16 a[246:247], v12 offset:32480
    v_fma_f32 v26, v26, v14, v16
    v_fma_f32 v27, v27, v14, v16
    v_mfma_f32_16x16x32_bf16 v[252:255], a[252:255], v[52:55], v[252:255]
    ds_read_b64_tr_b16 a[248:249], v12 offset:18688
    s_waitcnt lgkmcnt(9)
    v_mfma_f32_16x16x32_bf16 a[0:3], a[224:227], v[48:51], a[0:3]
    ds_read_b64_tr_b16 a[250:251], v12 offset:23296
    v_cvt_pk_bf16_f32 v63, v26, v27
    buffer_load_dwordx4 v[40:43], v18, s[16:19], s47 offen
    v_mfma_f32_16x16x32_bf16 a[8:11], a[224:227], v[52:55], a[8:11]
    ds_read_b64_tr_b16 a[252:253], v12 offset:27904
    v_mfma_f32_16x16x32_bf16 a[4:7], a[228:231], v[48:51], a[4:7]
    ds_read_b64_tr_b16 a[254:255], v12 offset:32512
    buffer_load_dwordx4 v[44:47], v19, s[16:19], s47 offen
    s_add_u32 s47, s47, 0x400
    v_mfma_f32_16x16x32_bf16 a[12:15], a[228:231], v[52:55], a[12:15]
    ds_read_b64_tr_b16 a[224:225], v12 offset:18720
    s_waitcnt lgkmcnt(9)
    v_mfma_f32_16x16x32_bf16 a[16:19], a[232:235], v[48:51], a[16:19]
    ds_read_b64_tr_b16 a[226:227], v12 offset:23328
    v_mfma_f32_16x16x32_bf16 a[24:27], a[232:235], v[52:55], a[24:27]
    ds_read_b64_tr_b16 a[228:229], v12 offset:27936
    v_mfma_f32_16x16x32_bf16 a[20:23], a[236:239], v[48:51], a[20:23]
    ds_read_b64_tr_b16 a[230:231], v12 offset:32544
    v_mfma_f32_16x16x32_bf16 a[28:31], a[236:239], v[52:55], a[28:31]
    ds_read_b64_tr_b16 a[232:233], v12 offset:18752
    s_waitcnt lgkmcnt(9)
    v_mfma_f32_16x16x32_bf16 a[32:35], a[240:243], v[48:51], a[32:35]
    ds_read_b64_tr_b16 a[234:235], v12 offset:23360
    v_mfma_f32_16x16x32_bf16 a[40:43], a[240:243], v[52:55], a[40:43]
    ds_read_b64_tr_b16 a[236:237], v12 offset:27968
    v_mfma_f32_16x16x32_bf16 a[36:39], a[244:247], v[48:51], a[36:39]
    ds_read_b64_tr_b16 a[238:239], v12 offset:32576
    v_mfma_f32_16x16x32_bf16 a[44:47], a[244:247], v[52:55], a[44:47]
    s_barrier
    ds_read_b64_tr_b16 a[240:241], v13 offset:0
    s_waitcnt lgkmcnt(9)
    v_mfma_f32_16x16x32_bf16 a[48:51], a[248:251], v[48:51], a[48:51]
    ds_read_b64_tr_b16 a[242:243], v13 offset:4608
    s_sub_u32 s52, s53, s52
    s_add_u32 m0, s52, 0
    s_mov_b32 s32, 4718592
    buffer_load_dwordx4 v2, s[8:11], s32 offen offset:0 lds
    v_mfma_f32_16x16x32_bf16 a[56:59], a[248:251], v[52:55], a[56:59]
    ds_read_b64_tr_b16 a[244:245], v13 offset:9216
    v_mfma_f32_16x16x32_bf16 a[52:55], a[252:255], v[48:51], a[52:55]
    ds_read_b64_tr_b16 a[246:247], v13 offset:13824
    buffer_load_dwordx4 v3, s[8:11], s32 offen offset:1024 lds
    v_mfma_f32_16x16x32_bf16 a[60:63], a[252:255], v[52:55], a[60:63]
    ds_read_b64_tr_b16 a[248:249], v13 offset:32
    s_waitcnt lgkmcnt(9)
    v_mfma_f32_16x16x32_bf16 a[64:67], a[224:227], v[48:51], a[64:67]
    ds_read_b64_tr_b16 a[250:251], v13 offset:4640
    buffer_load_dwordx4 v4, s[8:11], s32 offen offset:2048 lds
    v_mfma_f32_16x16x32_bf16 a[72:75], a[224:227], v[52:55], a[72:75]
    ds_read_b64_tr_b16 a[252:253], v13 offset:9248
    v_mfma_f32_16x16x32_bf16 a[68:71], a[228:231], v[48:51], a[68:71]
    ds_read_b64_tr_b16 a[254:255], v13 offset:13856
    buffer_load_dwordx4 v5, s[8:11], s32 offen offset:3072 lds
    v_mfma_f32_16x16x32_bf16 a[76:79], a[228:231], v[52:55], a[76:79]
    ds_read_b64_tr_b16 a[224:225], v13 offset:64
    s_waitcnt lgkmcnt(9)
    v_mfma_f32_16x16x32_bf16 a[80:83], a[232:235], v[48:51], a[80:83]
    ds_read_b64_tr_b16 a[226:227], v13 offset:4672
    s_add_u32 m0, m0, 0x400
    s_mov_b64 exec, s[34:35]
    buffer_load_dwordx4 v6, s[8:11], s32 offen offset:3072 lds
    s_mov_b64 exec, -1
    v_mfma_f32_16x16x32_bf16 a[88:91], a[232:235], v[52:55], a[88:91]
    ds_read_b64_tr_b16 a[228:229], v13 offset:9280
    v_mfma_f32_16x16x32_bf16 a[84:87], a[236:239], v[48:51], a[84:87]
    ds_read_b64_tr_b16 a[230:231], v13 offset:13888
    v_mfma_f32_16x16x32_bf16 a[92:95], a[236:239], v[52:55], a[92:95]
    ds_read_b64_tr_b16 a[232:233], v13 offset:96
    s_waitcnt lgkmcnt(9)
    v_mfma_f32_16x16x32_bf16 v[64:67], a[240:243], v[56:59], v[64:67]
    ds_read_b64_tr_b16 a[234:235], v13 offset:4704
    s_waitcnt vmcnt(17)
    v_lshlrev_b32 v24, 16, v32
    v_mfma_f32_16x16x32_bf16 v[72:75], a[240:243], v[60:63], v[72:75]
    ds_read_b64_tr_b16 a[236:237], v13 offset:9312
    v_mfma_f32_16x16x32_bf16 v[68:71], a[244:247], v[56:59], v[68:71]
    ds_read_b64_tr_b16 a[238:239], v13 offset:13920
    v_and_b32 v25, s46, v32
    v_fma_f32 v24, v24, v20, v22
    v_mfma_f32_16x16x32_bf16 v[76:79], a[244:247], v[60:63], v[76:79]
    ds_read_b64_tr_b16 a[240:241], v13 offset:128
    s_waitcnt lgkmcnt(9)
    v_mfma_f32_16x16x32_bf16 v[80:83], a[248:251], v[56:59], v[80:83]
    ds_read_b64_tr_b16 a[242:243], v13 offset:4736
    v_fma_f32 v25, v25, v20, v22
    v_cvt_pk_bf16_f32 v48, v24, v25
    v_mfma_f32_16x16x32_bf16 v[88:91], a[248:251], v[60:63], v[88:91]
    ds_read_b64_tr_b16 a[244:245], v13 offset:9344
    v_mfma_f32_16x16x32_bf16 v[84:87], a[252:255], v[56:59], v[84:87]
    ds_read_b64_tr_b16 a[246:247], v13 offset:13952
    v_lshlrev_b32 v26, 16, v33
    v_and_b32 v27, s46, v33
    v_mfma_f32_16x16x32_bf16 v[92:95], a[252:255], v[60:63], v[92:95]
    ds_read_b64_tr_b16 a[248:249], v13 offset:160
    s_waitcnt lgkmcnt(9)
    v_mfma_f32_16x16x32_bf16 v[96:99], a[224:227], v[56:59], v[96:99]
    ds_read_b64_tr_b16 a[250:251], v13 offset:4768
    v_fma_f32 v26, v26, v20, v22
    v_fma_f32 v27, v27, v20, v22
    v_mfma_f32_16x16x32_bf16 v[104:107], a[224:227], v[60:63], v[104:107]
    ds_read_b64_tr_b16 a[252:253], v13 offset:9376
    v_mfma_f32_16x16x32_bf16 v[100:103], a[228:231], v[56:59], v[100:103]
    ds_read_b64_tr_b16 a[254:255], v13 offset:13984
    v_cvt_pk_bf16_f32 v49, v26, v27
    v_lshlrev_b32 v24, 16, v34
    v_mfma_f32_16x16x32_bf16 v[108:111], a[228:231], v[60:63], v[108:111]
    ds_read_b64_tr_b16 a[224:225], v13 offset:192
    s_waitcnt lgkmcnt(9)
    v_mfma_f32_16x16x32_bf16 v[112:115], a[232:235], v[56:59], v[112:115]
    ds_read_b64_tr_b16 a[226:227], v13 offset:4800
    v_and_b32 v25, s46, v34
    v_fma_f32 v24, v24, v20, v22
    v_mfma_f32_16x16x32_bf16 v[120:123], a[232:235], v[60:63], v[120:123]
    ds_read_b64_tr_b16 a[228:229], v13 offset:9408
    v_mfma_f32_16x16x32_bf16 v[116:119], a[236:239], v[56:59], v[116:119]
    ds_read_b64_tr_b16 a[230:231], v13 offset:14016
    v_fma_f32 v25, v25, v20, v22
    v_cvt_pk_bf16_f32 v50, v24, v25
    v_mfma_f32_16x16x32_bf16 v[124:127], a[236:239], v[60:63], v[124:127]
    ds_read_b64_tr_b16 a[232:233], v13 offset:224
    s_waitcnt lgkmcnt(9)
    v_mfma_f32_16x16x32_bf16 v[128:131], a[240:243], v[56:59], v[128:131]
    ds_read_b64_tr_b16 a[234:235], v13 offset:4832
    v_lshlrev_b32 v26, 16, v35
    v_and_b32 v27, s46, v35
    v_mfma_f32_16x16x32_bf16 v[136:139], a[240:243], v[60:63], v[136:139]
    ds_read_b64_tr_b16 a[236:237], v13 offset:9440
    v_mfma_f32_16x16x32_bf16 v[132:135], a[244:247], v[56:59], v[132:135]
    ds_read_b64_tr_b16 a[238:239], v13 offset:14048
    v_fma_f32 v26, v26, v20, v22
    v_fma_f32 v27, v27, v20, v22
    v_mfma_f32_16x16x32_bf16 v[140:143], a[244:247], v[60:63], v[140:143]
    ds_read_b64_tr_b16 a[240:241], v13 offset:256
    s_waitcnt lgkmcnt(9)
    v_mfma_f32_16x16x32_bf16 v[144:147], a[248:251], v[56:59], v[144:147]
    ds_read_b64_tr_b16 a[242:243], v13 offset:4864
    v_cvt_pk_bf16_f32 v51, v26, v27
    v_lshlrev_b32 v24, 16, v36
    v_mfma_f32_16x16x32_bf16 v[152:155], a[248:251], v[60:63], v[152:155]
    ds_read_b64_tr_b16 a[244:245], v13 offset:9472
    v_mfma_f32_16x16x32_bf16 v[148:151], a[252:255], v[56:59], v[148:151]
    ds_read_b64_tr_b16 a[246:247], v13 offset:14080
    v_and_b32 v25, s46, v36
    v_fma_f32 v24, v24, v14, v16
    v_mfma_f32_16x16x32_bf16 v[156:159], a[252:255], v[60:63], v[156:159]
    s_barrier
    ds_read_b64_tr_b16 a[248:249], v13 offset:18496
    s_waitcnt lgkmcnt(9)
    v_mfma_f32_16x16x32_bf16 v[160:163], a[224:227], v[56:59], v[160:163]
    ds_read_b64_tr_b16 a[250:251], v13 offset:23104
    s_add_u32 m0, s52, 18496
    s_mov_b32 s32, 5013504
    buffer_load_dwordx4 v2, s[8:11], s32 offen offset:0 lds
    v_mfma_f32_16x16x32_bf16 v[168:171], a[224:227], v[60:63], v[168:171]
    ds_read_b64_tr_b16 a[252:253], v13 offset:27712
    v_mfma_f32_16x16x32_bf16 v[164:167], a[228:231], v[56:59], v[164:167]
    ds_read_b64_tr_b16 a[254:255], v13 offset:32320
    buffer_load_dwordx4 v3, s[8:11], s32 offen offset:1024 lds
    v_fma_f32 v25, v25, v14, v16
    v_mfma_f32_16x16x32_bf16 v[172:175], a[228:231], v[60:63], v[172:175]
    ds_read_b64_tr_b16 a[224:225], v13 offset:18528
    s_waitcnt lgkmcnt(9)
    v_mfma_f32_16x16x32_bf16 v[176:179], a[232:235], v[56:59], v[176:179]
    ds_read_b64_tr_b16 a[226:227], v13 offset:23136
    buffer_load_dwordx4 v4, s[8:11], s32 offen offset:2048 lds
    v_cvt_pk_bf16_f32 v52, v24, v25
    v_mfma_f32_16x16x32_bf16 v[184:187], a[232:235], v[60:63], v[184:187]
    ds_read_b64_tr_b16 a[228:229], v13 offset:27744
    v_mfma_f32_16x16x32_bf16 v[180:183], a[236:239], v[56:59], v[180:183]
    ds_read_b64_tr_b16 a[230:231], v13 offset:32352
    buffer_load_dwordx4 v5, s[8:11], s32 offen offset:3072 lds
    v_lshlrev_b32 v26, 16, v37
    v_mfma_f32_16x16x32_bf16 v[188:191], a[236:239], v[60:63], v[188:191]
    ds_read_b64_tr_b16 a[232:233], v13 offset:18560
    s_waitcnt lgkmcnt(9)
    v_mfma_f32_16x16x32_bf16 v[192:195], a[240:243], v[56:59], v[192:195]
    ds_read_b64_tr_b16 a[234:235], v13 offset:23168
    s_add_u32 m0, m0, 0x400
    s_mov_b64 exec, s[34:35]
    buffer_load_dwordx4 v6, s[8:11], s32 offen offset:3072 lds
    s_mov_b64 exec, -1
    v_mfma_f32_16x16x32_bf16 v[200:203], a[240:243], v[60:63], v[200:203]
    ds_read_b64_tr_b16 a[236:237], v13 offset:27776
    v_mfma_f32_16x16x32_bf16 v[196:199], a[244:247], v[56:59], v[196:199]
    ds_read_b64_tr_b16 a[238:239], v13 offset:32384
    v_and_b32 v27, s46, v37
    v_fma_f32 v26, v26, v14, v16
    v_mfma_f32_16x16x32_bf16 v[204:207], a[244:247], v[60:63], v[204:207]
    ds_read_b64_tr_b16 a[240:241], v13 offset:18592
    s_waitcnt lgkmcnt(9)
    v_mfma_f32_16x16x32_bf16 v[208:211], a[248:251], v[56:59], v[208:211]
    ds_read_b64_tr_b16 a[242:243], v13 offset:23200
    v_fma_f32 v27, v27, v14, v16
    v_cvt_pk_bf16_f32 v53, v26, v27
    v_mfma_f32_16x16x32_bf16 v[216:219], a[248:251], v[60:63], v[216:219]
    ds_read_b64_tr_b16 a[244:245], v13 offset:27808
    v_mfma_f32_16x16x32_bf16 v[212:215], a[252:255], v[56:59], v[212:215]
    ds_read_b64_tr_b16 a[246:247], v13 offset:32416
    v_lshlrev_b32 v24, 16, v38
    v_and_b32 v25, s46, v38
    v_mfma_f32_16x16x32_bf16 v[220:223], a[252:255], v[60:63], v[220:223]
    ds_read_b64_tr_b16 a[248:249], v13 offset:18624
    s_waitcnt lgkmcnt(9)
    v_mfma_f32_16x16x32_bf16 v[224:227], a[224:227], v[56:59], v[224:227]
    ds_read_b64_tr_b16 a[250:251], v13 offset:23232
    v_fma_f32 v24, v24, v14, v16
    v_fma_f32 v25, v25, v14, v16
    v_mfma_f32_16x16x32_bf16 v[232:235], a[224:227], v[60:63], v[232:235]
    ds_read_b64_tr_b16 a[252:253], v13 offset:27840
    v_mfma_f32_16x16x32_bf16 v[228:231], a[228:231], v[56:59], v[228:231]
    ds_read_b64_tr_b16 a[254:255], v13 offset:32448
    v_cvt_pk_bf16_f32 v54, v24, v25
    v_lshlrev_b32 v26, 16, v39
    v_mfma_f32_16x16x32_bf16 v[236:239], a[228:231], v[60:63], v[236:239]
    ds_read_b64_tr_b16 a[224:225], v13 offset:18656
    s_waitcnt lgkmcnt(9)
    v_mfma_f32_16x16x32_bf16 v[240:243], a[232:235], v[56:59], v[240:243]
    ds_read_b64_tr_b16 a[226:227], v13 offset:23264
    v_and_b32 v27, s46, v39
    v_fma_f32 v26, v26, v14, v16
    v_mfma_f32_16x16x32_bf16 v[248:251], a[232:235], v[60:63], v[248:251]
    ds_read_b64_tr_b16 a[228:229], v13 offset:27872
    v_mfma_f32_16x16x32_bf16 v[244:247], a[236:239], v[56:59], v[244:247]
    ds_read_b64_tr_b16 a[230:231], v13 offset:32480
    v_fma_f32 v27, v27, v14, v16
    v_cvt_pk_bf16_f32 v55, v26, v27
    v_mfma_f32_16x16x32_bf16 v[252:255], a[236:239], v[60:63], v[252:255]
    ds_read_b64_tr_b16 a[232:233], v13 offset:18688
    s_waitcnt lgkmcnt(9)
    v_mfma_f32_16x16x32_bf16 a[0:3], a[240:243], v[56:59], a[0:3]
    ds_read_b64_tr_b16 a[234:235], v13 offset:23296
    buffer_load_dwordx4 v[32:35], v18, s[16:19], s47 offen
    buffer_load_dwordx4 v[36:39], v19, s[16:19], s47 offen
    v_mfma_f32_16x16x32_bf16 a[8:11], a[240:243], v[60:63], a[8:11]
    ds_read_b64_tr_b16 a[236:237], v13 offset:27904
    v_mfma_f32_16x16x32_bf16 a[4:7], a[244:247], v[56:59], a[4:7]
    ds_read_b64_tr_b16 a[238:239], v13 offset:32512
    s_add_u32 s47, s47, 0x400
    v_mfma_f32_16x16x32_bf16 a[12:15], a[244:247], v[60:63], a[12:15]
    ds_read_b64_tr_b16 a[240:241], v13 offset:18720
    s_waitcnt lgkmcnt(9)
    v_mfma_f32_16x16x32_bf16 a[16:19], a[248:251], v[56:59], a[16:19]
    ds_read_b64_tr_b16 a[242:243], v13 offset:23328
    v_mfma_f32_16x16x32_bf16 a[24:27], a[248:251], v[60:63], a[24:27]
    ds_read_b64_tr_b16 a[244:245], v13 offset:27936
    v_mfma_f32_16x16x32_bf16 a[20:23], a[252:255], v[56:59], a[20:23]
    ds_read_b64_tr_b16 a[246:247], v13 offset:32544
    v_mfma_f32_16x16x32_bf16 a[28:31], a[252:255], v[60:63], a[28:31]
    ds_read_b64_tr_b16 a[248:249], v13 offset:18752
    s_waitcnt lgkmcnt(9)
    v_mfma_f32_16x16x32_bf16 a[32:35], a[224:227], v[56:59], a[32:35]
    ds_read_b64_tr_b16 a[250:251], v13 offset:23360
    v_mfma_f32_16x16x32_bf16 a[40:43], a[224:227], v[60:63], a[40:43]
    ds_read_b64_tr_b16 a[252:253], v13 offset:27968
    v_mfma_f32_16x16x32_bf16 a[36:39], a[228:231], v[56:59], a[36:39]
    ds_read_b64_tr_b16 a[254:255], v13 offset:32576
    v_mfma_f32_16x16x32_bf16 a[44:47], a[228:231], v[60:63], a[44:47]
    s_barrier
    v_add_u32 v12, s54, v12
    v_add_u32 v13, s54, v13
    s_sub_u32 s54, 0, s54
    ds_read_b64_tr_b16 a[224:225], v12 offset:0
    s_waitcnt lgkmcnt(9)
    v_mfma_f32_16x16x32_bf16 a[48:51], a[232:235], v[56:59], a[48:51]
    ds_read_b64_tr_b16 a[226:227], v12 offset:4608
    s_add_u32 m0, s52, 36992
    s_mov_b32 s32, 4718880
    buffer_load_dwordx4 v2, s[8:11], s32 offen offset:0 lds
    v_mfma_f32_16x16x32_bf16 a[56:59], a[232:235], v[60:63], a[56:59]
    ds_read_b64_tr_b16 a[228:229], v12 offset:9216
    v_mfma_f32_16x16x32_bf16 a[52:55], a[236:239], v[56:59], a[52:55]
    ds_read_b64_tr_b16 a[230:231], v12 offset:13824
    buffer_load_dwordx4 v3, s[8:11], s32 offen offset:1024 lds
    v_mfma_f32_16x16x32_bf16 a[60:63], a[236:239], v[60:63], a[60:63]
    ds_read_b64_tr_b16 a[232:233], v12 offset:32
    s_waitcnt lgkmcnt(9)
    v_mfma_f32_16x16x32_bf16 a[64:67], a[240:243], v[56:59], a[64:67]
    ds_read_b64_tr_b16 a[234:235], v12 offset:4640
    buffer_load_dwordx4 v4, s[8:11], s32 offen offset:2048 lds
    v_mfma_f32_16x16x32_bf16 a[72:75], a[240:243], v[60:63], a[72:75]
    ds_read_b64_tr_b16 a[236:237], v12 offset:9248
    v_mfma_f32_16x16x32_bf16 a[68:71], a[244:247], v[56:59], a[68:71]
    ds_read_b64_tr_b16 a[238:239], v12 offset:13856
    buffer_load_dwordx4 v5, s[8:11], s32 offen offset:3072 lds
    v_mfma_f32_16x16x32_bf16 a[76:79], a[244:247], v[60:63], a[76:79]
    ds_read_b64_tr_b16 a[240:241], v12 offset:64
    s_waitcnt lgkmcnt(9)
    v_mfma_f32_16x16x32_bf16 a[80:83], a[248:251], v[56:59], a[80:83]
    ds_read_b64_tr_b16 a[242:243], v12 offset:4672
    s_add_u32 m0, m0, 0x400
    s_mov_b64 exec, s[34:35]
    buffer_load_dwordx4 v6, s[8:11], s32 offen offset:3072 lds
    s_mov_b64 exec, -1
    v_mfma_f32_16x16x32_bf16 a[88:91], a[248:251], v[60:63], a[88:91]
    ds_read_b64_tr_b16 a[244:245], v12 offset:9280
    v_mfma_f32_16x16x32_bf16 a[84:87], a[252:255], v[56:59], a[84:87]
    ds_read_b64_tr_b16 a[246:247], v12 offset:13888
    v_mfma_f32_16x16x32_bf16 a[92:95], a[252:255], v[60:63], a[92:95]
    ds_read_b64_tr_b16 a[248:249], v12 offset:96
    s_waitcnt lgkmcnt(9)
    v_mfma_f32_16x16x32_bf16 v[64:67], a[224:227], v[48:51], v[64:67]
    ds_read_b64_tr_b16 a[250:251], v12 offset:4704
    s_waitcnt vmcnt(17)
    v_lshlrev_b32 v24, 16, v40
    v_mfma_f32_16x16x32_bf16 v[72:75], a[224:227], v[52:55], v[72:75]
    ds_read_b64_tr_b16 a[252:253], v12 offset:9312
    v_mfma_f32_16x16x32_bf16 v[68:71], a[228:231], v[48:51], v[68:71]
    ds_read_b64_tr_b16 a[254:255], v12 offset:13920
    v_and_b32 v25, s46, v40
    v_fma_f32 v24, v24, v20, v22
    v_mfma_f32_16x16x32_bf16 v[76:79], a[228:231], v[52:55], v[76:79]
    ds_read_b64_tr_b16 a[224:225], v12 offset:128
    s_waitcnt lgkmcnt(9)
    v_mfma_f32_16x16x32_bf16 v[80:83], a[232:235], v[48:51], v[80:83]
    ds_read_b64_tr_b16 a[226:227], v12 offset:4736
    v_fma_f32 v25, v25, v20, v22
    v_cvt_pk_bf16_f32 v56, v24, v25
    v_mfma_f32_16x16x32_bf16 v[88:91], a[232:235], v[52:55], v[88:91]
    ds_read_b64_tr_b16 a[228:229], v12 offset:9344
    v_mfma_f32_16x16x32_bf16 v[84:87], a[236:239], v[48:51], v[84:87]
    ds_read_b64_tr_b16 a[230:231], v12 offset:13952
    v_lshlrev_b32 v26, 16, v41
    v_and_b32 v27, s46, v41
    v_mfma_f32_16x16x32_bf16 v[92:95], a[236:239], v[52:55], v[92:95]
    ds_read_b64_tr_b16 a[232:233], v12 offset:160
    s_waitcnt lgkmcnt(9)
    v_mfma_f32_16x16x32_bf16 v[96:99], a[240:243], v[48:51], v[96:99]
    ds_read_b64_tr_b16 a[234:235], v12 offset:4768
    v_fma_f32 v26, v26, v20, v22
    v_fma_f32 v27, v27, v20, v22
    v_mfma_f32_16x16x32_bf16 v[104:107], a[240:243], v[52:55], v[104:107]
    ds_read_b64_tr_b16 a[236:237], v12 offset:9376
    v_mfma_f32_16x16x32_bf16 v[100:103], a[244:247], v[48:51], v[100:103]
    ds_read_b64_tr_b16 a[238:239], v12 offset:13984
    v_cvt_pk_bf16_f32 v57, v26, v27
    v_lshlrev_b32 v24, 16, v42
    v_mfma_f32_16x16x32_bf16 v[108:111], a[244:247], v[52:55], v[108:111]
    ds_read_b64_tr_b16 a[240:241], v12 offset:192
    s_waitcnt lgkmcnt(9)
    v_mfma_f32_16x16x32_bf16 v[112:115], a[248:251], v[48:51], v[112:115]
    ds_read_b64_tr_b16 a[242:243], v12 offset:4800
    v_and_b32 v25, s46, v42
    v_fma_f32 v24, v24, v20, v22
    v_mfma_f32_16x16x32_bf16 v[120:123], a[248:251], v[52:55], v[120:123]
    ds_read_b64_tr_b16 a[244:245], v12 offset:9408
    v_mfma_f32_16x16x32_bf16 v[116:119], a[252:255], v[48:51], v[116:119]
    ds_read_b64_tr_b16 a[246:247], v12 offset:14016
    v_fma_f32 v25, v25, v20, v22
    v_cvt_pk_bf16_f32 v58, v24, v25
    v_mfma_f32_16x16x32_bf16 v[124:127], a[252:255], v[52:55], v[124:127]
    ds_read_b64_tr_b16 a[248:249], v12 offset:224
    s_waitcnt lgkmcnt(9)
    v_mfma_f32_16x16x32_bf16 v[128:131], a[224:227], v[48:51], v[128:131]
    ds_read_b64_tr_b16 a[250:251], v12 offset:4832
    v_lshlrev_b32 v26, 16, v43
    v_and_b32 v27, s46, v43
    v_mfma_f32_16x16x32_bf16 v[136:139], a[224:227], v[52:55], v[136:139]
    ds_read_b64_tr_b16 a[252:253], v12 offset:9440
    v_mfma_f32_16x16x32_bf16 v[132:135], a[228:231], v[48:51], v[132:135]
    ds_read_b64_tr_b16 a[254:255], v12 offset:14048
    v_fma_f32 v26, v26, v20, v22
    v_fma_f32 v27, v27, v20, v22
    v_mfma_f32_16x16x32_bf16 v[140:143], a[228:231], v[52:55], v[140:143]
    ds_read_b64_tr_b16 a[224:225], v12 offset:256
    s_waitcnt lgkmcnt(9)
    v_mfma_f32_16x16x32_bf16 v[144:147], a[232:235], v[48:51], v[144:147]
    ds_read_b64_tr_b16 a[226:227], v12 offset:4864
    v_cvt_pk_bf16_f32 v59, v26, v27
    v_lshlrev_b32 v24, 16, v44
    v_mfma_f32_16x16x32_bf16 v[152:155], a[232:235], v[52:55], v[152:155]
    ds_read_b64_tr_b16 a[228:229], v12 offset:9472
    v_mfma_f32_16x16x32_bf16 v[148:151], a[236:239], v[48:51], v[148:151]
    ds_read_b64_tr_b16 a[230:231], v12 offset:14080
    v_and_b32 v25, s46, v44
    v_fma_f32 v24, v24, v14, v16
    v_mfma_f32_16x16x32_bf16 v[156:159], a[236:239], v[52:55], v[156:159]
    s_barrier
    ds_read_b64_tr_b16 a[232:233], v12 offset:18496
    s_waitcnt lgkmcnt(9)
    v_mfma_f32_16x16x32_bf16 v[160:163], a[240:243], v[48:51], v[160:163]
    ds_read_b64_tr_b16 a[234:235], v12 offset:23104
    s_add_u32 m0, s52, 55488
    s_mov_b32 s32, 5013792
    buffer_load_dwordx4 v2, s[8:11], s32 offen offset:0 lds
    v_mfma_f32_16x16x32_bf16 v[168:171], a[240:243], v[52:55], v[168:171]
    ds_read_b64_tr_b16 a[236:237], v12 offset:27712
    v_mfma_f32_16x16x32_bf16 v[164:167], a[244:247], v[48:51], v[164:167]
    ds_read_b64_tr_b16 a[238:239], v12 offset:32320
    buffer_load_dwordx4 v3, s[8:11], s32 offen offset:1024 lds
    v_fma_f32 v25, v25, v14, v16
    v_mfma_f32_16x16x32_bf16 v[172:175], a[244:247], v[52:55], v[172:175]
    ds_read_b64_tr_b16 a[240:241], v12 offset:18528
    s_waitcnt lgkmcnt(9)
    v_mfma_f32_16x16x32_bf16 v[176:179], a[248:251], v[48:51], v[176:179]
    ds_read_b64_tr_b16 a[242:243], v12 offset:23136
    buffer_load_dwordx4 v4, s[8:11], s32 offen offset:2048 lds
    v_cvt_pk_bf16_f32 v60, v24, v25
    v_mfma_f32_16x16x32_bf16 v[184:187], a[248:251], v[52:55], v[184:187]
    ds_read_b64_tr_b16 a[244:245], v12 offset:27744
    v_mfma_f32_16x16x32_bf16 v[180:183], a[252:255], v[48:51], v[180:183]
    ds_read_b64_tr_b16 a[246:247], v12 offset:32352
    buffer_load_dwordx4 v5, s[8:11], s32 offen offset:3072 lds
    v_lshlrev_b32 v26, 16, v45
    v_mfma_f32_16x16x32_bf16 v[188:191], a[252:255], v[52:55], v[188:191]
    ds_read_b64_tr_b16 a[248:249], v12 offset:18560
    s_waitcnt lgkmcnt(9)
    v_mfma_f32_16x16x32_bf16 v[192:195], a[224:227], v[48:51], v[192:195]
    ds_read_b64_tr_b16 a[250:251], v12 offset:23168
    s_add_u32 m0, m0, 0x400
    s_mov_b64 exec, s[34:35]
    buffer_load_dwordx4 v6, s[8:11], s32 offen offset:3072 lds
    s_mov_b64 exec, -1
    v_mfma_f32_16x16x32_bf16 v[200:203], a[224:227], v[52:55], v[200:203]
    ds_read_b64_tr_b16 a[252:253], v12 offset:27776
    v_mfma_f32_16x16x32_bf16 v[196:199], a[228:231], v[48:51], v[196:199]
    ds_read_b64_tr_b16 a[254:255], v12 offset:32384
    v_and_b32 v27, s46, v45
    v_fma_f32 v26, v26, v14, v16
    v_mfma_f32_16x16x32_bf16 v[204:207], a[228:231], v[52:55], v[204:207]
    ds_read_b64_tr_b16 a[224:225], v12 offset:18592
    s_waitcnt lgkmcnt(9)
    v_mfma_f32_16x16x32_bf16 v[208:211], a[232:235], v[48:51], v[208:211]
    ds_read_b64_tr_b16 a[226:227], v12 offset:23200
    v_fma_f32 v27, v27, v14, v16
    v_cvt_pk_bf16_f32 v61, v26, v27
    v_mfma_f32_16x16x32_bf16 v[216:219], a[232:235], v[52:55], v[216:219]
    ds_read_b64_tr_b16 a[228:229], v12 offset:27808
    v_mfma_f32_16x16x32_bf16 v[212:215], a[236:239], v[48:51], v[212:215]
    ds_read_b64_tr_b16 a[230:231], v12 offset:32416
    v_lshlrev_b32 v24, 16, v46
    v_and_b32 v25, s46, v46
    v_mfma_f32_16x16x32_bf16 v[220:223], a[236:239], v[52:55], v[220:223]
    ds_read_b64_tr_b16 a[232:233], v12 offset:18624
    s_waitcnt lgkmcnt(9)
    v_mfma_f32_16x16x32_bf16 v[224:227], a[240:243], v[48:51], v[224:227]
    ds_read_b64_tr_b16 a[234:235], v12 offset:23232
    v_fma_f32 v24, v24, v14, v16
    v_fma_f32 v25, v25, v14, v16
    v_mfma_f32_16x16x32_bf16 v[232:235], a[240:243], v[52:55], v[232:235]
    ds_read_b64_tr_b16 a[236:237], v12 offset:27840
    v_mfma_f32_16x16x32_bf16 v[228:231], a[244:247], v[48:51], v[228:231]
    ds_read_b64_tr_b16 a[238:239], v12 offset:32448
    v_cvt_pk_bf16_f32 v62, v24, v25
    v_lshlrev_b32 v26, 16, v47
    v_mfma_f32_16x16x32_bf16 v[236:239], a[244:247], v[52:55], v[236:239]
    ds_read_b64_tr_b16 a[240:241], v12 offset:18656
    s_waitcnt lgkmcnt(9)
    v_mfma_f32_16x16x32_bf16 v[240:243], a[248:251], v[48:51], v[240:243]
    ds_read_b64_tr_b16 a[242:243], v12 offset:23264
    v_and_b32 v27, s46, v47
    v_fma_f32 v26, v26, v14, v16
    v_mfma_f32_16x16x32_bf16 v[248:251], a[248:251], v[52:55], v[248:251]
    ds_read_b64_tr_b16 a[244:245], v12 offset:27872
    v_mfma_f32_16x16x32_bf16 v[244:247], a[252:255], v[48:51], v[244:247]
    ds_read_b64_tr_b16 a[246:247], v12 offset:32480
    v_fma_f32 v27, v27, v14, v16
    v_cvt_pk_bf16_f32 v63, v26, v27
    v_mfma_f32_16x16x32_bf16 v[252:255], a[252:255], v[52:55], v[252:255]
    ds_read_b64_tr_b16 a[248:249], v12 offset:18688
    s_waitcnt lgkmcnt(9)
    v_mfma_f32_16x16x32_bf16 a[0:3], a[224:227], v[48:51], a[0:3]
    ds_read_b64_tr_b16 a[250:251], v12 offset:23296
    buffer_load_dwordx4 v[40:43], v18, s[16:19], s47 offen
    buffer_load_dwordx4 v[44:47], v19, s[16:19], s47 offen
    v_mfma_f32_16x16x32_bf16 a[8:11], a[224:227], v[52:55], a[8:11]
    ds_read_b64_tr_b16 a[252:253], v12 offset:27904
    v_mfma_f32_16x16x32_bf16 a[4:7], a[228:231], v[48:51], a[4:7]
    ds_read_b64_tr_b16 a[254:255], v12 offset:32512
    s_add_u32 s47, s47, 0x400
    v_mfma_f32_16x16x32_bf16 a[12:15], a[228:231], v[52:55], a[12:15]
    ds_read_b64_tr_b16 a[224:225], v12 offset:18720
    s_waitcnt lgkmcnt(9)
    v_mfma_f32_16x16x32_bf16 a[16:19], a[232:235], v[48:51], a[16:19]
    ds_read_b64_tr_b16 a[226:227], v12 offset:23328
    v_mfma_f32_16x16x32_bf16 a[24:27], a[232:235], v[52:55], a[24:27]
    ds_read_b64_tr_b16 a[228:229], v12 offset:27936
    v_mfma_f32_16x16x32_bf16 a[20:23], a[236:239], v[48:51], a[20:23]
    ds_read_b64_tr_b16 a[230:231], v12 offset:32544
    v_mfma_f32_16x16x32_bf16 a[28:31], a[236:239], v[52:55], a[28:31]
    ds_read_b64_tr_b16 a[232:233], v12 offset:18752
    s_waitcnt lgkmcnt(9)
    v_mfma_f32_16x16x32_bf16 a[32:35], a[240:243], v[48:51], a[32:35]
    ds_read_b64_tr_b16 a[234:235], v12 offset:23360
    v_mfma_f32_16x16x32_bf16 a[40:43], a[240:243], v[52:55], a[40:43]
    ds_read_b64_tr_b16 a[236:237], v12 offset:27968
    v_mfma_f32_16x16x32_bf16 a[36:39], a[244:247], v[48:51], a[36:39]
    ds_read_b64_tr_b16 a[238:239], v12 offset:32576
    v_mfma_f32_16x16x32_bf16 a[44:47], a[244:247], v[52:55], a[44:47]
    s_barrier
    ds_read_b64_tr_b16 a[240:241], v13 offset:0
    s_waitcnt lgkmcnt(9)
    v_mfma_f32_16x16x32_bf16 a[48:51], a[248:251], v[48:51], a[48:51]
    ds_read_b64_tr_b16 a[242:243], v13 offset:4608
    s_sub_u32 s52, s53, s52
    s_add_u32 m0, s52, 0
    s_mov_b32 s32, 0
    buffer_load_dwordx4 v7, s[12:15], s32 offen offset:0 lds
    v_mfma_f32_16x16x32_bf16 a[56:59], a[248:251], v[52:55], a[56:59]
    ds_read_b64_tr_b16 a[244:245], v13 offset:9216
    v_mfma_f32_16x16x32_bf16 a[52:55], a[252:255], v[48:51], a[52:55]
    ds_read_b64_tr_b16 a[246:247], v13 offset:13824
    buffer_load_dwordx4 v8, s[12:15], s32 offen offset:1024 lds
    v_mfma_f32_16x16x32_bf16 a[60:63], a[252:255], v[52:55], a[60:63]
    ds_read_b64_tr_b16 a[248:249], v13 offset:32
    s_waitcnt lgkmcnt(9)
    v_mfma_f32_16x16x32_bf16 a[64:67], a[224:227], v[48:51], a[64:67]
    ds_read_b64_tr_b16 a[250:251], v13 offset:4640
    buffer_load_dwordx4 v9, s[12:15], s32 offen offset:2048 lds
    v_mfma_f32_16x16x32_bf16 a[72:75], a[224:227], v[52:55], a[72:75]
    ds_read_b64_tr_b16 a[252:253], v13 offset:9248
    v_mfma_f32_16x16x32_bf16 a[68:71], a[228:231], v[48:51], a[68:71]
    ds_read_b64_tr_b16 a[254:255], v13 offset:13856
    buffer_load_dwordx4 v10, s[12:15], s32 offen offset:3072 lds
    v_mfma_f32_16x16x32_bf16 a[76:79], a[228:231], v[52:55], a[76:79]
    ds_read_b64_tr_b16 a[224:225], v13 offset:64
    s_waitcnt lgkmcnt(9)
    v_mfma_f32_16x16x32_bf16 a[80:83], a[232:235], v[48:51], a[80:83]
    ds_read_b64_tr_b16 a[226:227], v13 offset:4672
    s_add_u32 m0, m0, 0x400
    s_mov_b64 exec, s[34:35]
    buffer_load_dwordx4 v11, s[12:15], s32 offen offset:3072 lds
    s_mov_b64 exec, -1
    v_mfma_f32_16x16x32_bf16 a[88:91], a[232:235], v[52:55], a[88:91]
    ds_read_b64_tr_b16 a[228:229], v13 offset:9280
    v_mfma_f32_16x16x32_bf16 a[84:87], a[236:239], v[48:51], a[84:87]
    ds_read_b64_tr_b16 a[230:231], v13 offset:13888
    v_mfma_f32_16x16x32_bf16 a[92:95], a[236:239], v[52:55], a[92:95]
    ds_read_b64_tr_b16 a[232:233], v13 offset:96
    s_waitcnt lgkmcnt(9)
    v_mfma_f32_16x16x32_bf16 v[64:67], a[240:243], v[56:59], v[64:67]
    ds_read_b64_tr_b16 a[234:235], v13 offset:4704
    s_waitcnt vmcnt(17)
    v_lshlrev_b32 v24, 16, v32
    v_mfma_f32_16x16x32_bf16 v[72:75], a[240:243], v[60:63], v[72:75]
    ds_read_b64_tr_b16 a[236:237], v13 offset:9312
    v_mfma_f32_16x16x32_bf16 v[68:71], a[244:247], v[56:59], v[68:71]
    ds_read_b64_tr_b16 a[238:239], v13 offset:13920
    v_and_b32 v25, s46, v32
    v_fma_f32 v24, v24, v20, v22
    v_mfma_f32_16x16x32_bf16 v[76:79], a[244:247], v[60:63], v[76:79]
    ds_read_b64_tr_b16 a[240:241], v13 offset:128
    s_waitcnt lgkmcnt(9)
    v_mfma_f32_16x16x32_bf16 v[80:83], a[248:251], v[56:59], v[80:83]
    ds_read_b64_tr_b16 a[242:243], v13 offset:4736
    v_fma_f32 v25, v25, v20, v22
    v_cvt_pk_bf16_f32 v48, v24, v25
    v_mfma_f32_16x16x32_bf16 v[88:91], a[248:251], v[60:63], v[88:91]
    ds_read_b64_tr_b16 a[244:245], v13 offset:9344
    v_mfma_f32_16x16x32_bf16 v[84:87], a[252:255], v[56:59], v[84:87]
    ds_read_b64_tr_b16 a[246:247], v13 offset:13952
    v_lshlrev_b32 v26, 16, v33
    v_and_b32 v27, s46, v33
    v_mfma_f32_16x16x32_bf16 v[92:95], a[252:255], v[60:63], v[92:95]
    ds_read_b64_tr_b16 a[248:249], v13 offset:160
    s_waitcnt lgkmcnt(9)
    v_mfma_f32_16x16x32_bf16 v[96:99], a[224:227], v[56:59], v[96:99]
    ds_read_b64_tr_b16 a[250:251], v13 offset:4768
    v_fma_f32 v26, v26, v20, v22
    v_fma_f32 v27, v27, v20, v22
    v_mfma_f32_16x16x32_bf16 v[104:107], a[224:227], v[60:63], v[104:107]
    ds_read_b64_tr_b16 a[252:253], v13 offset:9376
    v_mfma_f32_16x16x32_bf16 v[100:103], a[228:231], v[56:59], v[100:103]
    ds_read_b64_tr_b16 a[254:255], v13 offset:13984
    v_cvt_pk_bf16_f32 v49, v26, v27
    v_lshlrev_b32 v24, 16, v34
    v_mfma_f32_16x16x32_bf16 v[108:111], a[228:231], v[60:63], v[108:111]
    ds_read_b64_tr_b16 a[224:225], v13 offset:192
    s_waitcnt lgkmcnt(9)
    v_mfma_f32_16x16x32_bf16 v[112:115], a[232:235], v[56:59], v[112:115]
    ds_read_b64_tr_b16 a[226:227], v13 offset:4800
    v_and_b32 v25, s46, v34
    v_fma_f32 v24, v24, v20, v22
    v_mfma_f32_16x16x32_bf16 v[120:123], a[232:235], v[60:63], v[120:123]
    ds_read_b64_tr_b16 a[228:229], v13 offset:9408
    v_mfma_f32_16x16x32_bf16 v[116:119], a[236:239], v[56:59], v[116:119]
    ds_read_b64_tr_b16 a[230:231], v13 offset:14016
    v_fma_f32 v25, v25, v20, v22
    v_cvt_pk_bf16_f32 v50, v24, v25
    v_mfma_f32_16x16x32_bf16 v[124:127], a[236:239], v[60:63], v[124:127]
    ds_read_b64_tr_b16 a[232:233], v13 offset:224
    s_waitcnt lgkmcnt(9)
    v_mfma_f32_16x16x32_bf16 v[128:131], a[240:243], v[56:59], v[128:131]
    ds_read_b64_tr_b16 a[234:235], v13 offset:4832
    v_lshlrev_b32 v26, 16, v35
    v_and_b32 v27, s46, v35
    v_mfma_f32_16x16x32_bf16 v[136:139], a[240:243], v[60:63], v[136:139]
    ds_read_b64_tr_b16 a[236:237], v13 offset:9440
    v_mfma_f32_16x16x32_bf16 v[132:135], a[244:247], v[56:59], v[132:135]
    ds_read_b64_tr_b16 a[238:239], v13 offset:14048
    v_fma_f32 v26, v26, v20, v22
    v_fma_f32 v27, v27, v20, v22
    v_mfma_f32_16x16x32_bf16 v[140:143], a[244:247], v[60:63], v[140:143]
    ds_read_b64_tr_b16 a[240:241], v13 offset:256
    s_waitcnt lgkmcnt(9)
    v_mfma_f32_16x16x32_bf16 v[144:147], a[248:251], v[56:59], v[144:147]
    ds_read_b64_tr_b16 a[242:243], v13 offset:4864
    v_cvt_pk_bf16_f32 v51, v26, v27
    v_lshlrev_b32 v24, 16, v36
    v_mfma_f32_16x16x32_bf16 v[152:155], a[248:251], v[60:63], v[152:155]
    ds_read_b64_tr_b16 a[244:245], v13 offset:9472
    v_mfma_f32_16x16x32_bf16 v[148:151], a[252:255], v[56:59], v[148:151]
    ds_read_b64_tr_b16 a[246:247], v13 offset:14080
    v_and_b32 v25, s46, v36
    v_fma_f32 v24, v24, v14, v16
    v_mfma_f32_16x16x32_bf16 v[156:159], a[252:255], v[60:63], v[156:159]
    s_barrier
    ds_read_b64_tr_b16 a[248:249], v13 offset:18496
    s_waitcnt lgkmcnt(9)
    v_mfma_f32_16x16x32_bf16 v[160:163], a[224:227], v[56:59], v[160:163]
    ds_read_b64_tr_b16 a[250:251], v13 offset:23104
    s_add_u32 m0, s52, 18496
    s_mov_b32 s32, 36864
    buffer_load_dwordx4 v7, s[12:15], s32 offen offset:0 lds
    v_mfma_f32_16x16x32_bf16 v[168:171], a[224:227], v[60:63], v[168:171]
    ds_read_b64_tr_b16 a[252:253], v13 offset:27712
    v_mfma_f32_16x16x32_bf16 v[164:167], a[228:231], v[56:59], v[164:167]
    ds_read_b64_tr_b16 a[254:255], v13 offset:32320
    buffer_load_dwordx4 v8, s[12:15], s32 offen offset:1024 lds
    v_fma_f32 v25, v25, v14, v16
    v_mfma_f32_16x16x32_bf16 v[172:175], a[228:231], v[60:63], v[172:175]
    ds_read_b64_tr_b16 a[224:225], v13 offset:18528
    s_waitcnt lgkmcnt(9)
    v_mfma_f32_16x16x32_bf16 v[176:179], a[232:235], v[56:59], v[176:179]
    ds_read_b64_tr_b16 a[226:227], v13 offset:23136
    buffer_load_dwordx4 v9, s[12:15], s32 offen offset:2048 lds
    v_cvt_pk_bf16_f32 v52, v24, v25
    v_mfma_f32_16x16x32_bf16 v[184:187], a[232:235], v[60:63], v[184:187]
    ds_read_b64_tr_b16 a[228:229], v13 offset:27744
    v_mfma_f32_16x16x32_bf16 v[180:183], a[236:239], v[56:59], v[180:183]
    ds_read_b64_tr_b16 a[230:231], v13 offset:32352
    buffer_load_dwordx4 v10, s[12:15], s32 offen offset:3072 lds
    v_lshlrev_b32 v26, 16, v37
    v_mfma_f32_16x16x32_bf16 v[188:191], a[236:239], v[60:63], v[188:191]
    ds_read_b64_tr_b16 a[232:233], v13 offset:18560
    s_waitcnt lgkmcnt(9)
    v_mfma_f32_16x16x32_bf16 v[192:195], a[240:243], v[56:59], v[192:195]
    ds_read_b64_tr_b16 a[234:235], v13 offset:23168
    s_add_u32 m0, m0, 0x400
    s_mov_b64 exec, s[34:35]
    buffer_load_dwordx4 v11, s[12:15], s32 offen offset:3072 lds
    s_mov_b64 exec, -1
    v_mfma_f32_16x16x32_bf16 v[200:203], a[240:243], v[60:63], v[200:203]
    ds_read_b64_tr_b16 a[236:237], v13 offset:27776
    v_mfma_f32_16x16x32_bf16 v[196:199], a[244:247], v[56:59], v[196:199]
    ds_read_b64_tr_b16 a[238:239], v13 offset:32384
    v_and_b32 v27, s46, v37
    v_fma_f32 v26, v26, v14, v16
    v_mfma_f32_16x16x32_bf16 v[204:207], a[244:247], v[60:63], v[204:207]
    ds_read_b64_tr_b16 a[240:241], v13 offset:18592
    s_waitcnt lgkmcnt(9)
    v_mfma_f32_16x16x32_bf16 v[208:211], a[248:251], v[56:59], v[208:211]
    ds_read_b64_tr_b16 a[242:243], v13 offset:23200
    v_fma_f32 v27, v27, v14, v16
    v_cvt_pk_bf16_f32 v53, v26, v27
    v_mfma_f32_16x16x32_bf16 v[216:219], a[248:251], v[60:63], v[216:219]
    ds_read_b64_tr_b16 a[244:245], v13 offset:27808
    v_mfma_f32_16x16x32_bf16 v[212:215], a[252:255], v[56:59], v[212:215]
    ds_read_b64_tr_b16 a[246:247], v13 offset:32416
    v_lshlrev_b32 v24, 16, v38
    v_and_b32 v25, s46, v38
    v_mfma_f32_16x16x32_bf16 v[220:223], a[252:255], v[60:63], v[220:223]
    ds_read_b64_tr_b16 a[248:249], v13 offset:18624
    s_waitcnt lgkmcnt(9)
    v_mfma_f32_16x16x32_bf16 v[224:227], a[224:227], v[56:59], v[224:227]
    ds_read_b64_tr_b16 a[250:251], v13 offset:23232
    v_fma_f32 v24, v24, v14, v16
    v_fma_f32 v25, v25, v14, v16
    v_mfma_f32_16x16x32_bf16 v[232:235], a[224:227], v[60:63], v[232:235]
    ds_read_b64_tr_b16 a[252:253], v13 offset:27840
    v_mfma_f32_16x16x32_bf16 v[228:231], a[228:231], v[56:59], v[228:231]
    ds_read_b64_tr_b16 a[254:255], v13 offset:32448
    v_cvt_pk_bf16_f32 v54, v24, v25
    v_lshlrev_b32 v26, 16, v39
    v_mfma_f32_16x16x32_bf16 v[236:239], a[228:231], v[60:63], v[236:239]
    ds_read_b64_tr_b16 a[224:225], v13 offset:18656
    s_waitcnt lgkmcnt(9)
    v_mfma_f32_16x16x32_bf16 v[240:243], a[232:235], v[56:59], v[240:243]
    ds_read_b64_tr_b16 a[226:227], v13 offset:23264
    v_and_b32 v27, s46, v39
    v_fma_f32 v26, v26, v14, v16
    v_mfma_f32_16x16x32_bf16 v[248:251], a[232:235], v[60:63], v[248:251]
    ds_read_b64_tr_b16 a[228:229], v13 offset:27872
    v_mfma_f32_16x16x32_bf16 v[244:247], a[236:239], v[56:59], v[244:247]
    ds_read_b64_tr_b16 a[230:231], v13 offset:32480
    v_fma_f32 v27, v27, v14, v16
    v_cvt_pk_bf16_f32 v55, v26, v27
    v_mfma_f32_16x16x32_bf16 v[252:255], a[236:239], v[60:63], v[252:255]
    ds_read_b64_tr_b16 a[232:233], v13 offset:18688
    s_waitcnt lgkmcnt(9)
    v_mfma_f32_16x16x32_bf16 a[0:3], a[240:243], v[56:59], a[0:3]
    ds_read_b64_tr_b16 a[234:235], v13 offset:23296
    v_mfma_f32_16x16x32_bf16 a[8:11], a[240:243], v[60:63], a[8:11]
    ds_read_b64_tr_b16 a[236:237], v13 offset:27904
    v_mfma_f32_16x16x32_bf16 a[4:7], a[244:247], v[56:59], a[4:7]
    ds_read_b64_tr_b16 a[238:239], v13 offset:32512
    v_mfma_f32_16x16x32_bf16 a[12:15], a[244:247], v[60:63], a[12:15]
    ds_read_b64_tr_b16 a[240:241], v13 offset:18720
    s_waitcnt lgkmcnt(9)
    v_mfma_f32_16x16x32_bf16 a[16:19], a[248:251], v[56:59], a[16:19]
    ds_read_b64_tr_b16 a[242:243], v13 offset:23328
    v_mfma_f32_16x16x32_bf16 a[24:27], a[248:251], v[60:63], a[24:27]
    ds_read_b64_tr_b16 a[244:245], v13 offset:27936
    v_mfma_f32_16x16x32_bf16 a[20:23], a[252:255], v[56:59], a[20:23]
    ds_read_b64_tr_b16 a[246:247], v13 offset:32544
    v_mfma_f32_16x16x32_bf16 a[28:31], a[252:255], v[60:63], a[28:31]
    ds_read_b64_tr_b16 a[248:249], v13 offset:18752
    s_waitcnt lgkmcnt(9)
    v_mfma_f32_16x16x32_bf16 a[32:35], a[224:227], v[56:59], a[32:35]
    ds_read_b64_tr_b16 a[250:251], v13 offset:23360
    v_mfma_f32_16x16x32_bf16 a[40:43], a[224:227], v[60:63], a[40:43]
    ds_read_b64_tr_b16 a[252:253], v13 offset:27968
    v_mfma_f32_16x16x32_bf16 a[36:39], a[228:231], v[56:59], a[36:39]
    ds_read_b64_tr_b16 a[254:255], v13 offset:32576
    v_mfma_f32_16x16x32_bf16 a[44:47], a[228:231], v[60:63], a[44:47]
    s_barrier
    v_add_u32 v12, s54, v12
    v_add_u32 v13, s54, v13
    s_sub_u32 s54, 0, s54
    ds_read_b64_tr_b16 a[224:225], v12 offset:0
    s_waitcnt lgkmcnt(9)
    v_mfma_f32_16x16x32_bf16 a[48:51], a[232:235], v[56:59], a[48:51]
    ds_read_b64_tr_b16 a[226:227], v12 offset:4608
    s_add_u32 m0, s52, 36992
    s_mov_b32 s32, 73728
    buffer_load_dwordx4 v7, s[12:15], s32 offen offset:0 lds
    v_mfma_f32_16x16x32_bf16 a[56:59], a[232:235], v[60:63], a[56:59]
    ds_read_b64_tr_b16 a[228:229], v12 offset:9216
    v_mfma_f32_16x16x32_bf16 a[52:55], a[236:239], v[56:59], a[52:55]
    ds_read_b64_tr_b16 a[230:231], v12 offset:13824
    buffer_load_dwordx4 v8, s[12:15], s32 offen offset:1024 lds
    v_mfma_f32_16x16x32_bf16 a[60:63], a[236:239], v[60:63], a[60:63]
    ds_read_b64_tr_b16 a[232:233], v12 offset:32
    s_waitcnt lgkmcnt(9)
    v_mfma_f32_16x16x32_bf16 a[64:67], a[240:243], v[56:59], a[64:67]
    ds_read_b64_tr_b16 a[234:235], v12 offset:4640
    buffer_load_dwordx4 v9, s[12:15], s32 offen offset:2048 lds
    v_mfma_f32_16x16x32_bf16 a[72:75], a[240:243], v[60:63], a[72:75]
    ds_read_b64_tr_b16 a[236:237], v12 offset:9248
    v_mfma_f32_16x16x32_bf16 a[68:71], a[244:247], v[56:59], a[68:71]
    ds_read_b64_tr_b16 a[238:239], v12 offset:13856
    buffer_load_dwordx4 v10, s[12:15], s32 offen offset:3072 lds
    v_mfma_f32_16x16x32_bf16 a[76:79], a[244:247], v[60:63], a[76:79]
    ds_read_b64_tr_b16 a[240:241], v12 offset:64
    s_waitcnt lgkmcnt(9)
    v_mfma_f32_16x16x32_bf16 a[80:83], a[248:251], v[56:59], a[80:83]
    ds_read_b64_tr_b16 a[242:243], v12 offset:4672
    s_add_u32 m0, m0, 0x400
    s_mov_b64 exec, s[34:35]
    buffer_load_dwordx4 v11, s[12:15], s32 offen offset:3072 lds
    s_mov_b64 exec, -1
    v_mfma_f32_16x16x32_bf16 a[88:91], a[248:251], v[60:63], a[88:91]
    ds_read_b64_tr_b16 a[244:245], v12 offset:9280
    v_mfma_f32_16x16x32_bf16 a[84:87], a[252:255], v[56:59], a[84:87]
    ds_read_b64_tr_b16 a[246:247], v12 offset:13888
    v_mfma_f32_16x16x32_bf16 a[92:95], a[252:255], v[60:63], a[92:95]
    ds_read_b64_tr_b16 a[248:249], v12 offset:96
    s_waitcnt lgkmcnt(9)
    v_mfma_f32_16x16x32_bf16 v[64:67], a[224:227], v[48:51], v[64:67]
    ds_read_b64_tr_b16 a[250:251], v12 offset:4704
    s_waitcnt vmcnt(15)
    v_lshlrev_b32 v24, 16, v40
    v_mfma_f32_16x16x32_bf16 v[72:75], a[224:227], v[52:55], v[72:75]
    ds_read_b64_tr_b16 a[252:253], v12 offset:9312
    v_mfma_f32_16x16x32_bf16 v[68:71], a[228:231], v[48:51], v[68:71]
    ds_read_b64_tr_b16 a[254:255], v12 offset:13920
    v_and_b32 v25, s46, v40
    v_fma_f32 v24, v24, v20, v22
    v_mfma_f32_16x16x32_bf16 v[76:79], a[228:231], v[52:55], v[76:79]
    ds_read_b64_tr_b16 a[224:225], v12 offset:128
    s_waitcnt lgkmcnt(9)
    v_mfma_f32_16x16x32_bf16 v[80:83], a[232:235], v[48:51], v[80:83]
    ds_read_b64_tr_b16 a[226:227], v12 offset:4736
    v_fma_f32 v25, v25, v20, v22
    v_cvt_pk_bf16_f32 v56, v24, v25
    v_mfma_f32_16x16x32_bf16 v[88:91], a[232:235], v[52:55], v[88:91]
    ds_read_b64_tr_b16 a[228:229], v12 offset:9344
    v_mfma_f32_16x16x32_bf16 v[84:87], a[236:239], v[48:51], v[84:87]
    ds_read_b64_tr_b16 a[230:231], v12 offset:13952
    v_lshlrev_b32 v26, 16, v41
    v_and_b32 v27, s46, v41
    v_mfma_f32_16x16x32_bf16 v[92:95], a[236:239], v[52:55], v[92:95]
    ds_read_b64_tr_b16 a[232:233], v12 offset:160
    s_waitcnt lgkmcnt(9)
    v_mfma_f32_16x16x32_bf16 v[96:99], a[240:243], v[48:51], v[96:99]
    ds_read_b64_tr_b16 a[234:235], v12 offset:4768
    v_fma_f32 v26, v26, v20, v22
    v_fma_f32 v27, v27, v20, v22
    v_mfma_f32_16x16x32_bf16 v[104:107], a[240:243], v[52:55], v[104:107]
    ds_read_b64_tr_b16 a[236:237], v12 offset:9376
    v_mfma_f32_16x16x32_bf16 v[100:103], a[244:247], v[48:51], v[100:103]
    ds_read_b64_tr_b16 a[238:239], v12 offset:13984
    v_cvt_pk_bf16_f32 v57, v26, v27
    v_lshlrev_b32 v24, 16, v42
    v_mfma_f32_16x16x32_bf16 v[108:111], a[244:247], v[52:55], v[108:111]
    ds_read_b64_tr_b16 a[240:241], v12 offset:192
    s_waitcnt lgkmcnt(9)
    v_mfma_f32_16x16x32_bf16 v[112:115], a[248:251], v[48:51], v[112:115]
    ds_read_b64_tr_b16 a[242:243], v12 offset:4800
    v_and_b32 v25, s46, v42
    v_fma_f32 v24, v24, v20, v22
    v_mfma_f32_16x16x32_bf16 v[120:123], a[248:251], v[52:55], v[120:123]
    ds_read_b64_tr_b16 a[244:245], v12 offset:9408
    v_mfma_f32_16x16x32_bf16 v[116:119], a[252:255], v[48:51], v[116:119]
    ds_read_b64_tr_b16 a[246:247], v12 offset:14016
    v_fma_f32 v25, v25, v20, v22
    v_cvt_pk_bf16_f32 v58, v24, v25
    v_mfma_f32_16x16x32_bf16 v[124:127], a[252:255], v[52:55], v[124:127]
    ds_read_b64_tr_b16 a[248:249], v12 offset:224
    s_waitcnt lgkmcnt(9)
    v_mfma_f32_16x16x32_bf16 v[128:131], a[224:227], v[48:51], v[128:131]
    ds_read_b64_tr_b16 a[250:251], v12 offset:4832
    v_lshlrev_b32 v26, 16, v43
    v_and_b32 v27, s46, v43
    v_mfma_f32_16x16x32_bf16 v[136:139], a[224:227], v[52:55], v[136:139]
    ds_read_b64_tr_b16 a[252:253], v12 offset:9440
    v_mfma_f32_16x16x32_bf16 v[132:135], a[228:231], v[48:51], v[132:135]
    ds_read_b64_tr_b16 a[254:255], v12 offset:14048
    v_fma_f32 v26, v26, v20, v22
    v_fma_f32 v27, v27, v20, v22
    v_mfma_f32_16x16x32_bf16 v[140:143], a[228:231], v[52:55], v[140:143]
    ds_read_b64_tr_b16 a[224:225], v12 offset:256
    s_waitcnt lgkmcnt(9)
    v_mfma_f32_16x16x32_bf16 v[144:147], a[232:235], v[48:51], v[144:147]
    ds_read_b64_tr_b16 a[226:227], v12 offset:4864
    v_cvt_pk_bf16_f32 v59, v26, v27
    v_lshlrev_b32 v24, 16, v44
    v_mfma_f32_16x16x32_bf16 v[152:155], a[232:235], v[52:55], v[152:155]
    ds_read_b64_tr_b16 a[228:229], v12 offset:9472
    v_mfma_f32_16x16x32_bf16 v[148:151], a[236:239], v[48:51], v[148:151]
    ds_read_b64_tr_b16 a[230:231], v12 offset:14080
    v_and_b32 v25, s46, v44
    v_fma_f32 v24, v24, v14, v16
    v_mfma_f32_16x16x32_bf16 v[156:159], a[236:239], v[52:55], v[156:159]
    s_barrier
    ds_read_b64_tr_b16 a[232:233], v12 offset:18496
    s_waitcnt lgkmcnt(9)
    v_mfma_f32_16x16x32_bf16 v[160:163], a[240:243], v[48:51], v[160:163]
    ds_read_b64_tr_b16 a[234:235], v12 offset:23104
    s_add_u32 m0, s52, 55488
    s_mov_b32 s32, 110592
    buffer_load_dwordx4 v7, s[12:15], s32 offen offset:0 lds
    v_mfma_f32_16x16x32_bf16 v[168:171], a[240:243], v[52:55], v[168:171]
    ds_read_b64_tr_b16 a[236:237], v12 offset:27712
    v_mfma_f32_16x16x32_bf16 v[164:167], a[244:247], v[48:51], v[164:167]
    ds_read_b64_tr_b16 a[238:239], v12 offset:32320
    buffer_load_dwordx4 v8, s[12:15], s32 offen offset:1024 lds
    v_fma_f32 v25, v25, v14, v16
    v_mfma_f32_16x16x32_bf16 v[172:175], a[244:247], v[52:55], v[172:175]
    ds_read_b64_tr_b16 a[240:241], v12 offset:18528
    s_waitcnt lgkmcnt(9)
    v_mfma_f32_16x16x32_bf16 v[176:179], a[248:251], v[48:51], v[176:179]
    ds_read_b64_tr_b16 a[242:243], v12 offset:23136
    buffer_load_dwordx4 v9, s[12:15], s32 offen offset:2048 lds
    v_cvt_pk_bf16_f32 v60, v24, v25
    v_mfma_f32_16x16x32_bf16 v[184:187], a[248:251], v[52:55], v[184:187]
    ds_read_b64_tr_b16 a[244:245], v12 offset:27744
    v_mfma_f32_16x16x32_bf16 v[180:183], a[252:255], v[48:51], v[180:183]
    ds_read_b64_tr_b16 a[246:247], v12 offset:32352
    buffer_load_dwordx4 v10, s[12:15], s32 offen offset:3072 lds
    v_lshlrev_b32 v26, 16, v45
    v_mfma_f32_16x16x32_bf16 v[188:191], a[252:255], v[52:55], v[188:191]
    ds_read_b64_tr_b16 a[248:249], v12 offset:18560
    s_waitcnt lgkmcnt(9)
    v_mfma_f32_16x16x32_bf16 v[192:195], a[224:227], v[48:51], v[192:195]
    ds_read_b64_tr_b16 a[250:251], v12 offset:23168
    s_add_u32 m0, m0, 0x400
    s_mov_b64 exec, s[34:35]
    buffer_load_dwordx4 v11, s[12:15], s32 offen offset:3072 lds
    s_mov_b64 exec, -1
    v_mfma_f32_16x16x32_bf16 v[200:203], a[224:227], v[52:55], v[200:203]
    ds_read_b64_tr_b16 a[252:253], v12 offset:27776
    v_mfma_f32_16x16x32_bf16 v[196:199], a[228:231], v[48:51], v[196:199]
    ds_read_b64_tr_b16 a[254:255], v12 offset:32384
    v_and_b32 v27, s46, v45
    v_fma_f32 v26, v26, v14, v16
    v_mfma_f32_16x16x32_bf16 v[204:207], a[228:231], v[52:55], v[204:207]
    v_fma_f32 v27, v27, v14, v16
    v_cvt_pk_bf16_f32 v61, v26, v27
    v_lshlrev_b32 v24, 16, v46
    v_and_b32 v25, s46, v46
    v_fma_f32 v24, v24, v14, v16
    v_fma_f32 v25, v25, v14, v16
    v_cvt_pk_bf16_f32 v62, v24, v25
    v_lshlrev_b32 v26, 16, v47
    v_and_b32 v27, s46, v47
    v_fma_f32 v26, v26, v14, v16
    v_fma_f32 v27, v27, v14, v16
    v_cvt_pk_bf16_f32 v63, v26, v27
    ds_read_b64_tr_b16 a[224:225], v12 offset:18592
    s_waitcnt lgkmcnt(9)
    v_mfma_f32_16x16x32_bf16 v[64:67], a[232:235], v[56:59], v[64:67]
    ds_read_b64_tr_b16 a[226:227], v12 offset:23200
    v_mfma_f32_16x16x32_bf16 v[72:75], a[232:235], v[60:63], v[72:75]
    ds_read_b64_tr_b16 a[228:229], v12 offset:27808
    v_mfma_f32_16x16x32_bf16 v[68:71], a[236:239], v[56:59], v[68:71]
    ds_read_b64_tr_b16 a[230:231], v12 offset:32416
    v_mfma_f32_16x16x32_bf16 v[76:79], a[236:239], v[60:63], v[76:79]
    ds_read_b64_tr_b16 a[232:233], v12 offset:18624
    s_waitcnt lgkmcnt(9)
    v_mfma_f32_16x16x32_bf16 v[80:83], a[240:243], v[56:59], v[80:83]
    ds_read_b64_tr_b16 a[234:235], v12 offset:23232
    v_mfma_f32_16x16x32_bf16 v[88:91], a[240:243], v[60:63], v[88:91]
    ds_read_b64_tr_b16 a[236:237], v12 offset:27840
    v_mfma_f32_16x16x32_bf16 v[84:87], a[244:247], v[56:59], v[84:87]
    ds_read_b64_tr_b16 a[238:239], v12 offset:32448
    v_mfma_f32_16x16x32_bf16 v[92:95], a[244:247], v[60:63], v[92:95]
    ds_read_b64_tr_b16 a[240:241], v12 offset:18656
    s_waitcnt lgkmcnt(9)
    v_mfma_f32_16x16x32_bf16 v[96:99], a[248:251], v[56:59], v[96:99]
    ds_read_b64_tr_b16 a[242:243], v12 offset:23264
    v_mfma_f32_16x16x32_bf16 v[104:107], a[248:251], v[60:63], v[104:107]
    ds_read_b64_tr_b16 a[244:245], v12 offset:27872
    v_mfma_f32_16x16x32_bf16 v[100:103], a[252:255], v[56:59], v[100:103]
    ds_read_b64_tr_b16 a[246:247], v12 offset:32480
    v_mfma_f32_16x16x32_bf16 v[108:111], a[252:255], v[60:63], v[108:111]
    ds_read_b64_tr_b16 a[248:249], v12 offset:18688
    s_waitcnt lgkmcnt(9)
    v_mfma_f32_16x16x32_bf16 v[112:115], a[224:227], v[56:59], v[112:115]
    ds_read_b64_tr_b16 a[250:251], v12 offset:23296
    v_exp_f32 v24, v64
    v_exp_f32 v25, v65
    v_mfma_f32_16x16x32_bf16 v[120:123], a[224:227], v[60:63], v[120:123]
    ds_read_b64_tr_b16 a[252:253], v12 offset:27904
    v_mfma_f32_16x16x32_bf16 v[116:119], a[228:231], v[56:59], v[116:119]
    ds_read_b64_tr_b16 a[254:255], v12 offset:32512
    v_exp_f32 v26, v66
    v_exp_f32 v27, v67
    v_mfma_f32_16x16x32_bf16 v[124:127], a[228:231], v[60:63], v[124:127]
    ds_read_b64_tr_b16 a[224:225], v12 offset:18720
    s_waitcnt lgkmcnt(9)
    v_mfma_f32_16x16x32_bf16 v[128:131], a[232:235], v[56:59], v[128:131]
    ds_read_b64_tr_b16 a[226:227], v12 offset:23328
    v_pk_add_f32 v[24:25], v[24:25], 1.0 op_sel_hi:[1,0]
    v_pk_add_f32 v[26:27], v[26:27], 1.0 op_sel_hi:[1,0]
    v_mfma_f32_16x16x32_bf16 v[136:139], a[232:235], v[60:63], v[136:139]
    ds_read_b64_tr_b16 a[228:229], v12 offset:27936
    v_mfma_f32_16x16x32_bf16 v[132:135], a[236:239], v[56:59], v[132:135]
    ds_read_b64_tr_b16 a[230:231], v12 offset:32544
    v_rcp_f32 v24, v24
    v_rcp_f32 v25, v25
    v_mfma_f32_16x16x32_bf16 v[140:143], a[236:239], v[60:63], v[140:143]
    ds_read_b64_tr_b16 a[232:233], v12 offset:18752
    s_waitcnt lgkmcnt(9)
    v_mfma_f32_16x16x32_bf16 v[144:147], a[240:243], v[56:59], v[144:147]
    ds_read_b64_tr_b16 a[234:235], v12 offset:23360
    v_rcp_f32 v26, v26
    v_rcp_f32 v27, v27
    v_mfma_f32_16x16x32_bf16 v[152:155], a[240:243], v[60:63], v[152:155]
    ds_read_b64_tr_b16 a[236:237], v12 offset:27968
    v_mfma_f32_16x16x32_bf16 v[148:151], a[244:247], v[56:59], v[148:151]
    ds_read_b64_tr_b16 a[238:239], v12 offset:32576
    v_pk_mul_f32 v[24:25], v[24:25], v[68:69]
    v_pk_mul_f32 v[26:27], v[26:27], v[70:71]
    v_mfma_f32_16x16x32_bf16 v[156:159], a[244:247], v[60:63], v[156:159]
    s_barrier
    ds_read_b64_tr_b16 a[240:241], v13 offset:0
    s_waitcnt lgkmcnt(9)
    v_mfma_f32_16x16x32_bf16 v[160:163], a[248:251], v[56:59], v[160:163]
    ds_read_b64_tr_b16 a[242:243], v13 offset:4608
    s_sub_u32 s52, s53, s52
    s_add_u32 m0, s52, 0
    s_mov_b32 s32, 147456
    buffer_load_dwordx4 v7, s[12:15], s32 offen offset:0 lds
    v_mfma_f32_16x16x32_bf16 v[168:171], a[248:251], v[60:63], v[168:171]
    ds_read_b64_tr_b16 a[244:245], v13 offset:9216
    v_mfma_f32_16x16x32_bf16 v[164:167], a[252:255], v[56:59], v[164:167]
    ds_read_b64_tr_b16 a[246:247], v13 offset:13824
    buffer_load_dwordx4 v8, s[12:15], s32 offen offset:1024 lds
    v_cvt_pk_bf16_f32 v64, v24, v25
    v_mfma_f32_16x16x32_bf16 v[172:175], a[252:255], v[60:63], v[172:175]
    ds_read_b64_tr_b16 a[248:249], v13 offset:32
    s_waitcnt lgkmcnt(9)
    v_mfma_f32_16x16x32_bf16 v[176:179], a[224:227], v[56:59], v[176:179]
    ds_read_b64_tr_b16 a[250:251], v13 offset:4640
    buffer_load_dwordx4 v9, s[12:15], s32 offen offset:2048 lds
    v_cvt_pk_bf16_f32 v65, v26, v27
    v_mfma_f32_16x16x32_bf16 v[184:187], a[224:227], v[60:63], v[184:187]
    ds_read_b64_tr_b16 a[252:253], v13 offset:9248
    v_mfma_f32_16x16x32_bf16 v[180:183], a[228:231], v[56:59], v[180:183]
    ds_read_b64_tr_b16 a[254:255], v13 offset:13856
    buffer_load_dwordx4 v10, s[12:15], s32 offen offset:3072 lds
    v_exp_f32 v24, v80
    v_mfma_f32_16x16x32_bf16 v[188:191], a[228:231], v[60:63], v[188:191]
    ds_read_b64_tr_b16 a[224:225], v13 offset:64
    s_waitcnt lgkmcnt(9)
    v_mfma_f32_16x16x32_bf16 v[192:195], a[232:235], v[56:59], v[192:195]
    ds_read_b64_tr_b16 a[226:227], v13 offset:4672
    s_add_u32 m0, m0, 0x400
    s_mov_b64 exec, s[34:35]
    buffer_load_dwordx4 v11, s[12:15], s32 offen offset:3072 lds
    s_mov_b64 exec, -1
    v_mfma_f32_16x16x32_bf16 v[200:203], a[232:235], v[60:63], v[200:203]
    ds_read_b64_tr_b16 a[228:229], v13 offset:9280
    v_mfma_f32_16x16x32_bf16 v[196:199], a[236:239], v[56:59], v[196:199]
    ds_read_b64_tr_b16 a[230:231], v13 offset:13888
    v_exp_f32 v25, v81
    v_exp_f32 v26, v82
    v_mfma_f32_16x16x32_bf16 v[204:207], a[236:239], v[60:63], v[204:207]
    ds_read_b64_tr_b16 a[232:233], v13 offset:96
    s_waitcnt lgkmcnt(9)
    v_mfma_f32_16x16x32_bf16 v[208:211], a[240:243], v[48:51], v[208:211]
    ds_read_b64_tr_b16 a[234:235], v13 offset:4704
    v_exp_f32 v27, v83
    v_pk_add_f32 v[24:25], v[24:25], 1.0 op_sel_hi:[1,0]
    v_mfma_f32_16x16x32_bf16 v[216:219], a[240:243], v[52:55], v[216:219]
    ds_read_b64_tr_b16 a[236:237], v13 offset:9312
    v_mfma_f32_16x16x32_bf16 v[212:215], a[244:247], v[48:51], v[212:215]
    ds_read_b64_tr_b16 a[238:239], v13 offset:13920
    v_pk_add_f32 v[26:27], v[26:27], 1.0 op_sel_hi:[1,0]
    v_rcp_f32 v24, v24
    v_mfma_f32_16x16x32_bf16 v[220:223], a[244:247], v[52:55], v[220:223]
    ds_read_b64_tr_b16 a[240:241], v13 offset:128
    s_waitcnt lgkmcnt(9)
    v_mfma_f32_16x16x32_bf16 v[224:227], a[248:251], v[48:51], v[224:227]
    ds_read_b64_tr_b16 a[242:243], v13 offset:4736
    v_rcp_f32 v25, v25
    v_rcp_f32 v26, v26
    v_mfma_f32_16x16x32_bf16 v[232:235], a[248:251], v[52:55], v[232:235]
    ds_read_b64_tr_b16 a[244:245], v13 offset:9344
    v_mfma_f32_16x16x32_bf16 v[228:231], a[252:255], v[48:51], v[228:231]
    ds_read_b64_tr_b16 a[246:247], v13 offset:13952
    v_rcp_f32 v27, v27
    v_pk_mul_f32 v[24:25], v[24:25], v[84:85]
    v_mfma_f32_16x16x32_bf16 v[236:239], a[252:255], v[52:55], v[236:239]
    ds_read_b64_tr_b16 a[248:249], v13 offset:160
    s_waitcnt lgkmcnt(9)
    v_mfma_f32_16x16x32_bf16 v[240:243], a[224:227], v[48:51], v[240:243]
    ds_read_b64_tr_b16 a[250:251], v13 offset:4768
    v_pk_mul_f32 v[26:27], v[26:27], v[86:87]
    v_cvt_pk_bf16_f32 v66, v24, v25
    v_cvt_pk_bf16_f32 v67, v26, v27
    v_exp_f32 v24, v72
    v_mfma_f32_16x16x32_bf16 v[248:251], a[224:227], v[52:55], v[248:251]
    ds_read_b64_tr_b16 a[252:253], v13 offset:9376
    v_mfma_f32_16x16x32_bf16 v[244:247], a[228:231], v[48:51], v[244:247]
    ds_read_b64_tr_b16 a[254:255], v13 offset:13984
    v_exp_f32 v25, v73
    v_exp_f32 v26, v74
    v_exp_f32 v27, v75
    v_pk_add_f32 v[24:25], v[24:25], 1.0 op_sel_hi:[1,0]
    v_mfma_f32_16x16x32_bf16 v[252:255], a[228:231], v[52:55], v[252:255]
    ds_read_b64_tr_b16 a[224:225], v13 offset:192
    s_waitcnt lgkmcnt(9)
    v_mfma_f32_16x16x32_bf16 a[0:3], a[232:235], v[48:51], a[0:3]
    ds_read_b64_tr_b16 a[226:227], v13 offset:4800
    v_pk_add_f32 v[26:27], v[26:27], 1.0 op_sel_hi:[1,0]
    v_rcp_f32 v24, v24
    v_rcp_f32 v25, v25
    v_rcp_f32 v26, v26
    v_mfma_f32_16x16x32_bf16 a[8:11], a[232:235], v[52:55], a[8:11]
    ds_read_b64_tr_b16 a[228:229], v13 offset:9408
    v_mfma_f32_16x16x32_bf16 a[4:7], a[236:239], v[48:51], a[4:7]
    ds_read_b64_tr_b16 a[230:231], v13 offset:14016
    v_rcp_f32 v27, v27
    v_pk_mul_f32 v[24:25], v[24:25], v[76:77]
    v_pk_mul_f32 v[26:27], v[26:27], v[78:79]
    v_cvt_pk_bf16_f32 v68, v24, v25
    v_mfma_f32_16x16x32_bf16 a[12:15], a[236:239], v[52:55], a[12:15]
    ds_read_b64_tr_b16 a[232:233], v13 offset:224
    s_waitcnt lgkmcnt(9)
    v_mfma_f32_16x16x32_bf16 a[16:19], a[240:243], v[48:51], a[16:19]
    ds_read_b64_tr_b16 a[234:235], v13 offset:4832
    v_cvt_pk_bf16_f32 v69, v26, v27
    v_exp_f32 v24, v88
    v_exp_f32 v25, v89
    v_exp_f32 v26, v90
    v_mfma_f32_16x16x32_bf16 a[24:27], a[240:243], v[52:55], a[24:27]
    ds_read_b64_tr_b16 a[236:237], v13 offset:9440
    v_mfma_f32_16x16x32_bf16 a[20:23], a[244:247], v[48:51], a[20:23]
    ds_read_b64_tr_b16 a[238:239], v13 offset:14048
    v_exp_f32 v27, v91
    v_pk_add_f32 v[24:25], v[24:25], 1.0 op_sel_hi:[1,0]
    v_pk_add_f32 v[26:27], v[26:27], 1.0 op_sel_hi:[1,0]
    v_rcp_f32 v24, v24
    v_mfma_f32_16x16x32_bf16 a[28:31], a[244:247], v[52:55], a[28:31]
    ds_read_b64_tr_b16 a[240:241], v13 offset:256
    s_waitcnt lgkmcnt(9)
    v_mfma_f32_16x16x32_bf16 a[32:35], a[248:251], v[48:51], a[32:35]
    ds_read_b64_tr_b16 a[242:243], v13 offset:4864
    v_rcp_f32 v25, v25
    v_rcp_f32 v26, v26
    v_rcp_f32 v27, v27
    v_pk_mul_f32 v[24:25], v[24:25], v[92:93]
    v_mfma_f32_16x16x32_bf16 a[40:43], a[248:251], v[52:55], a[40:43]
    ds_read_b64_tr_b16 a[244:245], v13 offset:9472
    v_mfma_f32_16x16x32_bf16 a[36:39], a[252:255], v[48:51], a[36:39]
    ds_read_b64_tr_b16 a[246:247], v13 offset:14080
    v_pk_mul_f32 v[26:27], v[26:27], v[94:95]
    v_cvt_pk_bf16_f32 v70, v24, v25
    v_cvt_pk_bf16_f32 v71, v26, v27
    v_exp_f32 v24, v96
    v_mfma_f32_16x16x32_bf16 a[44:47], a[252:255], v[52:55], a[44:47]
    s_barrier
    ds_read_b64_tr_b16 a[248:249], v13 offset:18496
    s_waitcnt lgkmcnt(9)
    v_mfma_f32_16x16x32_bf16 a[48:51], a[224:227], v[48:51], a[48:51]
    ds_read_b64_tr_b16 a[250:251], v13 offset:23104
    s_add_u32 m0, s52, 18496
    s_mov_b32 s32, 184320
    buffer_load_dwordx4 v7, s[12:15], s32 offen offset:0 lds
    v_exp_f32 v25, v97
    v_mfma_f32_16x16x32_bf16 a[56:59], a[224:227], v[52:55], a[56:59]
    ds_read_b64_tr_b16 a[252:253], v13 offset:27712
    v_mfma_f32_16x16x32_bf16 a[52:55], a[228:231], v[48:51], a[52:55]
    ds_read_b64_tr_b16 a[254:255], v13 offset:32320
    buffer_load_dwordx4 v8, s[12:15], s32 offen offset:1024 lds
    v_exp_f32 v26, v98
    v_exp_f32 v27, v99
    v_pk_add_f32 v[24:25], v[24:25], 1.0 op_sel_hi:[1,0]
    v_mfma_f32_16x16x32_bf16 a[60:63], a[228:231], v[52:55], a[60:63]
    ds_read_b64_tr_b16 a[224:225], v13 offset:18528
    s_waitcnt lgkmcnt(9)
    v_mfma_f32_16x16x32_bf16 a[64:67], a[232:235], v[48:51], a[64:67]
    ds_read_b64_tr_b16 a[226:227], v13 offset:23136
    buffer_load_dwordx4 v9, s[12:15], s32 offen offset:2048 lds
    v_pk_add_f32 v[26:27], v[26:27], 1.0 op_sel_hi:[1,0]
    v_rcp_f32 v24, v24
    v_rcp_f32 v25, v25
    v_mfma_f32_16x16x32_bf16 a[72:75], a[232:235], v[52:55], a[72:75]
    ds_read_b64_tr_b16 a[228:229], v13 offset:27744
    v_mfma_f32_16x16x32_bf16 a[68:71], a[236:239], v[48:51], a[68:71]
    ds_read_b64_tr_b16 a[230:231], v13 offset:32352
    buffer_load_dwordx4 v10, s[12:15], s32 offen offset:3072 lds
    v_rcp_f32 v26, v26
    v_rcp_f32 v27, v27
    v_pk_mul_f32 v[24:25], v[24:25], v[100:101]
    v_mfma_f32_16x16x32_bf16 a[76:79], a[236:239], v[52:55], a[76:79]
    ds_read_b64_tr_b16 a[232:233], v13 offset:18560
    s_waitcnt lgkmcnt(9)
    v_mfma_f32_16x16x32_bf16 a[80:83], a[240:243], v[48:51], a[80:83]
    ds_read_b64_tr_b16 a[234:235], v13 offset:23168
    s_add_u32 m0, m0, 0x400
    s_mov_b64 exec, s[34:35]
    buffer_load_dwordx4 v11, s[12:15], s32 offen offset:3072 lds
    s_mov_b64 exec, -1
    v_pk_mul_f32 v[26:27], v[26:27], v[102:103]
    v_cvt_pk_bf16_f32 v72, v24, v25
    v_mfma_f32_16x16x32_bf16 a[88:91], a[240:243], v[52:55], a[88:91]
    ds_read_b64_tr_b16 a[236:237], v13 offset:27776
    v_mfma_f32_16x16x32_bf16 a[84:87], a[244:247], v[48:51], a[84:87]
    ds_read_b64_tr_b16 a[238:239], v13 offset:32384
    v_cvt_pk_bf16_f32 v73, v26, v27
    v_exp_f32 v24, v112
    v_exp_f32 v25, v113
    v_exp_f32 v26, v114
    v_mfma_f32_16x16x32_bf16 a[92:95], a[244:247], v[52:55], a[92:95]
    ds_read_b64_tr_b16 a[240:241], v13 offset:18592
    s_waitcnt lgkmcnt(9)
    v_mfma_f32_16x16x32_bf16 v[208:211], a[248:251], v[56:59], v[208:211]
    ds_read_b64_tr_b16 a[242:243], v13 offset:23200
    v_exp_f32 v27, v115
    v_pk_add_f32 v[24:25], v[24:25], 1.0 op_sel_hi:[1,0]
    v_pk_add_f32 v[26:27], v[26:27], 1.0 op_sel_hi:[1,0]
    v_rcp_f32 v24, v24
    v_mfma_f32_16x16x32_bf16 v[216:219], a[248:251], v[60:63], v[216:219]
    ds_read_b64_tr_b16 a[244:245], v13 offset:27808
    v_mfma_f32_16x16x32_bf16 v[212:215], a[252:255], v[56:59], v[212:215]
    ds_read_b64_tr_b16 a[246:247], v13 offset:32416
    v_rcp_f32 v25, v25
    v_rcp_f32 v26, v26
    v_rcp_f32 v27, v27
    v_pk_mul_f32 v[24:25], v[24:25], v[116:117]
    v_mfma_f32_16x16x32_bf16 v[220:223], a[252:255], v[60:63], v[220:223]
    ds_read_b64_tr_b16 a[248:249], v13 offset:18624
    s_waitcnt lgkmcnt(9)
    v_mfma_f32_16x16x32_bf16 v[224:227], a[224:227], v[56:59], v[224:227]
    ds_read_b64_tr_b16 a[250:251], v13 offset:23232
    v_pk_mul_f32 v[26:27], v[26:27], v[118:119]
    v_cvt_pk_bf16_f32 v74, v24, v25
    v_cvt_pk_bf16_f32 v75, v26, v27
    v_exp_f32 v24, v104
    v_mfma_f32_16x16x32_bf16 v[232:235], a[224:227], v[60:63], v[232:235]
    ds_read_b64_tr_b16 a[252:253], v13 offset:27840
    v_mfma_f32_16x16x32_bf16 v[228:231], a[228:231], v[56:59], v[228:231]
    ds_read_b64_tr_b16 a[254:255], v13 offset:32448
    v_exp_f32 v25, v105
    v_exp_f32 v26, v106
    v_exp_f32 v27, v107
    v_pk_add_f32 v[24:25], v[24:25], 1.0 op_sel_hi:[1,0]
    v_mfma_f32_16x16x32_bf16 v[236:239], a[228:231], v[60:63], v[236:239]
    ds_read_b64_tr_b16 a[224:225], v13 offset:18656
    s_waitcnt lgkmcnt(9)
    v_mfma_f32_16x16x32_bf16 v[240:243], a[232:235], v[56:59], v[240:243]
    ds_read_b64_tr_b16 a[226:227], v13 offset:23264
    v_pk_add_f32 v[26:27], v[26:27], 1.0 op_sel_hi:[1,0]
    v_rcp_f32 v24, v24
    v_rcp_f32 v25, v25
    v_rcp_f32 v26, v26
    v_mfma_f32_16x16x32_bf16 v[248:251], a[232:235], v[60:63], v[248:251]
    ds_read_b64_tr_b16 a[228:229], v13 offset:27872
    v_mfma_f32_16x16x32_bf16 v[244:247], a[236:239], v[56:59], v[244:247]
    ds_read_b64_tr_b16 a[230:231], v13 offset:32480
    v_rcp_f32 v27, v27
    v_pk_mul_f32 v[24:25], v[24:25], v[108:109]
    v_pk_mul_f32 v[26:27], v[26:27], v[110:111]
    v_cvt_pk_bf16_f32 v76, v24, v25
    v_mfma_f32_16x16x32_bf16 v[252:255], a[236:239], v[60:63], v[252:255]
    ds_read_b64_tr_b16 a[232:233], v13 offset:18688
    s_waitcnt lgkmcnt(9)
    v_mfma_f32_16x16x32_bf16 a[0:3], a[240:243], v[56:59], a[0:3]
    ds_read_b64_tr_b16 a[234:235], v13 offset:23296
    v_cvt_pk_bf16_f32 v77, v26, v27
    v_exp_f32 v24, v120
    v_exp_f32 v25, v121
    v_exp_f32 v26, v122
    v_mfma_f32_16x16x32_bf16 a[8:11], a[240:243], v[60:63], a[8:11]
    ds_read_b64_tr_b16 a[236:237], v13 offset:27904
    v_mfma_f32_16x16x32_bf16 a[4:7], a[244:247], v[56:59], a[4:7]
    ds_read_b64_tr_b16 a[238:239], v13 offset:32512
    v_exp_f32 v27, v123
    v_pk_add_f32 v[24:25], v[24:25], 1.0 op_sel_hi:[1,0]
    v_pk_add_f32 v[26:27], v[26:27], 1.0 op_sel_hi:[1,0]
    v_rcp_f32 v24, v24
    v_mfma_f32_16x16x32_bf16 a[12:15], a[244:247], v[60:63], a[12:15]
    ds_read_b64_tr_b16 a[240:241], v13 offset:18720
    s_waitcnt lgkmcnt(9)
    v_mfma_f32_16x16x32_bf16 a[16:19], a[248:251], v[56:59], a[16:19]
    ds_read_b64_tr_b16 a[242:243], v13 offset:23328
    v_rcp_f32 v25, v25
    v_rcp_f32 v26, v26
    v_rcp_f32 v27, v27
    v_pk_mul_f32 v[24:25], v[24:25], v[124:125]
    v_mfma_f32_16x16x32_bf16 a[24:27], a[248:251], v[60:63], a[24:27]
    ds_read_b64_tr_b16 a[244:245], v13 offset:27936
    v_mfma_f32_16x16x32_bf16 a[20:23], a[252:255], v[56:59], a[20:23]
    ds_read_b64_tr_b16 a[246:247], v13 offset:32544
    v_pk_mul_f32 v[26:27], v[26:27], v[126:127]
    v_cvt_pk_bf16_f32 v78, v24, v25
    v_cvt_pk_bf16_f32 v79, v26, v27
    v_exp_f32 v24, v128
    v_mfma_f32_16x16x32_bf16 a[28:31], a[252:255], v[60:63], a[28:31]
    ds_read_b64_tr_b16 a[248:249], v13 offset:18752
    s_waitcnt lgkmcnt(9)
    v_mfma_f32_16x16x32_bf16 a[32:35], a[224:227], v[56:59], a[32:35]
    ds_read_b64_tr_b16 a[250:251], v13 offset:23360
    v_exp_f32 v25, v129
    v_exp_f32 v26, v130
    v_exp_f32 v27, v131
    v_pk_add_f32 v[24:25], v[24:25], 1.0 op_sel_hi:[1,0]
    v_mfma_f32_16x16x32_bf16 a[40:43], a[224:227], v[60:63], a[40:43]
    ds_read_b64_tr_b16 a[252:253], v13 offset:27968
    v_mfma_f32_16x16x32_bf16 a[36:39], a[228:231], v[56:59], a[36:39]
    ds_read_b64_tr_b16 a[254:255], v13 offset:32576
    v_pk_add_f32 v[26:27], v[26:27], 1.0 op_sel_hi:[1,0]
    v_rcp_f32 v24, v24
    v_rcp_f32 v25, v25
    v_rcp_f32 v26, v26
    v_mfma_f32_16x16x32_bf16 a[44:47], a[228:231], v[60:63], a[44:47]
    s_waitcnt vmcnt(25)
    s_barrier
    v_add_u32 v12, s54, v12
    v_add_u32 v13, s54, v13
    s_sub_u32 s54, 0, s54
    ds_read_b64_tr_b16 a[224:225], v12 offset:0
    s_waitcnt lgkmcnt(9)
    v_mfma_f32_16x16x32_bf16 a[48:51], a[232:235], v[56:59], a[48:51]
    ds_read_b64_tr_b16 a[226:227], v12 offset:4608
    s_add_u32 m0, s52, 36992
    s_mov_b32 s32, 221184
    buffer_load_dwordx4 v7, s[12:15], s32 offen offset:0 lds
    v_rcp_f32 v27, v27
    v_mfma_f32_16x16x32_bf16 a[56:59], a[232:235], v[60:63], a[56:59]
    ds_read_b64_tr_b16 a[228:229], v12 offset:32
    v_mfma_f32_16x16x32_bf16 a[52:55], a[236:239], v[56:59], a[52:55]
    ds_read_b64_tr_b16 a[230:231], v12 offset:4640
    buffer_load_dwordx4 v8, s[12:15], s32 offen offset:1024 lds
    v_pk_mul_f32 v[24:25], v[24:25], v[132:133]
    v_pk_mul_f32 v[26:27], v[26:27], v[134:135]
    v_cvt_pk_bf16_f32 v80, v24, v25
    v_mfma_f32_16x16x32_bf16 a[60:63], a[236:239], v[60:63], a[60:63]
    ds_read_b64_tr_b16 a[232:233], v12 offset:64
    s_waitcnt lgkmcnt(9)
    v_mfma_f32_16x16x32_bf16 a[64:67], a[240:243], v[56:59], a[64:67]
    ds_read_b64_tr_b16 a[234:235], v12 offset:4672
    buffer_load_dwordx4 v9, s[12:15], s32 offen offset:2048 lds
    v_cvt_pk_bf16_f32 v81, v26, v27
    v_exp_f32 v24, v144
    v_exp_f32 v25, v145
    v_mfma_f32_16x16x32_bf16 a[72:75], a[240:243], v[60:63], a[72:75]
    ds_read_b64_tr_b16 a[236:237], v12 offset:96
    v_mfma_f32_16x16x32_bf16 a[68:71], a[244:247], v[56:59], a[68:71]
    ds_read_b64_tr_b16 a[238:239], v12 offset:4704
    buffer_load_dwordx4 v10, s[12:15], s32 offen offset:3072 lds
    v_exp_f32 v26, v146
    v_exp_f32 v27, v147
    v_pk_add_f32 v[24:25], v[24:25], 1.0 op_sel_hi:[1,0]
    v_mfma_f32_16x16x32_bf16 a[76:79], a[244:247], v[60:63], a[76:79]
    ds_read_b64_tr_b16 a[240:241], v12 offset:128
    s_waitcnt lgkmcnt(9)
    v_mfma_f32_16x16x32_bf16 a[80:83], a[248:251], v[56:59], a[80:83]
    ds_read_b64_tr_b16 a[242:243], v12 offset:4736
    s_add_u32 m0, m0, 0x400
    s_mov_b64 exec, s[34:35]
    buffer_load_dwordx4 v11, s[12:15], s32 offen offset:3072 lds
    s_mov_b64 exec, -1
    v_pk_add_f32 v[26:27], v[26:27], 1.0 op_sel_hi:[1,0]
    v_rcp_f32 v24, v24
    v_mfma_f32_16x16x32_bf16 a[88:91], a[248:251], v[60:63], a[88:91]
    ds_read_b64_tr_b16 a[244:245], v12 offset:160
    v_mfma_f32_16x16x32_bf16 a[84:87], a[252:255], v[56:59], a[84:87]
    ds_read_b64_tr_b16 a[246:247], v12 offset:4768
    v_rcp_f32 v25, v25
    v_rcp_f32 v26, v26
    v_rcp_f32 v27, v27
    v_pk_mul_f32 v[24:25], v[24:25], v[148:149]
    v_mfma_f32_16x16x32_bf16 a[92:95], a[252:255], v[60:63], a[92:95]
    ds_read_b64_tr_b16 a[248:249], v12 offset:192
    s_waitcnt lgkmcnt(9)
    v_mfma_f32_16x16x32_bf16 a[96:99], a[224:227], v[64:67], 0
    ds_read_b64_tr_b16 a[250:251], v12 offset:4800
    v_pk_mul_f32 v[26:27], v[26:27], v[150:151]
    v_cvt_pk_bf16_f32 v82, v24, v25
    v_cvt_pk_bf16_f32 v83, v26, v27
    v_exp_f32 v24, v136
    v_mfma_f32_16x16x32_bf16 a[104:107], a[224:227], v[68:71], 0
    ds_read_b64_tr_b16 a[252:253], v12 offset:224
    v_mfma_f32_16x16x32_bf16 a[100:103], a[228:231], v[64:67], 0
    ds_read_b64_tr_b16 a[254:255], v12 offset:4832
    v_exp_f32 v25, v137
    v_exp_f32 v26, v138
    v_exp_f32 v27, v139
    v_pk_add_f32 v[24:25], v[24:25], 1.0 op_sel_hi:[1,0]
    v_mfma_f32_16x16x32_bf16 a[108:111], a[228:231], v[68:71], 0
    ds_read_b64_tr_b16 a[224:225], v12 offset:256
    s_waitcnt lgkmcnt(9)
    v_mfma_f32_16x16x32_bf16 a[112:115], a[232:235], v[64:67], 0
    ds_read_b64_tr_b16 a[226:227], v12 offset:4864
    v_pk_add_f32 v[26:27], v[26:27], 1.0 op_sel_hi:[1,0]
    v_rcp_f32 v24, v24
    v_rcp_f32 v25, v25
    v_rcp_f32 v26, v26
    v_mfma_f32_16x16x32_bf16 a[120:123], a[232:235], v[68:71], 0
    ds_read_b64_tr_b16 a[228:229], v12 offset:9216
    v_mfma_f32_16x16x32_bf16 a[116:119], a[236:239], v[64:67], 0
    ds_read_b64_tr_b16 a[230:231], v12 offset:13824
    v_rcp_f32 v27, v27
    v_pk_mul_f32 v[24:25], v[24:25], v[140:141]
    v_pk_mul_f32 v[26:27], v[26:27], v[142:143]
    v_cvt_pk_bf16_f32 v84, v24, v25
    v_mfma_f32_16x16x32_bf16 a[124:127], a[236:239], v[68:71], 0
    ds_read_b64_tr_b16 a[232:233], v12 offset:9248
    s_waitcnt lgkmcnt(9)
    v_mfma_f32_16x16x32_bf16 a[128:131], a[240:243], v[64:67], 0
    ds_read_b64_tr_b16 a[234:235], v12 offset:13856
    v_cvt_pk_bf16_f32 v85, v26, v27
    v_exp_f32 v24, v152
    v_exp_f32 v25, v153
    v_exp_f32 v26, v154
    v_mfma_f32_16x16x32_bf16 a[136:139], a[240:243], v[68:71], 0
    ds_read_b64_tr_b16 a[236:237], v12 offset:9280
    v_mfma_f32_16x16x32_bf16 a[132:135], a[244:247], v[64:67], 0
    ds_read_b64_tr_b16 a[238:239], v12 offset:13888
    v_exp_f32 v27, v155
    v_pk_add_f32 v[24:25], v[24:25], 1.0 op_sel_hi:[1,0]
    v_pk_add_f32 v[26:27], v[26:27], 1.0 op_sel_hi:[1,0]
    v_rcp_f32 v24, v24
    v_mfma_f32_16x16x32_bf16 a[140:143], a[244:247], v[68:71], 0
    ds_read_b64_tr_b16 a[240:241], v12 offset:9312
    s_waitcnt lgkmcnt(9)
    v_mfma_f32_16x16x32_bf16 a[144:147], a[248:251], v[64:67], 0
    ds_read_b64_tr_b16 a[242:243], v12 offset:13920
    v_rcp_f32 v25, v25
    v_rcp_f32 v26, v26
    v_rcp_f32 v27, v27
    v_pk_mul_f32 v[24:25], v[24:25], v[156:157]
    v_mfma_f32_16x16x32_bf16 a[152:155], a[248:251], v[68:71], 0
    ds_read_b64_tr_b16 a[244:245], v12 offset:9344
    v_mfma_f32_16x16x32_bf16 a[148:151], a[252:255], v[64:67], 0
    ds_read_b64_tr_b16 a[246:247], v12 offset:13952
    v_pk_mul_f32 v[26:27], v[26:27], v[158:159]
    v_cvt_pk_bf16_f32 v86, v24, v25
    v_cvt_pk_bf16_f32 v87, v26, v27
    v_exp_f32 v24, v160
    v_mfma_f32_16x16x32_bf16 a[156:159], a[252:255], v[68:71], 0
    ds_read_b64_tr_b16 a[248:249], v12 offset:9376
    s_waitcnt lgkmcnt(9)
    v_mfma_f32_16x16x32_bf16 a[160:163], a[224:227], v[64:67], 0
    ds_read_b64_tr_b16 a[250:251], v12 offset:13984
    v_exp_f32 v25, v161
    v_exp_f32 v26, v162
    v_exp_f32 v27, v163
    v_pk_add_f32 v[24:25], v[24:25], 1.0 op_sel_hi:[1,0]
    v_mfma_f32_16x16x32_bf16 a[168:171], a[224:227], v[68:71], 0
    ds_read_b64_tr_b16 a[252:253], v12 offset:9408
    v_mfma_f32_16x16x32_bf16 a[164:167], a[228:231], v[64:67], 0
    ds_read_b64_tr_b16 a[254:255], v12 offset:14016
    v_pk_add_f32 v[26:27], v[26:27], 1.0 op_sel_hi:[1,0]
    v_rcp_f32 v24, v24
    v_rcp_f32 v25, v25
    v_rcp_f32 v26, v26
    v_mfma_f32_16x16x32_bf16 a[172:175], a[228:231], v[68:71], 0
    ds_read_b64_tr_b16 a[224:225], v12 offset:9440
    s_waitcnt lgkmcnt(9)
    v_mfma_f32_16x16x32_bf16 a[176:179], a[232:235], v[64:67], 0
    ds_read_b64_tr_b16 a[226:227], v12 offset:14048
    v_rcp_f32 v27, v27
    v_pk_mul_f32 v[24:25], v[24:25], v[164:165]
    v_pk_mul_f32 v[26:27], v[26:27], v[166:167]
    v_cvt_pk_bf16_f32 v88, v24, v25
    v_mfma_f32_16x16x32_bf16 a[184:187], a[232:235], v[68:71], 0
    ds_read_b64_tr_b16 a[228:229], v12 offset:9472
    v_mfma_f32_16x16x32_bf16 a[180:183], a[236:239], v[64:67], 0
    ds_read_b64_tr_b16 a[230:231], v12 offset:14080
    v_cvt_pk_bf16_f32 v89, v26, v27
    v_exp_f32 v24, v176
    v_exp_f32 v25, v177
    v_exp_f32 v26, v178
    v_mfma_f32_16x16x32_bf16 a[188:191], a[236:239], v[68:71], 0
    s_waitcnt vmcnt(25)
    s_barrier
    ds_read_b64_tr_b16 a[232:233], v12 offset:18496
    s_waitcnt lgkmcnt(9)
    v_mfma_f32_16x16x32_bf16 a[192:195], a[240:243], v[64:67], 0
    ds_read_b64_tr_b16 a[234:235], v12 offset:23104
    s_add_u32 m0, s52, 55488
    s_mov_b32 s32, 258048
    buffer_load_dwordx4 v7, s[12:15], s32 offen offset:0 lds
    v_exp_f32 v27, v179
    v_mfma_f32_16x16x32_bf16 a[200:203], a[240:243], v[68:71], 0
    ds_read_b64_tr_b16 a[236:237], v12 offset:18528
    v_mfma_f32_16x16x32_bf16 a[196:199], a[244:247], v[64:67], 0
    ds_read_b64_tr_b16 a[238:239], v12 offset:23136
    buffer_load_dwordx4 v8, s[12:15], s32 offen offset:1024 lds
    v_pk_add_f32 v[24:25], v[24:25], 1.0 op_sel_hi:[1,0]
    v_pk_add_f32 v[26:27], v[26:27], 1.0 op_sel_hi:[1,0]
    v_rcp_f32 v24, v24
    v_mfma_f32_16x16x32_bf16 a[204:207], a[244:247], v[68:71], 0
    ds_read_b64_tr_b16 a[240:241], v12 offset:18560
    s_waitcnt lgkmcnt(9)
    v_mfma_f32_16x16x32_bf16 a[208:211], a[248:251], v[64:67], 0
    ds_read_b64_tr_b16 a[242:243], v12 offset:23168
    buffer_load_dwordx4 v9, s[12:15], s32 offen offset:2048 lds
    v_rcp_f32 v25, v25
    v_rcp_f32 v26, v26
    v_rcp_f32 v27, v27
    v_mfma_f32_16x16x32_bf16 a[216:219], a[248:251], v[68:71], 0
    ds_read_b64_tr_b16 a[244:245], v12 offset:18592
    v_mfma_f32_16x16x32_bf16 a[212:215], a[252:255], v[64:67], 0
    ds_read_b64_tr_b16 a[246:247], v12 offset:23200
    buffer_load_dwordx4 v10, s[12:15], s32 offen offset:3072 lds
    v_pk_mul_f32 v[24:25], v[24:25], v[180:181]
    v_pk_mul_f32 v[26:27], v[26:27], v[182:183]
    v_cvt_pk_bf16_f32 v90, v24, v25
    v_mfma_f32_16x16x32_bf16 a[220:223], a[252:255], v[68:71], 0
    ds_read_b64_tr_b16 a[248:249], v12 offset:18624
    s_waitcnt lgkmcnt(9)
    v_mfma_f32_16x16x32_bf16 v[32:35], a[224:227], v[64:67], 0
    ds_read_b64_tr_b16 a[250:251], v12 offset:23232
    s_add_u32 m0, m0, 0x400
    s_mov_b64 exec, s[34:35]
    buffer_load_dwordx4 v11, s[12:15], s32 offen offset:3072 lds
    s_mov_b64 exec, -1
    v_cvt_pk_bf16_f32 v91, v26, v27
    v_exp_f32 v24, v168
    v_mfma_f32_16x16x32_bf16 v[40:43], a[224:227], v[68:71], 0
    ds_read_b64_tr_b16 a[252:253], v12 offset:18656
    v_mfma_f32_16x16x32_bf16 v[36:39], a[228:231], v[64:67], 0
    ds_read_b64_tr_b16 a[254:255], v12 offset:23264
    v_exp_f32 v25, v169
    v_exp_f32 v26, v170
    v_exp_f32 v27, v171
    v_pk_add_f32 v[24:25], v[24:25], 1.0 op_sel_hi:[1,0]
    v_mfma_f32_16x16x32_bf16 v[44:47], a[228:231], v[68:71], 0
    ds_read_b64_tr_b16 a[224:225], v12 offset:18688
    s_waitcnt lgkmcnt(9)
    v_mfma_f32_16x16x32_bf16 a[96:99], a[232:235], v[72:75], a[96:99]
    ds_read_b64_tr_b16 a[226:227], v12 offset:23296
    v_pk_add_f32 v[26:27], v[26:27], 1.0 op_sel_hi:[1,0]
    v_rcp_f32 v24, v24
    v_rcp_f32 v25, v25
    v_rcp_f32 v26, v26
    v_mfma_f32_16x16x32_bf16 a[104:107], a[232:235], v[76:79], a[104:107]
    ds_read_b64_tr_b16 a[228:229], v12 offset:18720
    v_mfma_f32_16x16x32_bf16 a[100:103], a[236:239], v[72:75], a[100:103]
    ds_read_b64_tr_b16 a[230:231], v12 offset:23328
    v_rcp_f32 v27, v27
    v_pk_mul_f32 v[24:25], v[24:25], v[172:173]
    v_pk_mul_f32 v[26:27], v[26:27], v[174:175]
    v_cvt_pk_bf16_f32 v92, v24, v25
    v_mfma_f32_16x16x32_bf16 a[108:111], a[236:239], v[76:79], a[108:111]
    ds_read_b64_tr_b16 a[232:233], v12 offset:18752
    s_waitcnt lgkmcnt(9)
    v_mfma_f32_16x16x32_bf16 a[112:115], a[240:243], v[72:75], a[112:115]
    ds_read_b64_tr_b16 a[234:235], v12 offset:23360
    v_cvt_pk_bf16_f32 v93, v26, v27
    v_exp_f32 v24, v184
    v_exp_f32 v25, v185
    v_exp_f32 v26, v186
    v_mfma_f32_16x16x32_bf16 a[120:123], a[240:243], v[76:79], a[120:123]
    ds_read_b64_tr_b16 a[236:237], v12 offset:27712
    v_mfma_f32_16x16x32_bf16 a[116:119], a[244:247], v[72:75], a[116:119]
    ds_read_b64_tr_b16 a[238:239], v12 offset:32320
    v_exp_f32 v27, v187
    v_pk_add_f32 v[24:25], v[24:25], 1.0 op_sel_hi:[1,0]
    v_pk_add_f32 v[26:27], v[26:27], 1.0 op_sel_hi:[1,0]
    v_rcp_f32 v24, v24
    v_mfma_f32_16x16x32_bf16 a[124:127], a[244:247], v[76:79], a[124:127]
    ds_read_b64_tr_b16 a[240:241], v12 offset:27744
    s_waitcnt lgkmcnt(9)
    v_mfma_f32_16x16x32_bf16 a[128:131], a[248:251], v[72:75], a[128:131]
    ds_read_b64_tr_b16 a[242:243], v12 offset:32352
    v_rcp_f32 v25, v25
    v_rcp_f32 v26, v26
    v_rcp_f32 v27, v27
    v_pk_mul_f32 v[24:25], v[24:25], v[188:189]
    v_mfma_f32_16x16x32_bf16 a[136:139], a[248:251], v[76:79], a[136:139]
    ds_read_b64_tr_b16 a[244:245], v12 offset:27776
    v_mfma_f32_16x16x32_bf16 a[132:135], a[252:255], v[72:75], a[132:135]
    ds_read_b64_tr_b16 a[246:247], v12 offset:32384
    v_pk_mul_f32 v[26:27], v[26:27], v[190:191]
    v_cvt_pk_bf16_f32 v94, v24, v25
    v_cvt_pk_bf16_f32 v95, v26, v27
    v_exp_f32 v24, v192
    v_mfma_f32_16x16x32_bf16 a[140:143], a[252:255], v[76:79], a[140:143]
    ds_read_b64_tr_b16 a[248:249], v12 offset:27808
    s_waitcnt lgkmcnt(9)
    v_mfma_f32_16x16x32_bf16 a[144:147], a[224:227], v[72:75], a[144:147]
    ds_read_b64_tr_b16 a[250:251], v12 offset:32416
    v_exp_f32 v25, v193
    v_exp_f32 v26, v194
    v_exp_f32 v27, v195
    v_pk_add_f32 v[24:25], v[24:25], 1.0 op_sel_hi:[1,0]
    v_mfma_f32_16x16x32_bf16 a[152:155], a[224:227], v[76:79], a[152:155]
    ds_read_b64_tr_b16 a[252:253], v12 offset:27840
    v_mfma_f32_16x16x32_bf16 a[148:151], a[228:231], v[72:75], a[148:151]
    ds_read_b64_tr_b16 a[254:255], v12 offset:32448
    v_pk_add_f32 v[26:27], v[26:27], 1.0 op_sel_hi:[1,0]
    v_rcp_f32 v24, v24
    v_rcp_f32 v25, v25
    v_rcp_f32 v26, v26
    v_mfma_f32_16x16x32_bf16 a[156:159], a[228:231], v[76:79], a[156:159]
    ds_read_b64_tr_b16 a[224:225], v12 offset:27872
    s_waitcnt lgkmcnt(9)
    v_mfma_f32_16x16x32_bf16 a[160:163], a[232:235], v[72:75], a[160:163]
    ds_read_b64_tr_b16 a[226:227], v12 offset:32480
    v_rcp_f32 v27, v27
    v_pk_mul_f32 v[24:25], v[24:25], v[196:197]
    v_pk_mul_f32 v[26:27], v[26:27], v[198:199]
    v_cvt_pk_bf16_f32 v96, v24, v25
    v_mfma_f32_16x16x32_bf16 a[168:171], a[232:235], v[76:79], a[168:171]
    ds_read_b64_tr_b16 a[228:229], v12 offset:27904
    v_mfma_f32_16x16x32_bf16 a[164:167], a[236:239], v[72:75], a[164:167]
    ds_read_b64_tr_b16 a[230:231], v12 offset:32512
    v_cvt_pk_bf16_f32 v97, v26, v27
    v_exp_f32 v24, v208
    v_exp_f32 v25, v209
    v_exp_f32 v26, v210
    v_mfma_f32_16x16x32_bf16 a[172:175], a[236:239], v[76:79], a[172:175]
    ds_read_b64_tr_b16 a[232:233], v12 offset:27936
    s_waitcnt lgkmcnt(9)
    v_mfma_f32_16x16x32_bf16 a[176:179], a[240:243], v[72:75], a[176:179]
    ds_read_b64_tr_b16 a[234:235], v12 offset:32544
    v_exp_f32 v27, v211
    v_pk_add_f32 v[24:25], v[24:25], 1.0 op_sel_hi:[1,0]
    v_pk_add_f32 v[26:27], v[26:27], 1.0 op_sel_hi:[1,0]
    v_rcp_f32 v24, v24
    v_mfma_f32_16x16x32_bf16 a[184:187], a[240:243], v[76:79], a[184:187]
    ds_read_b64_tr_b16 a[236:237], v12 offset:27968
    v_mfma_f32_16x16x32_bf16 a[180:183], a[244:247], v[72:75], a[180:183]
    ds_read_b64_tr_b16 a[238:239], v12 offset:32576
    v_rcp_f32 v25, v25
    v_rcp_f32 v26, v26
    v_rcp_f32 v27, v27
    v_pk_mul_f32 v[24:25], v[24:25], v[212:213]
    v_mfma_f32_16x16x32_bf16 a[188:191], a[244:247], v[76:79], a[188:191]
    s_waitcnt vmcnt(25)
    s_barrier
    ds_read_b64_tr_b16 a[240:241], v13 offset:0
    s_waitcnt lgkmcnt(9)
    v_mfma_f32_16x16x32_bf16 a[192:195], a[248:251], v[72:75], a[192:195]
    ds_read_b64_tr_b16 a[242:243], v13 offset:4608
    s_sub_u32 s52, s53, s52
    s_add_u32 m0, s52, 0
    s_mov_b32 s32, 294912
    buffer_load_dwordx4 v7, s[12:15], s32 offen offset:0 lds
    v_mfma_f32_16x16x32_bf16 a[200:203], a[248:251], v[76:79], a[200:203]
    ds_read_b64_tr_b16 a[244:245], v13 offset:32
    v_mfma_f32_16x16x32_bf16 a[196:199], a[252:255], v[72:75], a[196:199]
    ds_read_b64_tr_b16 a[246:247], v13 offset:4640
    buffer_load_dwordx4 v8, s[12:15], s32 offen offset:1024 lds
    v_pk_mul_f32 v[26:27], v[26:27], v[214:215]
    v_cvt_pk_bf16_f32 v98, v24, v25
    v_cvt_pk_bf16_f32 v99, v26, v27
    v_mfma_f32_16x16x32_bf16 a[204:207], a[252:255], v[76:79], a[204:207]
    ds_read_b64_tr_b16 a[248:249], v13 offset:64
    s_waitcnt lgkmcnt(9)
    v_mfma_f32_16x16x32_bf16 a[208:211], a[224:227], v[72:75], a[208:211]
    ds_read_b64_tr_b16 a[250:251], v13 offset:4672
    buffer_load_dwordx4 v9, s[12:15], s32 offen offset:2048 lds
    v_exp_f32 v24, v200
    v_exp_f32 v25, v201
    v_exp_f32 v26, v202
    v_mfma_f32_16x16x32_bf16 a[216:219], a[224:227], v[76:79], a[216:219]
    ds_read_b64_tr_b16 a[252:253], v13 offset:96
    v_mfma_f32_16x16x32_bf16 a[212:215], a[228:231], v[72:75], a[212:215]
    ds_read_b64_tr_b16 a[254:255], v13 offset:4704
    buffer_load_dwordx4 v10, s[12:15], s32 offen offset:3072 lds
    v_exp_f32 v27, v203
    v_pk_add_f32 v[24:25], v[24:25], 1.0 op_sel_hi:[1,0]
    v_pk_add_f32 v[26:27], v[26:27], 1.0 op_sel_hi:[1,0]
    v_mfma_f32_16x16x32_bf16 a[220:223], a[228:231], v[76:79], a[220:223]
    ds_read_b64_tr_b16 a[224:225], v13 offset:128
    s_waitcnt lgkmcnt(9)
    v_mfma_f32_16x16x32_bf16 v[32:35], a[232:235], v[72:75], v[32:35]
    ds_read_b64_tr_b16 a[226:227], v13 offset:4736
    s_add_u32 m0, m0, 0x400
    s_mov_b64 exec, s[34:35]
    buffer_load_dwordx4 v11, s[12:15], s32 offen offset:3072 lds
    s_mov_b64 exec, -1
    v_rcp_f32 v24, v24
    v_rcp_f32 v25, v25
    v_mfma_f32_16x16x32_bf16 v[40:43], a[232:235], v[76:79], v[40:43]
    ds_read_b64_tr_b16 a[228:229], v13 offset:160
    v_mfma_f32_16x16x32_bf16 v[36:39], a[236:239], v[72:75], v[36:39]
    ds_read_b64_tr_b16 a[230:231], v13 offset:4768
    v_rcp_f32 v26, v26
    v_rcp_f32 v27, v27
    v_pk_mul_f32 v[24:25], v[24:25], v[204:205]
    v_pk_mul_f32 v[26:27], v[26:27], v[206:207]
    v_mfma_f32_16x16x32_bf16 v[44:47], a[236:239], v[76:79], v[44:47]
    ds_read_b64_tr_b16 a[232:233], v13 offset:192
    s_waitcnt lgkmcnt(9)
    v_mfma_f32_16x16x32_bf16 a[96:99], a[240:243], v[80:83], a[96:99]
    ds_read_b64_tr_b16 a[234:235], v13 offset:4800
    v_cvt_pk_bf16_f32 v100, v24, v25
    v_cvt_pk_bf16_f32 v101, v26, v27
    v_exp_f32 v24, v216
    v_exp_f32 v25, v217
    v_mfma_f32_16x16x32_bf16 a[104:107], a[240:243], v[84:87], a[104:107]
    ds_read_b64_tr_b16 a[236:237], v13 offset:224
    v_mfma_f32_16x16x32_bf16 a[100:103], a[244:247], v[80:83], a[100:103]
    ds_read_b64_tr_b16 a[238:239], v13 offset:4832
    v_exp_f32 v26, v218
    v_exp_f32 v27, v219
    v_pk_add_f32 v[24:25], v[24:25], 1.0 op_sel_hi:[1,0]
    v_pk_add_f32 v[26:27], v[26:27], 1.0 op_sel_hi:[1,0]
    v_mfma_f32_16x16x32_bf16 a[108:111], a[244:247], v[84:87], a[108:111]
    ds_read_b64_tr_b16 a[240:241], v13 offset:256
    s_waitcnt lgkmcnt(9)
    v_mfma_f32_16x16x32_bf16 a[112:115], a[248:251], v[80:83], a[112:115]
    ds_read_b64_tr_b16 a[242:243], v13 offset:4864
    v_rcp_f32 v24, v24
    v_rcp_f32 v25, v25
    v_rcp_f32 v26, v26
    v_rcp_f32 v27, v27
    v_mfma_f32_16x16x32_bf16 a[120:123], a[248:251], v[84:87], a[120:123]
    ds_read_b64_tr_b16 a[244:245], v13 offset:9216
    v_mfma_f32_16x16x32_bf16 a[116:119], a[252:255], v[80:83], a[116:119]
    ds_read_b64_tr_b16 a[246:247], v13 offset:13824
    v_pk_mul_f32 v[24:25], v[24:25], v[220:221]
    v_pk_mul_f32 v[26:27], v[26:27], v[222:223]
    v_cvt_pk_bf16_f32 v102, v24, v25
    v_cvt_pk_bf16_f32 v103, v26, v27
    v_mfma_f32_16x16x32_bf16 a[124:127], a[252:255], v[84:87], a[124:127]
    ds_read_b64_tr_b16 a[248:249], v13 offset:9248
    s_waitcnt lgkmcnt(9)
    v_mfma_f32_16x16x32_bf16 a[128:131], a[224:227], v[80:83], a[128:131]
    ds_read_b64_tr_b16 a[250:251], v13 offset:13856
    v_exp_f32 v24, v224
    v_exp_f32 v25, v225
    v_exp_f32 v26, v226
    v_exp_f32 v27, v227
    v_mfma_f32_16x16x32_bf16 a[136:139], a[224:227], v[84:87], a[136:139]
    ds_read_b64_tr_b16 a[252:253], v13 offset:9280
    v_mfma_f32_16x16x32_bf16 a[132:135], a[228:231], v[80:83], a[132:135]
    ds_read_b64_tr_b16 a[254:255], v13 offset:13888
    v_pk_add_f32 v[24:25], v[24:25], 1.0 op_sel_hi:[1,0]
    v_pk_add_f32 v[26:27], v[26:27], 1.0 op_sel_hi:[1,0]
    v_rcp_f32 v24, v24
    v_rcp_f32 v25, v25
    v_mfma_f32_16x16x32_bf16 a[140:143], a[228:231], v[84:87], a[140:143]
    ds_read_b64_tr_b16 a[224:225], v13 offset:9312
    s_waitcnt lgkmcnt(9)
    v_mfma_f32_16x16x32_bf16 a[144:147], a[232:235], v[80:83], a[144:147]
    ds_read_b64_tr_b16 a[226:227], v13 offset:13920
    v_rcp_f32 v26, v26
    v_rcp_f32 v27, v27
    v_pk_mul_f32 v[24:25], v[24:25], v[228:229]
    v_pk_mul_f32 v[26:27], v[26:27], v[230:231]
    v_mfma_f32_16x16x32_bf16 a[152:155], a[232:235], v[84:87], a[152:155]
    ds_read_b64_tr_b16 a[228:229], v13 offset:9344
    v_mfma_f32_16x16x32_bf16 a[148:151], a[236:239], v[80:83], a[148:151]
    ds_read_b64_tr_b16 a[230:231], v13 offset:13952
    v_cvt_pk_bf16_f32 v104, v24, v25
    v_cvt_pk_bf16_f32 v105, v26, v27
    v_exp_f32 v24, v240
    v_exp_f32 v25, v241
    v_mfma_f32_16x16x32_bf16 a[156:159], a[236:239], v[84:87], a[156:159]
    ds_read_b64_tr_b16 a[232:233], v13 offset:9376
    s_waitcnt lgkmcnt(9)
    v_mfma_f32_16x16x32_bf16 a[160:163], a[240:243], v[80:83], a[160:163]
    ds_read_b64_tr_b16 a[234:235], v13 offset:13984
    v_exp_f32 v26, v242
    v_exp_f32 v27, v243
    v_pk_add_f32 v[24:25], v[24:25], 1.0 op_sel_hi:[1,0]
    v_pk_add_f32 v[26:27], v[26:27], 1.0 op_sel_hi:[1,0]
    v_mfma_f32_16x16x32_bf16 a[168:171], a[240:243], v[84:87], a[168:171]
    ds_read_b64_tr_b16 a[236:237], v13 offset:9408
    v_mfma_f32_16x16x32_bf16 a[164:167], a[244:247], v[80:83], a[164:167]
    ds_read_b64_tr_b16 a[238:239], v13 offset:14016
    v_rcp_f32 v24, v24
    v_rcp_f32 v25, v25
    v_rcp_f32 v26, v26
    v_rcp_f32 v27, v27
    v_mfma_f32_16x16x32_bf16 a[172:175], a[244:247], v[84:87], a[172:175]
    ds_read_b64_tr_b16 a[240:241], v13 offset:9440
    s_waitcnt lgkmcnt(9)
    v_mfma_f32_16x16x32_bf16 a[176:179], a[248:251], v[80:83], a[176:179]
    ds_read_b64_tr_b16 a[242:243], v13 offset:14048
    v_pk_mul_f32 v[24:25], v[24:25], v[244:245]
    v_pk_mul_f32 v[26:27], v[26:27], v[246:247]
    v_cvt_pk_bf16_f32 v106, v24, v25
    v_cvt_pk_bf16_f32 v107, v26, v27
    v_mfma_f32_16x16x32_bf16 a[184:187], a[248:251], v[84:87], a[184:187]
    ds_read_b64_tr_b16 a[244:245], v13 offset:9472
    v_mfma_f32_16x16x32_bf16 a[180:183], a[252:255], v[80:83], a[180:183]
    ds_read_b64_tr_b16 a[246:247], v13 offset:14080
    v_exp_f32 v24, v232
    v_exp_f32 v25, v233
    v_exp_f32 v26, v234
    v_exp_f32 v27, v235
    v_mfma_f32_16x16x32_bf16 a[188:191], a[252:255], v[84:87], a[188:191]
    s_waitcnt vmcnt(25)
    s_barrier
    ds_read_b64_tr_b16 a[248:249], v13 offset:18496
    s_waitcnt lgkmcnt(9)
    v_mfma_f32_16x16x32_bf16 a[192:195], a[224:227], v[80:83], a[192:195]
    ds_read_b64_tr_b16 a[250:251], v13 offset:23104
    s_add_u32 m0, s52, 18496
    s_cmp_eq_u32 s37, 0
    s_mov_b32 s32, 37152
    s_cselect_b32 s32, 576, s32
    buffer_load_dwordx4 v7, s[12:15], s32 offen offset:0 lds
    v_pk_add_f32 v[24:25], v[24:25], 1.0 op_sel_hi:[1,0]
    v_mfma_f32_16x16x32_bf16 a[200:203], a[224:227], v[84:87], a[200:203]
    ds_read_b64_tr_b16 a[252:253], v13 offset:18528
    v_mfma_f32_16x16x32_bf16 a[196:199], a[228:231], v[80:83], a[196:199]
    ds_read_b64_tr_b16 a[254:255], v13 offset:23136
    buffer_load_dwordx4 v8, s[12:15], s32 offen offset:1024 lds
    v_pk_add_f32 v[26:27], v[26:27], 1.0 op_sel_hi:[1,0]
    v_rcp_f32 v24, v24
    v_rcp_f32 v25, v25
    v_mfma_f32_16x16x32_bf16 a[204:207], a[228:231], v[84:87], a[204:207]
    ds_read_b64_tr_b16 a[224:225], v13 offset:18560
    s_waitcnt lgkmcnt(9)
    v_mfma_f32_16x16x32_bf16 a[208:211], a[232:235], v[80:83], a[208:211]
    ds_read_b64_tr_b16 a[226:227], v13 offset:23168
    buffer_load_dwordx4 v9, s[12:15], s32 offen offset:2048 lds
    v_rcp_f32 v26, v26
    v_rcp_f32 v27, v27
    v_pk_mul_f32 v[24:25], v[24:25], v[236:237]
    v_mfma_f32_16x16x32_bf16 a[216:219], a[232:235], v[84:87], a[216:219]
    ds_read_b64_tr_b16 a[228:229], v13 offset:18592
    v_mfma_f32_16x16x32_bf16 a[212:215], a[236:239], v[80:83], a[212:215]
    ds_read_b64_tr_b16 a[230:231], v13 offset:23200
    buffer_load_dwordx4 v10, s[12:15], s32 offen offset:3072 lds
    v_pk_mul_f32 v[26:27], v[26:27], v[238:239]
    v_cvt_pk_bf16_f32 v108, v24, v25
    v_cvt_pk_bf16_f32 v109, v26, v27
    v_mfma_f32_16x16x32_bf16 a[220:223], a[236:239], v[84:87], a[220:223]
    ds_read_b64_tr_b16 a[232:233], v13 offset:18624
    s_waitcnt lgkmcnt(9)
    v_mfma_f32_16x16x32_bf16 v[32:35], a[240:243], v[80:83], v[32:35]
    ds_read_b64_tr_b16 a[234:235], v13 offset:23232
    s_add_u32 m0, m0, 0x400
    s_mov_b64 exec, s[34:35]
    buffer_load_dwordx4 v11, s[12:15], s32 offen offset:3072 lds
    s_mov_b64 exec, -1
    v_exp_f32 v24, v248
    v_exp_f32 v25, v249
    v_mfma_f32_16x16x32_bf16 v[40:43], a[240:243], v[84:87], v[40:43]
    ds_read_b64_tr_b16 a[236:237], v13 offset:18656
    v_mfma_f32_16x16x32_bf16 v[36:39], a[244:247], v[80:83], v[36:39]
    ds_read_b64_tr_b16 a[238:239], v13 offset:23264
    v_exp_f32 v26, v250
    v_exp_f32 v27, v251
    v_pk_add_f32 v[24:25], v[24:25], 1.0 op_sel_hi:[1,0]
    v_pk_add_f32 v[26:27], v[26:27], 1.0 op_sel_hi:[1,0]
    v_mfma_f32_16x16x32_bf16 v[44:47], a[244:247], v[84:87], v[44:47]
    ds_read_b64_tr_b16 a[240:241], v13 offset:18688
    s_waitcnt lgkmcnt(9)
    v_mfma_f32_16x16x32_bf16 a[96:99], a[248:251], v[88:91], a[96:99]
    ds_read_b64_tr_b16 a[242:243], v13 offset:23296
    v_rcp_f32 v24, v24
    v_rcp_f32 v25, v25
    v_rcp_f32 v26, v26
    v_rcp_f32 v27, v27
    v_mfma_f32_16x16x32_bf16 a[104:107], a[248:251], v[92:95], a[104:107]
    ds_read_b64_tr_b16 a[244:245], v13 offset:18720
    v_mfma_f32_16x16x32_bf16 a[100:103], a[252:255], v[88:91], a[100:103]
    ds_read_b64_tr_b16 a[246:247], v13 offset:23328
    v_pk_mul_f32 v[24:25], v[24:25], v[252:253]
    v_pk_mul_f32 v[26:27], v[26:27], v[254:255]
    v_cvt_pk_bf16_f32 v110, v24, v25
    v_cvt_pk_bf16_f32 v111, v26, v27
    v_mfma_f32_16x16x32_bf16 a[108:111], a[252:255], v[92:95], a[108:111]
    ds_read_b64_tr_b16 a[248:249], v13 offset:18752
    s_waitcnt lgkmcnt(9)
    v_mfma_f32_16x16x32_bf16 a[112:115], a[224:227], v[88:91], a[112:115]
    ds_read_b64_tr_b16 a[250:251], v13 offset:23360
    v_accvgpr_read_b32 v24, a0
    v_accvgpr_read_b32 v25, a1
    v_accvgpr_read_b32 v26, a2
    v_accvgpr_read_b32 v27, a3
    v_mfma_f32_16x16x32_bf16 a[120:123], a[224:227], v[92:95], a[120:123]
    ds_read_b64_tr_b16 a[252:253], v13 offset:27712
    v_mfma_f32_16x16x32_bf16 a[116:119], a[228:231], v[88:91], a[116:119]
    ds_read_b64_tr_b16 a[254:255], v13 offset:32320
    v_accvgpr_read_b32 v28, a4
    v_accvgpr_read_b32 v29, a5
    v_accvgpr_read_b32 v30, a6
    v_accvgpr_read_b32 v31, a7
    v_mfma_f32_16x16x32_bf16 a[124:127], a[228:231], v[92:95], a[124:127]
    ds_read_b64_tr_b16 a[224:225], v13 offset:27744
    s_waitcnt lgkmcnt(9)
    v_mfma_f32_16x16x32_bf16 a[128:131], a[232:235], v[88:91], a[128:131]
    ds_read_b64_tr_b16 a[226:227], v13 offset:32352
    v_exp_f32 v24, v24
    v_exp_f32 v25, v25
    v_exp_f32 v26, v26
    v_exp_f32 v27, v27
    v_mfma_f32_16x16x32_bf16 a[136:139], a[232:235], v[92:95], a[136:139]
    ds_read_b64_tr_b16 a[228:229], v13 offset:27776
    v_mfma_f32_16x16x32_bf16 a[132:135], a[236:239], v[88:91], a[132:135]
    ds_read_b64_tr_b16 a[230:231], v13 offset:32384
    v_pk_add_f32 v[24:25], v[24:25], 1.0 op_sel_hi:[1,0]
    v_pk_add_f32 v[26:27], v[26:27], 1.0 op_sel_hi:[1,0]
    v_rcp_f32 v24, v24
    v_rcp_f32 v25, v25
    v_mfma_f32_16x16x32_bf16 a[140:143], a[236:239], v[92:95], a[140:143]
    ds_read_b64_tr_b16 a[232:233], v13 offset:27808
    s_waitcnt lgkmcnt(9)
    v_mfma_f32_16x16x32_bf16 a[144:147], a[240:243], v[88:91], a[144:147]
    ds_read_b64_tr_b16 a[234:235], v13 offset:32416
    v_rcp_f32 v26, v26
    v_rcp_f32 v27, v27
    v_pk_mul_f32 v[24:25], v[24:25], v[28:29]
    v_pk_mul_f32 v[26:27], v[26:27], v[30:31]
    v_mfma_f32_16x16x32_bf16 a[152:155], a[240:243], v[92:95], a[152:155]
    ds_read_b64_tr_b16 a[236:237], v13 offset:27840
    v_mfma_f32_16x16x32_bf16 a[148:151], a[244:247], v[88:91], a[148:151]
    ds_read_b64_tr_b16 a[238:239], v13 offset:32448
    v_cvt_pk_bf16_f32 v112, v24, v25
    v_cvt_pk_bf16_f32 v113, v26, v27
    v_accvgpr_read_b32 v24, a16
    v_accvgpr_read_b32 v25, a17
    v_mfma_f32_16x16x32_bf16 a[156:159], a[244:247], v[92:95], a[156:159]
    ds_read_b64_tr_b16 a[240:241], v13 offset:27872
    s_waitcnt lgkmcnt(9)
    v_mfma_f32_16x16x32_bf16 a[160:163], a[248:251], v[88:91], a[160:163]
    ds_read_b64_tr_b16 a[242:243], v13 offset:32480
    v_accvgpr_read_b32 v26, a18
    v_accvgpr_read_b32 v27, a19
    v_accvgpr_read_b32 v28, a20
    v_accvgpr_read_b32 v29, a21
    v_mfma_f32_16x16x32_bf16 a[168:171], a[248:251], v[92:95], a[168:171]
    ds_read_b64_tr_b16 a[244:245], v13 offset:27904
    v_mfma_f32_16x16x32_bf16 a[164:167], a[252:255], v[88:91], a[164:167]
    ds_read_b64_tr_b16 a[246:247], v13 offset:32512
    v_accvgpr_read_b32 v30, a22
    v_accvgpr_read_b32 v31, a23
    v_exp_f32 v24, v24
    v_exp_f32 v25, v25
    v_mfma_f32_16x16x32_bf16 a[172:175], a[252:255], v[92:95], a[172:175]
    ds_read_b64_tr_b16 a[248:249], v13 offset:27936
    s_waitcnt lgkmcnt(9)
    v_mfma_f32_16x16x32_bf16 a[176:179], a[224:227], v[88:91], a[176:179]
    ds_read_b64_tr_b16 a[250:251], v13 offset:32544
    v_exp_f32 v26, v26
    v_exp_f32 v27, v27
    v_pk_add_f32 v[24:25], v[24:25], 1.0 op_sel_hi:[1,0]
    v_pk_add_f32 v[26:27], v[26:27], 1.0 op_sel_hi:[1,0]
    v_mfma_f32_16x16x32_bf16 a[184:187], a[224:227], v[92:95], a[184:187]
    ds_read_b64_tr_b16 a[252:253], v13 offset:27968
    v_mfma_f32_16x16x32_bf16 a[180:183], a[228:231], v[88:91], a[180:183]
    ds_read_b64_tr_b16 a[254:255], v13 offset:32576
    v_rcp_f32 v24, v24
    v_rcp_f32 v25, v25
    v_rcp_f32 v26, v26
    v_rcp_f32 v27, v27
    v_mfma_f32_16x16x32_bf16 a[188:191], a[228:231], v[92:95], a[188:191]
    s_waitcnt vmcnt(25)
    s_barrier
    v_add_u32 v12, s54, v12
    v_add_u32 v13, s54, v13
    s_sub_u32 s54, 0, s54
    ds_read_b64_tr_b16 a[224:225], v12 offset:0
    s_waitcnt lgkmcnt(9)
    v_mfma_f32_16x16x32_bf16 a[192:195], a[232:235], v[88:91], a[192:195]
    ds_read_b64_tr_b16 a[226:227], v12 offset:4608
    s_add_u32 m0, s52, 36992
    s_cmp_eq_u32 s37, 0
    s_mov_b32 s32, 110880
    s_cselect_b32 s32, 74304, s32
    buffer_load_dwordx4 v7, s[12:15], s32 offen offset:0 lds
    v_pk_mul_f32 v[24:25], v[24:25], v[28:29]
    v_mfma_f32_16x16x32_bf16 a[200:203], a[232:235], v[92:95], a[200:203]
    ds_read_b64_tr_b16 a[228:229], v12 offset:32
    v_mfma_f32_16x16x32_bf16 a[196:199], a[236:239], v[88:91], a[196:199]
    ds_read_b64_tr_b16 a[230:231], v12 offset:4640
    buffer_load_dwordx4 v8, s[12:15], s32 offen offset:1024 lds
    v_pk_mul_f32 v[26:27], v[26:27], v[30:31]
    v_cvt_pk_bf16_f32 v114, v24, v25
    v_cvt_pk_bf16_f32 v115, v26, v27
    v_mfma_f32_16x16x32_bf16 a[204:207], a[236:239], v[92:95], a[204:207]
    ds_read_b64_tr_b16 a[232:233], v12 offset:64
    s_waitcnt lgkmcnt(9)
    v_mfma_f32_16x16x32_bf16 a[208:211], a[240:243], v[88:91], a[208:211]
    ds_read_b64_tr_b16 a[234:235], v12 offset:4672
    buffer_load_dwordx4 v9, s[12:15], s32 offen offset:2048 lds
    v_accvgpr_read_b32 v24, a8
    v_accvgpr_read_b32 v25, a9
    v_accvgpr_read_b32 v26, a10
    v_mfma_f32_16x16x32_bf16 a[216:219], a[240:243], v[92:95], a[216:219]
    ds_read_b64_tr_b16 a[236:237], v12 offset:96
    v_mfma_f32_16x16x32_bf16 a[212:215], a[244:247], v[88:91], a[212:215]
    ds_read_b64_tr_b16 a[238:239], v12 offset:4704
    buffer_load_dwordx4 v10, s[12:15], s32 offen offset:3072 lds
    v_accvgpr_read_b32 v27, a11
    v_accvgpr_read_b32 v28, a12
    v_accvgpr_read_b32 v29, a13
    v_mfma_f32_16x16x32_bf16 a[220:223], a[244:247], v[92:95], a[220:223]
    ds_read_b64_tr_b16 a[240:241], v12 offset:128
    s_waitcnt lgkmcnt(9)
    v_mfma_f32_16x16x32_bf16 v[32:35], a[248:251], v[88:91], v[32:35]
    ds_read_b64_tr_b16 a[242:243], v12 offset:4736
    s_add_u32 m0, m0, 0x400
    s_mov_b64 exec, s[34:35]
    buffer_load_dwordx4 v11, s[12:15], s32 offen offset:3072 lds
    s_mov_b64 exec, -1
    v_accvgpr_read_b32 v30, a14
    v_accvgpr_read_b32 v31, a15
    v_mfma_f32_16x16x32_bf16 v[40:43], a[248:251], v[92:95], v[40:43]
    ds_read_b64_tr_b16 a[244:245], v12 offset:160
    v_mfma_f32_16x16x32_bf16 v[36:39], a[252:255], v[88:91], v[36:39]
    ds_read_b64_tr_b16 a[246:247], v12 offset:4768
    v_exp_f32 v24, v24
    v_exp_f32 v25, v25
    v_exp_f32 v26, v26
    v_exp_f32 v27, v27
    v_mfma_f32_16x16x32_bf16 v[44:47], a[252:255], v[92:95], v[44:47]
    ds_read_b64_tr_b16 a[248:249], v12 offset:192
    s_waitcnt lgkmcnt(9)
    v_mfma_f32_16x16x32_bf16 a[96:99], a[224:227], v[96:99], a[96:99]
    ds_read_b64_tr_b16 a[250:251], v12 offset:4800
    v_pk_add_f32 v[24:25], v[24:25], 1.0 op_sel_hi:[1,0]
    v_pk_add_f32 v[26:27], v[26:27], 1.0 op_sel_hi:[1,0]
    v_rcp_f32 v24, v24
    v_rcp_f32 v25, v25
    v_mfma_f32_16x16x32_bf16 a[104:107], a[224:227], v[100:103], a[104:107]
    ds_read_b64_tr_b16 a[252:253], v12 offset:224
    v_mfma_f32_16x16x32_bf16 a[100:103], a[228:231], v[96:99], a[100:103]
    ds_read_b64_tr_b16 a[254:255], v12 offset:4832
    v_rcp_f32 v26, v26
    v_rcp_f32 v27, v27
    v_pk_mul_f32 v[24:25], v[24:25], v[28:29]
    v_pk_mul_f32 v[26:27], v[26:27], v[30:31]
    v_mfma_f32_16x16x32_bf16 a[108:111], a[228:231], v[100:103], a[108:111]
    ds_read_b64_tr_b16 a[224:225], v12 offset:256
    s_waitcnt lgkmcnt(9)
    v_mfma_f32_16x16x32_bf16 a[112:115], a[232:235], v[96:99], a[112:115]
    ds_read_b64_tr_b16 a[226:227], v12 offset:4864
    v_cvt_pk_bf16_f32 v116, v24, v25
    v_cvt_pk_bf16_f32 v117, v26, v27
    v_accvgpr_read_b32 v24, a24
    v_accvgpr_read_b32 v25, a25
    v_mfma_f32_16x16x32_bf16 a[120:123], a[232:235], v[100:103], a[120:123]
    ds_read_b64_tr_b16 a[228:229], v12 offset:9216
    v_mfma_f32_16x16x32_bf16 a[116:119], a[236:239], v[96:99], a[116:119]
    ds_read_b64_tr_b16 a[230:231], v12 offset:13824
    v_accvgpr_read_b32 v26, a26
    v_accvgpr_read_b32 v27, a27
    v_accvgpr_read_b32 v28, a28
    v_accvgpr_read_b32 v29, a29
    v_mfma_f32_16x16x32_bf16 a[124:127], a[236:239], v[100:103], a[124:127]
    ds_read_b64_tr_b16 a[232:233], v12 offset:9248
    s_waitcnt lgkmcnt(9)
    v_mfma_f32_16x16x32_bf16 a[128:131], a[240:243], v[96:99], a[128:131]
    ds_read_b64_tr_b16 a[234:235], v12 offset:13856
    v_accvgpr_read_b32 v30, a30
    v_accvgpr_read_b32 v31, a31
    v_exp_f32 v24, v24
    v_exp_f32 v25, v25
    v_mfma_f32_16x16x32_bf16 a[136:139], a[240:243], v[100:103], a[136:139]
    ds_read_b64_tr_b16 a[236:237], v12 offset:9280
    v_mfma_f32_16x16x32_bf16 a[132:135], a[244:247], v[96:99], a[132:135]
    ds_read_b64_tr_b16 a[238:239], v12 offset:13888
    v_exp_f32 v26, v26
    v_exp_f32 v27, v27
    v_pk_add_f32 v[24:25], v[24:25], 1.0 op_sel_hi:[1,0]
    v_pk_add_f32 v[26:27], v[26:27], 1.0 op_sel_hi:[1,0]
    v_mfma_f32_16x16x32_bf16 a[140:143], a[244:247], v[100:103], a[140:143]
    ds_read_b64_tr_b16 a[240:241], v12 offset:9312
    s_waitcnt lgkmcnt(9)
    v_mfma_f32_16x16x32_bf16 a[144:147], a[248:251], v[96:99], a[144:147]
    ds_read_b64_tr_b16 a[242:243], v12 offset:13920
    v_rcp_f32 v24, v24
    v_rcp_f32 v25, v25
    v_rcp_f32 v26, v26
    v_rcp_f32 v27, v27
    v_mfma_f32_16x16x32_bf16 a[152:155], a[248:251], v[100:103], a[152:155]
    ds_read_b64_tr_b16 a[244:245], v12 offset:9344
    v_mfma_f32_16x16x32_bf16 a[148:151], a[252:255], v[96:99], a[148:151]
    ds_read_b64_tr_b16 a[246:247], v12 offset:13952
    v_pk_mul_f32 v[24:25], v[24:25], v[28:29]
    v_pk_mul_f32 v[26:27], v[26:27], v[30:31]
    v_cvt_pk_bf16_f32 v118, v24, v25
    v_cvt_pk_bf16_f32 v119, v26, v27
    v_mfma_f32_16x16x32_bf16 a[156:159], a[252:255], v[100:103], a[156:159]
    ds_read_b64_tr_b16 a[248:249], v12 offset:9376
    s_waitcnt lgkmcnt(9)
    v_mfma_f32_16x16x32_bf16 a[160:163], a[224:227], v[96:99], a[160:163]
    ds_read_b64_tr_b16 a[250:251], v12 offset:13984
    v_accvgpr_read_b32 v24, a32
    v_accvgpr_read_b32 v25, a33
    v_accvgpr_read_b32 v26, a34
    v_accvgpr_read_b32 v27, a35
    v_mfma_f32_16x16x32_bf16 a[168:171], a[224:227], v[100:103], a[168:171]
    ds_read_b64_tr_b16 a[252:253], v12 offset:9408
    v_mfma_f32_16x16x32_bf16 a[164:167], a[228:231], v[96:99], a[164:167]
    ds_read_b64_tr_b16 a[254:255], v12 offset:14016
    v_accvgpr_read_b32 v28, a36
    v_accvgpr_read_b32 v29, a37
    v_accvgpr_read_b32 v30, a38
    v_accvgpr_read_b32 v31, a39
    v_mfma_f32_16x16x32_bf16 a[172:175], a[228:231], v[100:103], a[172:175]
    ds_read_b64_tr_b16 a[224:225], v12 offset:9440
    s_waitcnt lgkmcnt(9)
    v_mfma_f32_16x16x32_bf16 a[176:179], a[232:235], v[96:99], a[176:179]
    ds_read_b64_tr_b16 a[226:227], v12 offset:14048
    v_exp_f32 v24, v24
    v_exp_f32 v25, v25
    v_exp_f32 v26, v26
    v_exp_f32 v27, v27
    v_mfma_f32_16x16x32_bf16 a[184:187], a[232:235], v[100:103], a[184:187]
    ds_read_b64_tr_b16 a[228:229], v12 offset:9472
    v_mfma_f32_16x16x32_bf16 a[180:183], a[236:239], v[96:99], a[180:183]
    ds_read_b64_tr_b16 a[230:231], v12 offset:14080
    v_pk_add_f32 v[24:25], v[24:25], 1.0 op_sel_hi:[1,0]
    v_pk_add_f32 v[26:27], v[26:27], 1.0 op_sel_hi:[1,0]
    v_rcp_f32 v24, v24
    v_rcp_f32 v25, v25
    v_mfma_f32_16x16x32_bf16 a[188:191], a[236:239], v[100:103], a[188:191]
    s_waitcnt vmcnt(25)
    s_barrier
    ds_read_b64_tr_b16 a[232:233], v12 offset:18496
    s_waitcnt lgkmcnt(9)
    v_mfma_f32_16x16x32_bf16 a[192:195], a[240:243], v[96:99], a[192:195]
    ds_read_b64_tr_b16 a[234:235], v12 offset:23104
    s_add_u32 m0, s52, 55488
    s_cmp_eq_u32 s37, 0
    s_mov_b32 s32, 184608
    s_cselect_b32 s32, 148032, s32
    buffer_load_dwordx4 v7, s[12:15], s32 offen offset:0 lds
    v_rcp_f32 v26, v26
    v_mfma_f32_16x16x32_bf16 a[200:203], a[240:243], v[100:103], a[200:203]
    ds_read_b64_tr_b16 a[236:237], v12 offset:18528
    v_mfma_f32_16x16x32_bf16 a[196:199], a[244:247], v[96:99], a[196:199]
    ds_read_b64_tr_b16 a[238:239], v12 offset:23136
    buffer_load_dwordx4 v8, s[12:15], s32 offen offset:1024 lds
    v_rcp_f32 v27, v27
    v_pk_mul_f32 v[24:25], v[24:25], v[28:29]
    v_pk_mul_f32 v[26:27], v[26:27], v[30:31]
    v_mfma_f32_16x16x32_bf16 a[204:207], a[244:247], v[100:103], a[204:207]
    ds_read_b64_tr_b16 a[240:241], v12 offset:18560
    s_waitcnt lgkmcnt(9)
    v_mfma_f32_16x16x32_bf16 a[208:211], a[248:251], v[96:99], a[208:211]
    ds_read_b64_tr_b16 a[242:243], v12 offset:23168
    buffer_load_dwordx4 v9, s[12:15], s32 offen offset:2048 lds
    v_cvt_pk_bf16_f32 v120, v24, v25
    v_cvt_pk_bf16_f32 v121, v26, v27
    v_accvgpr_read_b32 v24, a48
    v_mfma_f32_16x16x32_bf16 a[216:219], a[248:251], v[100:103], a[216:219]
    ds_read_b64_tr_b16 a[244:245], v12 offset:18592
    v_mfma_f32_16x16x32_bf16 a[212:215], a[252:255], v[96:99], a[212:215]
    ds_read_b64_tr_b16 a[246:247], v12 offset:23200
    buffer_load_dwordx4 v10, s[12:15], s32 offen offset:3072 lds
    v_accvgpr_read_b32 v25, a49
    v_accvgpr_read_b32 v26, a50
    v_accvgpr_read_b32 v27, a51
    v_mfma_f32_16x16x32_bf16 a[220:223], a[252:255], v[100:103], a[220:223]
    ds_read_b64_tr_b16 a[248:249], v12 offset:18624
    s_waitcnt lgkmcnt(9)
    v_mfma_f32_16x16x32_bf16 v[32:35], a[224:227], v[96:99], v[32:35]
    ds_read_b64_tr_b16 a[250:251], v12 offset:23232
    s_add_u32 m0, m0, 0x400
    s_mov_b64 exec, s[34:35]
    buffer_load_dwordx4 v11, s[12:15], s32 offen offset:3072 lds
    s_mov_b64 exec, -1
    v_accvgpr_read_b32 v28, a52
    v_accvgpr_read_b32 v29, a53
    v_mfma_f32_16x16x32_bf16 v[40:43], a[224:227], v[100:103], v[40:43]
    ds_read_b64_tr_b16 a[252:253], v12 offset:18656
    v_mfma_f32_16x16x32_bf16 v[36:39], a[228:231], v[96:99], v[36:39]
    ds_read_b64_tr_b16 a[254:255], v12 offset:23264
    v_accvgpr_read_b32 v30, a54
    v_accvgpr_read_b32 v31, a55
    v_exp_f32 v24, v24
    v_exp_f32 v25, v25
    v_mfma_f32_16x16x32_bf16 v[44:47], a[228:231], v[100:103], v[44:47]
    ds_read_b64_tr_b16 a[224:225], v12 offset:18688
    s_waitcnt lgkmcnt(9)
    v_mfma_f32_16x16x32_bf16 a[96:99], a[232:235], v[104:107], a[96:99]
    ds_read_b64_tr_b16 a[226:227], v12 offset:23296
    v_exp_f32 v26, v26
    v_exp_f32 v27, v27
    v_pk_add_f32 v[24:25], v[24:25], 1.0 op_sel_hi:[1,0]
    v_pk_add_f32 v[26:27], v[26:27], 1.0 op_sel_hi:[1,0]
    v_mfma_f32_16x16x32_bf16 a[104:107], a[232:235], v[108:111], a[104:107]
    ds_read_b64_tr_b16 a[228:229], v12 offset:18720
    v_mfma_f32_16x16x32_bf16 a[100:103], a[236:239], v[104:107], a[100:103]
    ds_read_b64_tr_b16 a[230:231], v12 offset:23328
    v_rcp_f32 v24, v24
    v_rcp_f32 v25, v25
    v_rcp_f32 v26, v26
    v_rcp_f32 v27, v27
    v_mfma_f32_16x16x32_bf16 a[108:111], a[236:239], v[108:111], a[108:111]
    ds_read_b64_tr_b16 a[232:233], v12 offset:18752
    s_waitcnt lgkmcnt(9)
    v_mfma_f32_16x16x32_bf16 a[112:115], a[240:243], v[104:107], a[112:115]
    ds_read_b64_tr_b16 a[234:235], v12 offset:23360
    v_pk_mul_f32 v[24:25], v[24:25], v[28:29]
    v_pk_mul_f32 v[26:27], v[26:27], v[30:31]
    v_cvt_pk_bf16_f32 v122, v24, v25
    v_cvt_pk_bf16_f32 v123, v26, v27
    v_mfma_f32_16x16x32_bf16 a[120:123], a[240:243], v[108:111], a[120:123]
    ds_read_b64_tr_b16 a[236:237], v12 offset:27712
    v_mfma_f32_16x16x32_bf16 a[116:119], a[244:247], v[104:107], a[116:119]
    ds_read_b64_tr_b16 a[238:239], v12 offset:32320
    v_accvgpr_read_b32 v24, a40
    v_accvgpr_read_b32 v25, a41
    v_accvgpr_read_b32 v26, a42
    v_accvgpr_read_b32 v27, a43
    v_mfma_f32_16x16x32_bf16 a[124:127], a[244:247], v[108:111], a[124:127]
    ds_read_b64_tr_b16 a[240:241], v12 offset:27744
    s_waitcnt lgkmcnt(9)
    v_mfma_f32_16x16x32_bf16 a[128:131], a[248:251], v[104:107], a[128:131]
    ds_read_b64_tr_b16 a[242:243], v12 offset:32352
    v_accvgpr_read_b32 v28, a44
    v_accvgpr_read_b32 v29, a45
    v_accvgpr_read_b32 v30, a46
    v_accvgpr_read_b32 v31, a47
    v_mfma_f32_16x16x32_bf16 a[136:139], a[248:251], v[108:111], a[136:139]
    ds_read_b64_tr_b16 a[244:245], v12 offset:27776
    v_mfma_f32_16x16x32_bf16 a[132:135], a[252:255], v[104:107], a[132:135]
    ds_read_b64_tr_b16 a[246:247], v12 offset:32384
    v_exp_f32 v24, v24
    v_exp_f32 v25, v25
    v_exp_f32 v26, v26
    v_exp_f32 v27, v27
    v_mfma_f32_16x16x32_bf16 a[140:143], a[252:255], v[108:111], a[140:143]
    ds_read_b64_tr_b16 a[248:249], v12 offset:27808
    s_waitcnt lgkmcnt(9)
    v_mfma_f32_16x16x32_bf16 a[144:147], a[224:227], v[104:107], a[144:147]
    ds_read_b64_tr_b16 a[250:251], v12 offset:32416
    v_pk_add_f32 v[24:25], v[24:25], 1.0 op_sel_hi:[1,0]
    v_pk_add_f32 v[26:27], v[26:27], 1.0 op_sel_hi:[1,0]
    v_rcp_f32 v24, v24
    v_rcp_f32 v25, v25
    v_mfma_f32_16x16x32_bf16 a[152:155], a[224:227], v[108:111], a[152:155]
    ds_read_b64_tr_b16 a[252:253], v12 offset:27840
    v_mfma_f32_16x16x32_bf16 a[148:151], a[228:231], v[104:107], a[148:151]
    ds_read_b64_tr_b16 a[254:255], v12 offset:32448
    v_rcp_f32 v26, v26
    v_rcp_f32 v27, v27
    v_pk_mul_f32 v[24:25], v[24:25], v[28:29]
    v_pk_mul_f32 v[26:27], v[26:27], v[30:31]
    v_mfma_f32_16x16x32_bf16 a[156:159], a[228:231], v[108:111], a[156:159]
    ds_read_b64_tr_b16 a[224:225], v12 offset:27872
    s_waitcnt lgkmcnt(9)
    v_mfma_f32_16x16x32_bf16 a[160:163], a[232:235], v[104:107], a[160:163]
    ds_read_b64_tr_b16 a[226:227], v12 offset:32480
    v_cvt_pk_bf16_f32 v124, v24, v25
    v_cvt_pk_bf16_f32 v125, v26, v27
    v_accvgpr_read_b32 v24, a56
    v_accvgpr_read_b32 v25, a57
    v_mfma_f32_16x16x32_bf16 a[168:171], a[232:235], v[108:111], a[168:171]
    ds_read_b64_tr_b16 a[228:229], v12 offset:27904
    v_mfma_f32_16x16x32_bf16 a[164:167], a[236:239], v[104:107], a[164:167]
    ds_read_b64_tr_b16 a[230:231], v12 offset:32512
    v_accvgpr_read_b32 v26, a58
    v_accvgpr_read_b32 v27, a59
    v_accvgpr_read_b32 v28, a60
    v_accvgpr_read_b32 v29, a61
    v_mfma_f32_16x16x32_bf16 a[172:175], a[236:239], v[108:111], a[172:175]
    ds_read_b64_tr_b16 a[232:233], v12 offset:27936
    s_waitcnt lgkmcnt(9)
    v_mfma_f32_16x16x32_bf16 a[176:179], a[240:243], v[104:107], a[176:179]
    ds_read_b64_tr_b16 a[234:235], v12 offset:32544
    v_accvgpr_read_b32 v30, a62
    v_accvgpr_read_b32 v31, a63
    v_exp_f32 v24, v24
    v_exp_f32 v25, v25
    v_mfma_f32_16x16x32_bf16 a[184:187], a[240:243], v[108:111], a[184:187]
    ds_read_b64_tr_b16 a[236:237], v12 offset:27968
    v_mfma_f32_16x16x32_bf16 a[180:183], a[244:247], v[104:107], a[180:183]
    ds_read_b64_tr_b16 a[238:239], v12 offset:32576
    v_exp_f32 v26, v26
    v_exp_f32 v27, v27
    v_pk_add_f32 v[24:25], v[24:25], 1.0 op_sel_hi:[1,0]
    v_pk_add_f32 v[26:27], v[26:27], 1.0 op_sel_hi:[1,0]
    v_mfma_f32_16x16x32_bf16 a[188:191], a[244:247], v[108:111], a[188:191]
    s_waitcnt vmcnt(25)
    s_barrier
    ds_read_b64_tr_b16 a[240:241], v13 offset:0
    s_waitcnt lgkmcnt(9)
    v_mfma_f32_16x16x32_bf16 a[192:195], a[248:251], v[104:107], a[192:195]
    ds_read_b64_tr_b16 a[242:243], v13 offset:4608
    s_sub_u32 s52, s53, s52
    s_add_u32 m0, s52, 0
    s_cmp_eq_u32 s37, 0
    s_mov_b32 s32, 258336
    s_cselect_b32 s32, 221760, s32
    buffer_load_dwordx4 v7, s[12:15], s32 offen offset:0 lds
    v_mfma_f32_16x16x32_bf16 a[200:203], a[248:251], v[108:111], a[200:203]
    ds_read_b64_tr_b16 a[244:245], v13 offset:32
    v_mfma_f32_16x16x32_bf16 a[196:199], a[252:255], v[104:107], a[196:199]
    ds_read_b64_tr_b16 a[246:247], v13 offset:4640
    buffer_load_dwordx4 v8, s[12:15], s32 offen offset:1024 lds
    v_rcp_f32 v24, v24
    v_rcp_f32 v25, v25
    v_rcp_f32 v26, v26
    v_mfma_f32_16x16x32_bf16 a[204:207], a[252:255], v[108:111], a[204:207]
    ds_read_b64_tr_b16 a[248:249], v13 offset:64
    s_waitcnt lgkmcnt(9)
    v_mfma_f32_16x16x32_bf16 a[208:211], a[224:227], v[104:107], a[208:211]
    ds_read_b64_tr_b16 a[250:251], v13 offset:4672
    buffer_load_dwordx4 v9, s[12:15], s32 offen offset:2048 lds
    v_rcp_f32 v27, v27
    v_pk_mul_f32 v[24:25], v[24:25], v[28:29]
    v_pk_mul_f32 v[26:27], v[26:27], v[30:31]
    v_mfma_f32_16x16x32_bf16 a[216:219], a[224:227], v[108:111], a[216:219]
    ds_read_b64_tr_b16 a[252:253], v13 offset:96
    v_mfma_f32_16x16x32_bf16 a[212:215], a[228:231], v[104:107], a[212:215]
    ds_read_b64_tr_b16 a[254:255], v13 offset:4704
    buffer_load_dwordx4 v10, s[12:15], s32 offen offset:3072 lds
    v_cvt_pk_bf16_f32 v126, v24, v25
    v_cvt_pk_bf16_f32 v127, v26, v27
    v_accvgpr_read_b32 v24, a64
    v_mfma_f32_16x16x32_bf16 a[220:223], a[228:231], v[108:111], a[220:223]
    ds_read_b64_tr_b16 a[224:225], v13 offset:128
    s_waitcnt lgkmcnt(9)
    v_mfma_f32_16x16x32_bf16 v[32:35], a[232:235], v[104:107], v[32:35]
    ds_read_b64_tr_b16 a[226:227], v13 offset:4736
    s_add_u32 m0, m0, 0x400
    s_mov_b64 exec, s[34:35]
    buffer_load_dwordx4 v11, s[12:15], s32 offen offset:3072 lds
    s_mov_b64 exec, -1
    v_accvgpr_read_b32 v25, a65
    v_accvgpr_read_b32 v26, a66
    v_mfma_f32_16x16x32_bf16 v[40:43], a[232:235], v[108:111], v[40:43]
    ds_read_b64_tr_b16 a[228:229], v13 offset:160
    v_mfma_f32_16x16x32_bf16 v[36:39], a[236:239], v[104:107], v[36:39]
    ds_read_b64_tr_b16 a[230:231], v13 offset:4768
    v_accvgpr_read_b32 v27, a67
    v_accvgpr_read_b32 v28, a68
    v_accvgpr_read_b32 v29, a69
    v_accvgpr_read_b32 v30, a70
    v_mfma_f32_16x16x32_bf16 v[44:47], a[236:239], v[108:111], v[44:47]
    ds_read_b64_tr_b16 a[232:233], v13 offset:192
    s_waitcnt lgkmcnt(9)
    v_mfma_f32_16x16x32_bf16 a[96:99], a[240:243], v[112:115], a[96:99]
    ds_read_b64_tr_b16 a[234:235], v13 offset:4800
    v_accvgpr_read_b32 v31, a71
    v_exp_f32 v24, v24
    v_exp_f32 v25, v25
    v_exp_f32 v26, v26
    v_mfma_f32_16x16x32_bf16 a[104:107], a[240:243], v[116:119], a[104:107]
    ds_read_b64_tr_b16 a[236:237], v13 offset:224
    v_mfma_f32_16x16x32_bf16 a[100:103], a[244:247], v[112:115], a[100:103]
    ds_read_b64_tr_b16 a[238:239], v13 offset:4832
    v_exp_f32 v27, v27
    v_pk_add_f32 v[24:25], v[24:25], 1.0 op_sel_hi:[1,0]
    v_pk_add_f32 v[26:27], v[26:27], 1.0 op_sel_hi:[1,0]
    v_rcp_f32 v24, v24
    v_mfma_f32_16x16x32_bf16 a[108:111], a[244:247], v[116:119], a[108:111]
    ds_read_b64_tr_b16 a[240:241], v13 offset:256
    s_waitcnt lgkmcnt(9)
    v_mfma_f32_16x16x32_bf16 a[112:115], a[248:251], v[112:115], a[112:115]
    ds_read_b64_tr_b16 a[242:243], v13 offset:4864
    v_rcp_f32 v25, v25
    v_rcp_f32 v26, v26
    v_rcp_f32 v27, v27
    v_pk_mul_f32 v[24:25], v[24:25], v[28:29]
    v_mfma_f32_16x16x32_bf16 a[120:123], a[248:251], v[116:119], a[120:123]
    ds_read_b64_tr_b16 a[244:245], v13 offset:9216
    v_mfma_f32_16x16x32_bf16 a[116:119], a[252:255], v[112:115], a[116:119]
    ds_read_b64_tr_b16 a[246:247], v13 offset:13824
    v_pk_mul_f32 v[26:27], v[26:27], v[30:31]
    v_cvt_pk_bf16_f32 v128, v24, v25
    v_cvt_pk_bf16_f32 v129, v26, v27
    v_accvgpr_read_b32 v24, a80
    v_mfma_f32_16x16x32_bf16 a[124:127], a[252:255], v[116:119], a[124:127]
    ds_read_b64_tr_b16 a[248:249], v13 offset:9248
    s_waitcnt lgkmcnt(9)
    v_mfma_f32_16x16x32_bf16 a[128:131], a[224:227], v[112:115], a[128:131]
    ds_read_b64_tr_b16 a[250:251], v13 offset:13856
    v_accvgpr_read_b32 v25, a81
    v_accvgpr_read_b32 v26, a82
    v_accvgpr_read_b32 v27, a83
    v_accvgpr_read_b32 v28, a84
    v_mfma_f32_16x16x32_bf16 a[136:139], a[224:227], v[116:119], a[136:139]
    ds_read_b64_tr_b16 a[252:253], v13 offset:9280
    v_mfma_f32_16x16x32_bf16 a[132:135], a[228:231], v[112:115], a[132:135]
    ds_read_b64_tr_b16 a[254:255], v13 offset:13888
    v_accvgpr_read_b32 v29, a85
    v_accvgpr_read_b32 v30, a86
    v_accvgpr_read_b32 v31, a87
    v_exp_f32 v24, v24
    v_mfma_f32_16x16x32_bf16 a[140:143], a[228:231], v[116:119], a[140:143]
    ds_read_b64_tr_b16 a[224:225], v13 offset:9312
    s_waitcnt lgkmcnt(9)
    v_mfma_f32_16x16x32_bf16 a[144:147], a[232:235], v[112:115], a[144:147]
    ds_read_b64_tr_b16 a[226:227], v13 offset:13920
    v_exp_f32 v25, v25
    v_exp_f32 v26, v26
    v_exp_f32 v27, v27
    v_pk_add_f32 v[24:25], v[24:25], 1.0 op_sel_hi:[1,0]
    v_mfma_f32_16x16x32_bf16 a[152:155], a[232:235], v[116:119], a[152:155]
    ds_read_b64_tr_b16 a[228:229], v13 offset:9344
    v_mfma_f32_16x16x32_bf16 a[148:151], a[236:239], v[112:115], a[148:151]
    ds_read_b64_tr_b16 a[230:231], v13 offset:13952
    v_pk_add_f32 v[26:27], v[26:27], 1.0 op_sel_hi:[1,0]
    v_rcp_f32 v24, v24
    v_rcp_f32 v25, v25
    v_rcp_f32 v26, v26
    v_mfma_f32_16x16x32_bf16 a[156:159], a[236:239], v[116:119], a[156:159]
    ds_read_b64_tr_b16 a[232:233], v13 offset:9376
    s_waitcnt lgkmcnt(9)
    v_mfma_f32_16x16x32_bf16 a[160:163], a[240:243], v[112:115], a[160:163]
    ds_read_b64_tr_b16 a[234:235], v13 offset:13984
    v_rcp_f32 v27, v27
    v_pk_mul_f32 v[24:25], v[24:25], v[28:29]
    v_pk_mul_f32 v[26:27], v[26:27], v[30:31]
    v_cvt_pk_bf16_f32 v130, v24, v25
    v_mfma_f32_16x16x32_bf16 a[168:171], a[240:243], v[116:119], a[168:171]
    ds_read_b64_tr_b16 a[236:237], v13 offset:9408
    v_mfma_f32_16x16x32_bf16 a[164:167], a[244:247], v[112:115], a[164:167]
    ds_read_b64_tr_b16 a[238:239], v13 offset:14016
    v_cvt_pk_bf16_f32 v131, v26, v27
    v_accvgpr_read_b32 v24, a72
    v_accvgpr_read_b32 v25, a73
    v_accvgpr_read_b32 v26, a74
    v_mfma_f32_16x16x32_bf16 a[172:175], a[244:247], v[116:119], a[172:175]
    ds_read_b64_tr_b16 a[240:241], v13 offset:9440
    s_waitcnt lgkmcnt(9)
    v_mfma_f32_16x16x32_bf16 a[176:179], a[248:251], v[112:115], a[176:179]
    ds_read_b64_tr_b16 a[242:243], v13 offset:14048
    v_accvgpr_read_b32 v27, a75
    v_accvgpr_read_b32 v28, a76
    v_accvgpr_read_b32 v29, a77
    v_accvgpr_read_b32 v30, a78
    v_mfma_f32_16x16x32_bf16 a[184:187], a[248:251], v[116:119], a[184:187]
    ds_read_b64_tr_b16 a[244:245], v13 offset:9472
    v_mfma_f32_16x16x32_bf16 a[180:183], a[252:255], v[112:115], a[180:183]
    ds_read_b64_tr_b16 a[246:247], v13 offset:14080
    v_accvgpr_read_b32 v31, a79
    v_exp_f32 v24, v24
    v_exp_f32 v25, v25
    v_exp_f32 v26, v26
    v_mfma_f32_16x16x32_bf16 a[188:191], a[252:255], v[116:119], a[188:191]
    s_waitcnt vmcnt(25)
    s_barrier
    ds_read_b64_tr_b16 a[248:249], v13 offset:18496
    s_waitcnt lgkmcnt(9)
    v_mfma_f32_16x16x32_bf16 a[192:195], a[224:227], v[112:115], a[192:195]
    ds_read_b64_tr_b16 a[250:251], v13 offset:23104
    s_add_u32 m0, s52, 18496
    s_cmp_eq_u32 s37, 0
    s_mov_b32 s32, 576
    s_cselect_b32 s32, 295488, s32
    buffer_load_dwordx4 v7, s[12:15], s32 offen offset:0 lds
    v_exp_f32 v27, v27
    v_mfma_f32_16x16x32_bf16 a[200:203], a[224:227], v[116:119], a[200:203]
    ds_read_b64_tr_b16 a[252:253], v13 offset:18528
    v_mfma_f32_16x16x32_bf16 a[196:199], a[228:231], v[112:115], a[196:199]
    ds_read_b64_tr_b16 a[254:255], v13 offset:23136
    buffer_load_dwordx4 v8, s[12:15], s32 offen offset:1024 lds
    v_pk_add_f32 v[24:25], v[24:25], 1.0 op_sel_hi:[1,0]
    v_pk_add_f32 v[26:27], v[26:27], 1.0 op_sel_hi:[1,0]
    v_rcp_f32 v24, v24
    v_mfma_f32_16x16x32_bf16 a[204:207], a[228:231], v[116:119], a[204:207]
    ds_read_b64_tr_b16 a[224:225], v13 offset:18560
    s_waitcnt lgkmcnt(9)
    v_mfma_f32_16x16x32_bf16 a[208:211], a[232:235], v[112:115], a[208:211]
    ds_read_b64_tr_b16 a[226:227], v13 offset:23168
    buffer_load_dwordx4 v9, s[12:15], s32 offen offset:2048 lds
    v_rcp_f32 v25, v25
    v_rcp_f32 v26, v26
    v_rcp_f32 v27, v27
    v_mfma_f32_16x16x32_bf16 a[216:219], a[232:235], v[116:119], a[216:219]
    ds_read_b64_tr_b16 a[228:229], v13 offset:18592
    v_mfma_f32_16x16x32_bf16 a[212:215], a[236:239], v[112:115], a[212:215]
    ds_read_b64_tr_b16 a[230:231], v13 offset:23200
    buffer_load_dwordx4 v10, s[12:15], s32 offen offset:3072 lds
    v_pk_mul_f32 v[24:25], v[24:25], v[28:29]
    v_pk_mul_f32 v[26:27], v[26:27], v[30:31]
    v_cvt_pk_bf16_f32 v132, v24, v25
    v_mfma_f32_16x16x32_bf16 a[220:223], a[236:239], v[116:119], a[220:223]
    ds_read_b64_tr_b16 a[232:233], v13 offset:18624
    s_waitcnt lgkmcnt(9)
    v_mfma_f32_16x16x32_bf16 v[32:35], a[240:243], v[112:115], v[32:35]
    ds_read_b64_tr_b16 a[234:235], v13 offset:23232
    s_add_u32 m0, m0, 0x400
    s_mov_b64 exec, s[34:35]
    buffer_load_dwordx4 v11, s[12:15], s32 offen offset:3072 lds
    s_mov_b64 exec, -1
    v_cvt_pk_bf16_f32 v133, v26, v27
    v_accvgpr_read_b32 v24, a88
    v_mfma_f32_16x16x32_bf16 v[40:43], a[240:243], v[116:119], v[40:43]
    ds_read_b64_tr_b16 a[236:237], v13 offset:18656
    v_mfma_f32_16x16x32_bf16 v[36:39], a[244:247], v[112:115], v[36:39]
    ds_read_b64_tr_b16 a[238:239], v13 offset:23264
    v_accvgpr_read_b32 v25, a89
    v_accvgpr_read_b32 v26, a90
    v_accvgpr_read_b32 v27, a91
    v_accvgpr_read_b32 v28, a92
    v_mfma_f32_16x16x32_bf16 v[44:47], a[244:247], v[116:119], v[44:47]
    ds_read_b64_tr_b16 a[240:241], v13 offset:18688
    s_waitcnt lgkmcnt(9)
    v_mfma_f32_16x16x32_bf16 a[96:99], a[248:251], v[120:123], a[96:99]
    ds_read_b64_tr_b16 a[242:243], v13 offset:23296
    v_accvgpr_read_b32 v29, a93
    v_accvgpr_read_b32 v30, a94
    v_accvgpr_read_b32 v31, a95
    v_exp_f32 v24, v24
    v_mfma_f32_16x16x32_bf16 a[104:107], a[248:251], v[124:127], a[104:107]
    ds_read_b64_tr_b16 a[244:245], v13 offset:18720
    v_mfma_f32_16x16x32_bf16 a[100:103], a[252:255], v[120:123], a[100:103]
    ds_read_b64_tr_b16 a[246:247], v13 offset:23328
    v_exp_f32 v25, v25
    v_exp_f32 v26, v26
    v_exp_f32 v27, v27
    v_pk_add_f32 v[24:25], v[24:25], 1.0 op_sel_hi:[1,0]
    v_mfma_f32_16x16x32_bf16 a[108:111], a[252:255], v[124:127], a[108:111]
    ds_read_b64_tr_b16 a[248:249], v13 offset:18752
    s_waitcnt lgkmcnt(9)
    v_mfma_f32_16x16x32_bf16 a[112:115], a[224:227], v[120:123], a[112:115]
    ds_read_b64_tr_b16 a[250:251], v13 offset:23360
    v_pk_add_f32 v[26:27], v[26:27], 1.0 op_sel_hi:[1,0]
    v_rcp_f32 v24, v24
    v_rcp_f32 v25, v25
    v_rcp_f32 v26, v26
    v_mfma_f32_16x16x32_bf16 a[120:123], a[224:227], v[124:127], a[120:123]
    ds_read_b64_tr_b16 a[252:253], v13 offset:27712
    v_mfma_f32_16x16x32_bf16 a[116:119], a[228:231], v[120:123], a[116:119]
    ds_read_b64_tr_b16 a[254:255], v13 offset:32320
    v_rcp_f32 v27, v27
    v_pk_mul_f32 v[24:25], v[24:25], v[28:29]
    v_pk_mul_f32 v[26:27], v[26:27], v[30:31]
    v_cvt_pk_bf16_f32 v134, v24, v25
    v_mfma_f32_16x16x32_bf16 a[124:127], a[228:231], v[124:127], a[124:127]
    ds_read_b64_tr_b16 a[224:225], v13 offset:27744
    s_waitcnt lgkmcnt(9)
    v_mfma_f32_16x16x32_bf16 a[128:131], a[232:235], v[120:123], a[128:131]
    ds_read_b64_tr_b16 a[226:227], v13 offset:32352
    v_cvt_pk_bf16_f32 v135, v26, v27
    v_mfma_f32_16x16x32_bf16 a[136:139], a[232:235], v[124:127], a[136:139]
    ds_read_b64_tr_b16 a[228:229], v13 offset:27776
    v_mfma_f32_16x16x32_bf16 a[132:135], a[236:239], v[120:123], a[132:135]
    ds_read_b64_tr_b16 a[230:231], v13 offset:32384
    v_mfma_f32_16x16x32_bf16 a[140:143], a[236:239], v[124:127], a[140:143]
    ds_read_b64_tr_b16 a[232:233], v13 offset:27808
    s_waitcnt lgkmcnt(9)
    v_mfma_f32_16x16x32_bf16 a[144:147], a[240:243], v[120:123], a[144:147]
    ds_read_b64_tr_b16 a[234:235], v13 offset:32416
    v_mfma_f32_16x16x32_bf16 a[152:155], a[240:243], v[124:127], a[152:155]
    ds_read_b64_tr_b16 a[236:237], v13 offset:27840
    v_mfma_f32_16x16x32_bf16 a[148:151], a[244:247], v[120:123], a[148:151]
    ds_read_b64_tr_b16 a[238:239], v13 offset:32448
    v_mfma_f32_16x16x32_bf16 a[156:159], a[244:247], v[124:127], a[156:159]
    ds_read_b64_tr_b16 a[240:241], v13 offset:27872
    s_waitcnt lgkmcnt(9)
    v_mfma_f32_16x16x32_bf16 a[160:163], a[248:251], v[120:123], a[160:163]
    ds_read_b64_tr_b16 a[242:243], v13 offset:32480
    v_mfma_f32_16x16x32_bf16 a[168:171], a[248:251], v[124:127], a[168:171]
    ds_read_b64_tr_b16 a[244:245], v13 offset:27904
    v_mfma_f32_16x16x32_bf16 a[164:167], a[252:255], v[120:123], a[164:167]
    ds_read_b64_tr_b16 a[246:247], v13 offset:32512
    v_mfma_f32_16x16x32_bf16 a[172:175], a[252:255], v[124:127], a[172:175]
    ds_read_b64_tr_b16 a[248:249], v13 offset:27936
    s_waitcnt lgkmcnt(9)
    v_mfma_f32_16x16x32_bf16 a[176:179], a[224:227], v[120:123], a[176:179]
    ds_read_b64_tr_b16 a[250:251], v13 offset:32544
    v_mfma_f32_16x16x32_bf16 a[184:187], a[224:227], v[124:127], a[184:187]
    ds_read_b64_tr_b16 a[252:253], v13 offset:27968
    v_mfma_f32_16x16x32_bf16 a[180:183], a[228:231], v[120:123], a[180:183]
    ds_read_b64_tr_b16 a[254:255], v13 offset:32576
    v_mfma_f32_16x16x32_bf16 a[188:191], a[228:231], v[124:127], a[188:191]
    s_waitcnt vmcnt(25)
    s_barrier
    v_add_u32 v12, s54, v12
    v_add_u32 v13, s54, v13
    s_sub_u32 s54, 0, s54
    ds_read_b64_tr_b16 a[224:225], v12 offset:0
    s_waitcnt lgkmcnt(9)
    v_mfma_f32_16x16x32_bf16 a[192:195], a[232:235], v[120:123], a[192:195]
    ds_read_b64_tr_b16 a[226:227], v12 offset:4608
    s_add_u32 m0, s52, 36992
    s_cmp_eq_u32 s37, 0
    s_mov_b32 s32, 74304
    s_cselect_b32 s32, 37728, s32
    buffer_load_dwordx4 v7, s[12:15], s32 offen offset:0 lds
    v_mfma_f32_16x16x32_bf16 a[200:203], a[232:235], v[124:127], a[200:203]
    ds_read_b64_tr_b16 a[228:229], v12 offset:32
    v_mfma_f32_16x16x32_bf16 a[196:199], a[236:239], v[120:123], a[196:199]
    ds_read_b64_tr_b16 a[230:231], v12 offset:4640
    buffer_load_dwordx4 v8, s[12:15], s32 offen offset:1024 lds
    v_mfma_f32_16x16x32_bf16 a[204:207], a[236:239], v[124:127], a[204:207]
    ds_read_b64_tr_b16 a[232:233], v12 offset:64
    s_waitcnt lgkmcnt(9)
    v_mfma_f32_16x16x32_bf16 a[208:211], a[240:243], v[120:123], a[208:211]
    ds_read_b64_tr_b16 a[234:235], v12 offset:4672
    buffer_load_dwordx4 v9, s[12:15], s32 offen offset:2048 lds
    v_mfma_f32_16x16x32_bf16 a[216:219], a[240:243], v[124:127], a[216:219]
    ds_read_b64_tr_b16 a[236:237], v12 offset:96
    v_mfma_f32_16x16x32_bf16 a[212:215], a[244:247], v[120:123], a[212:215]
    ds_read_b64_tr_b16 a[238:239], v12 offset:4704
    buffer_load_dwordx4 v10, s[12:15], s32 offen offset:3072 lds
    v_mfma_f32_16x16x32_bf16 a[220:223], a[244:247], v[124:127], a[220:223]
    ds_read_b64_tr_b16 a[240:241], v12 offset:128
    s_waitcnt lgkmcnt(9)
    v_mfma_f32_16x16x32_bf16 v[32:35], a[248:251], v[120:123], v[32:35]
    ds_read_b64_tr_b16 a[242:243], v12 offset:4736
    s_add_u32 m0, m0, 0x400
    s_mov_b64 exec, s[34:35]
    buffer_load_dwordx4 v11, s[12:15], s32 offen offset:3072 lds
    s_mov_b64 exec, -1
    v_mfma_f32_16x16x32_bf16 v[40:43], a[248:251], v[124:127], v[40:43]
    ds_read_b64_tr_b16 a[244:245], v12 offset:160
    v_mfma_f32_16x16x32_bf16 v[36:39], a[252:255], v[120:123], v[36:39]
    ds_read_b64_tr_b16 a[246:247], v12 offset:4768
    v_mfma_f32_16x16x32_bf16 v[44:47], a[252:255], v[124:127], v[44:47]
    ds_read_b64_tr_b16 a[248:249], v12 offset:192
    s_waitcnt lgkmcnt(9)
    v_mfma_f32_16x16x32_bf16 a[96:99], a[224:227], v[128:131], a[96:99]
    ds_read_b64_tr_b16 a[250:251], v12 offset:4800
    v_mfma_f32_16x16x32_bf16 a[104:107], a[224:227], v[132:135], a[104:107]
    ds_read_b64_tr_b16 a[252:253], v12 offset:224
    v_mfma_f32_16x16x32_bf16 a[100:103], a[228:231], v[128:131], a[100:103]
    ds_read_b64_tr_b16 a[254:255], v12 offset:4832
    v_mfma_f32_16x16x32_bf16 a[108:111], a[228:231], v[132:135], a[108:111]
    ds_read_b64_tr_b16 a[224:225], v12 offset:256
    s_waitcnt lgkmcnt(9)
    v_mfma_f32_16x16x32_bf16 a[112:115], a[232:235], v[128:131], a[112:115]
    ds_read_b64_tr_b16 a[226:227], v12 offset:4864
    v_mfma_f32_16x16x32_bf16 a[120:123], a[232:235], v[132:135], a[120:123]
    ds_read_b64_tr_b16 a[228:229], v12 offset:9216
    v_mfma_f32_16x16x32_bf16 a[116:119], a[236:239], v[128:131], a[116:119]
    ds_read_b64_tr_b16 a[230:231], v12 offset:13824
    v_mfma_f32_16x16x32_bf16 a[124:127], a[236:239], v[132:135], a[124:127]
    ds_read_b64_tr_b16 a[232:233], v12 offset:9248
    s_waitcnt lgkmcnt(9)
    v_mfma_f32_16x16x32_bf16 a[128:131], a[240:243], v[128:131], a[128:131]
    ds_read_b64_tr_b16 a[234:235], v12 offset:13856
    v_accvgpr_read_b32 v24, a96
    v_accvgpr_read_b32 v25, a97
    v_accvgpr_read_b32 v26, a98
    v_accvgpr_read_b32 v27, a99
    v_mfma_f32_16x16x32_bf16 a[136:139], a[240:243], v[132:135], a[136:139]
    ds_read_b64_tr_b16 a[236:237], v12 offset:9280
    v_mfma_f32_16x16x32_bf16 a[132:135], a[244:247], v[128:131], a[132:135]
    ds_read_b64_tr_b16 a[238:239], v12 offset:13888
    v_accvgpr_read_b32 v28, a100
    v_accvgpr_read_b32 v29, a101
    v_accvgpr_read_b32 v30, a102
    v_accvgpr_read_b32 v31, a103
    v_mfma_f32_16x16x32_bf16 a[140:143], a[244:247], v[132:135], a[140:143]
    ds_read_b64_tr_b16 a[240:241], v12 offset:9312
    s_waitcnt lgkmcnt(9)
    v_mfma_f32_16x16x32_bf16 a[144:147], a[248:251], v[128:131], a[144:147]
    ds_read_b64_tr_b16 a[242:243], v12 offset:13920
    v_cvt_pk_bf16_f32 v24, v24, v25
    v_cvt_pk_bf16_f32 v25, v26, v27
    v_cvt_pk_bf16_f32 v26, v28, v29
    v_cvt_pk_bf16_f32 v27, v30, v31
    v_mfma_f32_16x16x32_bf16 a[152:155], a[248:251], v[132:135], a[152:155]
    ds_read_b64_tr_b16 a[244:245], v12 offset:9344
    v_mfma_f32_16x16x32_bf16 a[148:151], a[252:255], v[128:131], a[148:151]
    ds_read_b64_tr_b16 a[246:247], v12 offset:13952
    s_mov_b32 s33, 0
    buffer_store_dwordx4 v[24:27], v18, s[20:23], s33 offen sc0 sc1
    s_nop 1
    v_accvgpr_read_b32 v24, a104
    v_accvgpr_read_b32 v25, a105
    v_mfma_f32_16x16x32_bf16 a[156:159], a[252:255], v[132:135], a[156:159]
    ds_read_b64_tr_b16 a[248:249], v12 offset:9376
    s_waitcnt lgkmcnt(9)
    v_mfma_f32_16x16x32_bf16 a[160:163], a[224:227], v[128:131], a[160:163]
    ds_read_b64_tr_b16 a[250:251], v12 offset:13984
    v_accvgpr_read_b32 v26, a106
    v_accvgpr_read_b32 v27, a107
    v_accvgpr_read_b32 v28, a108
    v_accvgpr_read_b32 v29, a109
    v_mfma_f32_16x16x32_bf16 a[168:171], a[224:227], v[132:135], a[168:171]
    ds_read_b64_tr_b16 a[252:253], v12 offset:9408
    v_mfma_f32_16x16x32_bf16 a[164:167], a[228:231], v[128:131], a[164:167]
    ds_read_b64_tr_b16 a[254:255], v12 offset:14016
    v_accvgpr_read_b32 v30, a110
    v_accvgpr_read_b32 v31, a111
    v_cvt_pk_bf16_f32 v24, v24, v25
    v_cvt_pk_bf16_f32 v25, v26, v27
    v_mfma_f32_16x16x32_bf16 a[172:175], a[228:231], v[132:135], a[172:175]
    ds_read_b64_tr_b16 a[224:225], v12 offset:9440
    s_waitcnt lgkmcnt(9)
    v_mfma_f32_16x16x32_bf16 a[176:179], a[232:235], v[128:131], a[176:179]
    ds_read_b64_tr_b16 a[226:227], v12 offset:14048
    v_cvt_pk_bf16_f32 v26, v28, v29
    v_cvt_pk_bf16_f32 v27, v30, v31
    s_mov_b32 s33, 0
    buffer_store_dwordx4 v[24:27], v19, s[20:23], s33 offen sc0 sc1
    v_mfma_f32_16x16x32_bf16 a[184:187], a[232:235], v[132:135], a[184:187]
    ds_read_b64_tr_b16 a[228:229], v12 offset:9472
    v_mfma_f32_16x16x32_bf16 a[180:183], a[236:239], v[128:131], a[180:183]
    ds_read_b64_tr_b16 a[230:231], v12 offset:14080
    v_accvgpr_read_b32 v24, a112
    v_accvgpr_read_b32 v25, a113
    v_accvgpr_read_b32 v26, a114
    v_accvgpr_read_b32 v27, a115
    v_mfma_f32_16x16x32_bf16 a[188:191], a[236:239], v[132:135], a[188:191]
    s_waitcnt vmcnt(27)
    s_barrier
    ds_read_b64_tr_b16 a[232:233], v12 offset:18496
    s_waitcnt lgkmcnt(9)
    v_mfma_f32_16x16x32_bf16 a[192:195], a[240:243], v[128:131], a[192:195]
    ds_read_b64_tr_b16 a[234:235], v12 offset:23104
    s_add_u32 m0, s52, 55488
    s_cmp_eq_u32 s37, 0
    s_mov_b32 s32, 148032
    s_cselect_b32 s32, 111456, s32
    buffer_load_dwordx4 v7, s[12:15], s32 offen offset:0 lds
    v_accvgpr_read_b32 v28, a116
    v_mfma_f32_16x16x32_bf16 a[200:203], a[240:243], v[132:135], a[200:203]
    ds_read_b64_tr_b16 a[236:237], v12 offset:18528
    v_mfma_f32_16x16x32_bf16 a[196:199], a[244:247], v[128:131], a[196:199]
    ds_read_b64_tr_b16 a[238:239], v12 offset:23136
    buffer_load_dwordx4 v8, s[12:15], s32 offen offset:1024 lds
    v_accvgpr_read_b32 v29, a117
    v_accvgpr_read_b32 v30, a118
    v_accvgpr_read_b32 v31, a119
    v_mfma_f32_16x16x32_bf16 a[204:207], a[244:247], v[132:135], a[204:207]
    ds_read_b64_tr_b16 a[240:241], v12 offset:18560
    s_waitcnt lgkmcnt(9)
    v_mfma_f32_16x16x32_bf16 a[208:211], a[248:251], v[128:131], a[208:211]
    ds_read_b64_tr_b16 a[242:243], v12 offset:23168
    buffer_load_dwordx4 v9, s[12:15], s32 offen offset:2048 lds
    v_cvt_pk_bf16_f32 v24, v24, v25
    v_cvt_pk_bf16_f32 v25, v26, v27
    v_cvt_pk_bf16_f32 v26, v28, v29
    v_mfma_f32_16x16x32_bf16 a[216:219], a[248:251], v[132:135], a[216:219]
    ds_read_b64_tr_b16 a[244:245], v12 offset:18592
    v_mfma_f32_16x16x32_bf16 a[212:215], a[252:255], v[128:131], a[212:215]
    ds_read_b64_tr_b16 a[246:247], v12 offset:23200
    buffer_load_dwordx4 v10, s[12:15], s32 offen offset:3072 lds
    v_cvt_pk_bf16_f32 v27, v30, v31
    s_mov_b32 s33, 1024
    buffer_store_dwordx4 v[24:27], v18, s[20:23], s33 offen sc0 sc1
    v_mfma_f32_16x16x32_bf16 a[220:223], a[252:255], v[132:135], a[220:223]
    ds_read_b64_tr_b16 a[248:249], v12 offset:18624
    s_waitcnt lgkmcnt(9)
    v_mfma_f32_16x16x32_bf16 v[32:35], a[224:227], v[128:131], v[32:35]
    ds_read_b64_tr_b16 a[250:251], v12 offset:23232
    s_add_u32 m0, m0, 0x400
    s_mov_b64 exec, s[34:35]
    buffer_load_dwordx4 v11, s[12:15], s32 offen offset:3072 lds
    s_mov_b64 exec, -1
    v_accvgpr_read_b32 v24, a120
    v_accvgpr_read_b32 v25, a121
    v_mfma_f32_16x16x32_bf16 v[40:43], a[224:227], v[132:135], v[40:43]
    ds_read_b64_tr_b16 a[252:253], v12 offset:18656
    v_mfma_f32_16x16x32_bf16 v[36:39], a[228:231], v[128:131], v[36:39]
    ds_read_b64_tr_b16 a[254:255], v12 offset:23264
    v_accvgpr_read_b32 v26, a122
    v_accvgpr_read_b32 v27, a123
    v_accvgpr_read_b32 v28, a124
    v_accvgpr_read_b32 v29, a125
    v_mfma_f32_16x16x32_bf16 v[44:47], a[228:231], v[132:135], v[44:47]
    ds_read_b64_tr_b16 a[224:225], v12 offset:18688
    s_waitcnt lgkmcnt(9)
    v_mfma_f32_16x16x32_bf16 v[144:147], a[232:235], v[64:67], 0
    ds_read_b64_tr_b16 a[226:227], v12 offset:23296
    v_accvgpr_read_b32 v30, a126
    v_accvgpr_read_b32 v31, a127
    v_mfma_f32_16x16x32_bf16 v[152:155], a[232:235], v[68:71], 0
    ds_read_b64_tr_b16 a[228:229], v12 offset:18720
    v_mfma_f32_16x16x32_bf16 v[148:151], a[236:239], v[64:67], 0
    ds_read_b64_tr_b16 a[230:231], v12 offset:23328
    v_cvt_pk_bf16_f32 v24, v24, v25
    v_cvt_pk_bf16_f32 v25, v26, v27
    v_mfma_f32_16x16x32_bf16 v[156:159], a[236:239], v[68:71], 0
    ds_read_b64_tr_b16 a[232:233], v12 offset:18752
    s_waitcnt lgkmcnt(9)
    v_mfma_f32_16x16x32_bf16 v[160:163], a[240:243], v[64:67], 0
    ds_read_b64_tr_b16 a[234:235], v12 offset:23360
    v_cvt_pk_bf16_f32 v26, v28, v29
    v_cvt_pk_bf16_f32 v27, v30, v31
    v_mfma_f32_16x16x32_bf16 v[168:171], a[240:243], v[68:71], 0
    ds_read_b64_tr_b16 a[236:237], v12 offset:27712
    v_mfma_f32_16x16x32_bf16 v[164:167], a[244:247], v[64:67], 0
    ds_read_b64_tr_b16 a[238:239], v12 offset:32320
    s_mov_b32 s33, 1024
    buffer_store_dwordx4 v[24:27], v19, s[20:23], s33 offen sc0 sc1
    v_mfma_f32_16x16x32_bf16 v[172:175], a[244:247], v[68:71], 0
    ds_read_b64_tr_b16 a[240:241], v12 offset:27744
    s_waitcnt lgkmcnt(9)
    v_mfma_f32_16x16x32_bf16 v[176:179], a[248:251], v[64:67], 0
    ds_read_b64_tr_b16 a[242:243], v12 offset:32352
    v_accvgpr_read_b32 v24, a128
    v_accvgpr_read_b32 v25, a129
    v_mfma_f32_16x16x32_bf16 v[184:187], a[248:251], v[68:71], 0
    ds_read_b64_tr_b16 a[244:245], v12 offset:27776
    v_mfma_f32_16x16x32_bf16 v[180:183], a[252:255], v[64:67], 0
    ds_read_b64_tr_b16 a[246:247], v12 offset:32384
    v_accvgpr_read_b32 v26, a130
    v_accvgpr_read_b32 v27, a131
    v_mfma_f32_16x16x32_bf16 v[188:191], a[252:255], v[68:71], 0
    ds_read_b64_tr_b16 a[248:249], v12 offset:27808
    s_waitcnt lgkmcnt(9)
    v_mfma_f32_16x16x32_bf16 v[192:195], a[224:227], v[64:67], 0
    ds_read_b64_tr_b16 a[250:251], v12 offset:32416
    v_accvgpr_read_b32 v28, a132
    v_accvgpr_read_b32 v29, a133
    v_mfma_f32_16x16x32_bf16 v[200:203], a[224:227], v[68:71], 0
    ds_read_b64_tr_b16 a[252:253], v12 offset:27840
    v_mfma_f32_16x16x32_bf16 v[196:199], a[228:231], v[64:67], 0
    ds_read_b64_tr_b16 a[254:255], v12 offset:32448
    v_accvgpr_read_b32 v30, a134
    v_accvgpr_read_b32 v31, a135
    v_mfma_f32_16x16x32_bf16 v[204:207], a[228:231], v[68:71], 0
    ds_read_b64_tr_b16 a[224:225], v12 offset:27872
    s_waitcnt lgkmcnt(9)
    v_mfma_f32_16x16x32_bf16 v[208:211], a[232:235], v[64:67], 0
    ds_read_b64_tr_b16 a[226:227], v12 offset:32480
    v_cvt_pk_bf16_f32 v24, v24, v25
    v_cvt_pk_bf16_f32 v25, v26, v27
    v_mfma_f32_16x16x32_bf16 v[216:219], a[232:235], v[68:71], 0
    ds_read_b64_tr_b16 a[228:229], v12 offset:27904
    v_mfma_f32_16x16x32_bf16 v[144:147], a[236:239], v[72:75], v[144:147]
    ds_read_b64_tr_b16 a[230:231], v12 offset:32512
    v_cvt_pk_bf16_f32 v26, v28, v29
    v_cvt_pk_bf16_f32 v27, v30, v31
    v_mfma_f32_16x16x32_bf16 v[152:155], a[236:239], v[76:79], v[152:155]
    ds_read_b64_tr_b16 a[232:233], v12 offset:27936
    s_waitcnt lgkmcnt(9)
    v_mfma_f32_16x16x32_bf16 v[148:151], a[240:243], v[72:75], v[148:151]
    ds_read_b64_tr_b16 a[234:235], v12 offset:32544
    s_mov_b32 s33, 2048
    buffer_store_dwordx4 v[24:27], v18, s[20:23], s33 offen sc0 sc1
    v_mfma_f32_16x16x32_bf16 v[156:159], a[240:243], v[76:79], v[156:159]
    ds_read_b64_tr_b16 a[236:237], v12 offset:27968
    v_mfma_f32_16x16x32_bf16 v[160:163], a[244:247], v[72:75], v[160:163]
    ds_read_b64_tr_b16 a[238:239], v12 offset:32576
    v_accvgpr_read_b32 v24, a136
    v_accvgpr_read_b32 v25, a137
    v_mfma_f32_16x16x32_bf16 v[168:171], a[244:247], v[76:79], v[168:171]
    s_waitcnt vmcnt(30)
    s_barrier
    ds_read_b64_tr_b16 a[240:241], v13 offset:0
    s_waitcnt lgkmcnt(9)
    v_mfma_f32_16x16x32_bf16 v[164:167], a[248:251], v[72:75], v[164:167]
    ds_read_b64_tr_b16 a[242:243], v13 offset:4608
    s_sub_u32 s52, s53, s52
    s_add_u32 m0, s52, 0
    s_cmp_eq_u32 s37, 0
    s_mov_b32 s32, 221760
    s_cselect_b32 s32, 185184, s32
    buffer_load_dwordx4 v7, s[12:15], s32 offen offset:0 lds
    v_mfma_f32_16x16x32_bf16 v[172:175], a[248:251], v[76:79], v[172:175]
    ds_read_b64_tr_b16 a[244:245], v13 offset:32
    v_mfma_f32_16x16x32_bf16 v[176:179], a[252:255], v[72:75], v[176:179]
    ds_read_b64_tr_b16 a[246:247], v13 offset:4640
    buffer_load_dwordx4 v8, s[12:15], s32 offen offset:1024 lds
    v_accvgpr_read_b32 v26, a138
    v_mfma_f32_16x16x32_bf16 v[184:187], a[252:255], v[76:79], v[184:187]
    ds_read_b64_tr_b16 a[248:249], v13 offset:64
    s_waitcnt lgkmcnt(9)
    v_mfma_f32_16x16x32_bf16 v[180:183], a[224:227], v[72:75], v[180:183]
    ds_read_b64_tr_b16 a[250:251], v13 offset:4672
    buffer_load_dwordx4 v9, s[12:15], s32 offen offset:2048 lds
    v_accvgpr_read_b32 v27, a139
    v_mfma_f32_16x16x32_bf16 v[188:191], a[224:227], v[76:79], v[188:191]
    ds_read_b64_tr_b16 a[252:253], v13 offset:96
    v_mfma_f32_16x16x32_bf16 v[192:195], a[228:231], v[72:75], v[192:195]
    ds_read_b64_tr_b16 a[254:255], v13 offset:4704
    buffer_load_dwordx4 v10, s[12:15], s32 offen offset:3072 lds
    v_accvgpr_read_b32 v28, a140
    v_mfma_f32_16x16x32_bf16 v[200:203], a[228:231], v[76:79], v[200:203]
    ds_read_b64_tr_b16 a[224:225], v13 offset:128
    s_waitcnt lgkmcnt(9)
    v_mfma_f32_16x16x32_bf16 v[196:199], a[232:235], v[72:75], v[196:199]
    ds_read_b64_tr_b16 a[226:227], v13 offset:4736
    s_add_u32 m0, m0, 0x400
    s_mov_b64 exec, s[34:35]
    buffer_load_dwordx4 v11, s[12:15], s32 offen offset:3072 lds
    s_mov_b64 exec, -1
    v_mfma_f32_16x16x32_bf16 v[204:207], a[232:235], v[76:79], v[204:207]
    ds_read_b64_tr_b16 a[228:229], v13 offset:160
    v_mfma_f32_16x16x32_bf16 v[208:211], a[236:239], v[72:75], v[208:211]
    ds_read_b64_tr_b16 a[230:231], v13 offset:4768
    v_accvgpr_read_b32 v29, a141
    v_accvgpr_read_b32 v30, a142
    v_mfma_f32_16x16x32_bf16 v[216:219], a[236:239], v[76:79], v[216:219]
    ds_read_b64_tr_b16 a[232:233], v13 offset:192
    s_waitcnt lgkmcnt(9)
    v_mfma_f32_16x16x32_bf16 v[144:147], a[240:243], v[80:83], v[144:147]
    ds_read_b64_tr_b16 a[234:235], v13 offset:4800
    v_accvgpr_read_b32 v31, a143
    v_cvt_pk_bf16_f32 v24, v24, v25
    v_mfma_f32_16x16x32_bf16 v[152:155], a[240:243], v[84:87], v[152:155]
    ds_read_b64_tr_b16 a[236:237], v13 offset:224
    v_mfma_f32_16x16x32_bf16 v[148:151], a[244:247], v[80:83], v[148:151]
    ds_read_b64_tr_b16 a[238:239], v13 offset:4832
    v_cvt_pk_bf16_f32 v25, v26, v27
    v_cvt_pk_bf16_f32 v26, v28, v29
    v_mfma_f32_16x16x32_bf16 v[156:159], a[244:247], v[84:87], v[156:159]
    ds_read_b64_tr_b16 a[240:241], v13 offset:256
    s_waitcnt lgkmcnt(9)
    v_mfma_f32_16x16x32_bf16 v[160:163], a[248:251], v[80:83], v[160:163]
    ds_read_b64_tr_b16 a[242:243], v13 offset:4864
    v_cvt_pk_bf16_f32 v27, v30, v31
    s_mov_b32 s33, 2048
    v_mfma_f32_16x16x32_bf16 v[168:171], a[248:251], v[84:87], v[168:171]
    ds_read_b64_tr_b16 a[244:245], v13 offset:9216
    v_mfma_f32_16x16x32_bf16 v[164:167], a[252:255], v[80:83], v[164:167]
    ds_read_b64_tr_b16 a[246:247], v13 offset:13824
    buffer_store_dwordx4 v[24:27], v19, s[20:23], s33 offen sc0 sc1
    s_nop 1
    v_accvgpr_read_b32 v24, a144
    v_mfma_f32_16x16x32_bf16 v[172:175], a[252:255], v[84:87], v[172:175]
    ds_read_b64_tr_b16 a[248:249], v13 offset:9248
    s_waitcnt lgkmcnt(9)
    v_mfma_f32_16x16x32_bf16 v[176:179], a[224:227], v[80:83], v[176:179]
    ds_read_b64_tr_b16 a[250:251], v13 offset:13856
    v_accvgpr_read_b32 v25, a145
    v_accvgpr_read_b32 v26, a146
    v_mfma_f32_16x16x32_bf16 v[184:187], a[224:227], v[84:87], v[184:187]
    ds_read_b64_tr_b16 a[252:253], v13 offset:9280
    v_mfma_f32_16x16x32_bf16 v[180:183], a[228:231], v[80:83], v[180:183]
    ds_read_b64_tr_b16 a[254:255], v13 offset:13888
    v_accvgpr_read_b32 v27, a147
    v_accvgpr_read_b32 v28, a148
    v_mfma_f32_16x16x32_bf16 v[188:191], a[228:231], v[84:87], v[188:191]
    ds_read_b64_tr_b16 a[224:225], v13 offset:9312
    s_waitcnt lgkmcnt(9)
    v_mfma_f32_16x16x32_bf16 v[192:195], a[232:235], v[80:83], v[192:195]
    ds_read_b64_tr_b16 a[226:227], v13 offset:13920
    v_accvgpr_read_b32 v29, a149
    v_accvgpr_read_b32 v30, a150
    v_mfma_f32_16x16x32_bf16 v[200:203], a[232:235], v[84:87], v[200:203]
    ds_read_b64_tr_b16 a[228:229], v13 offset:9344
    v_mfma_f32_16x16x32_bf16 v[196:199], a[236:239], v[80:83], v[196:199]
    ds_read_b64_tr_b16 a[230:231], v13 offset:13952
    v_accvgpr_read_b32 v31, a151
    v_cvt_pk_bf16_f32 v24, v24, v25
    v_mfma_f32_16x16x32_bf16 v[204:207], a[236:239], v[84:87], v[204:207]
    ds_read_b64_tr_b16 a[232:233], v13 offset:9376
    s_waitcnt lgkmcnt(9)
    v_mfma_f32_16x16x32_bf16 v[208:211], a[240:243], v[80:83], v[208:211]
    ds_read_b64_tr_b16 a[234:235], v13 offset:13984
    v_cvt_pk_bf16_f32 v25, v26, v27
    v_cvt_pk_bf16_f32 v26, v28, v29
    v_mfma_f32_16x16x32_bf16 v[216:219], a[240:243], v[84:87], v[216:219]
    ds_read_b64_tr_b16 a[236:237], v13 offset:9408
    v_mfma_f32_16x16x32_bf16 v[144:147], a[244:247], v[88:91], v[144:147]
    ds_read_b64_tr_b16 a[238:239], v13 offset:14016
    v_cvt_pk_bf16_f32 v27, v30, v31
    s_mov_b32 s33, 3072
    v_mfma_f32_16x16x32_bf16 v[152:155], a[244:247], v[92:95], v[152:155]
    ds_read_b64_tr_b16 a[240:241], v13 offset:9440
    s_waitcnt lgkmcnt(9)
    v_mfma_f32_16x16x32_bf16 v[148:151], a[248:251], v[88:91], v[148:151]
    ds_read_b64_tr_b16 a[242:243], v13 offset:14048
    buffer_store_dwordx4 v[24:27], v18, s[20:23], s33 offen sc0 sc1
    s_nop 1
    v_accvgpr_read_b32 v24, a152
    v_mfma_f32_16x16x32_bf16 v[156:159], a[248:251], v[92:95], v[156:159]
    ds_read_b64_tr_b16 a[244:245], v13 offset:9472
    v_mfma_f32_16x16x32_bf16 v[160:163], a[252:255], v[88:91], v[160:163]
    ds_read_b64_tr_b16 a[246:247], v13 offset:14080
    v_accvgpr_read_b32 v25, a153
    v_accvgpr_read_b32 v26, a154
    v_mfma_f32_16x16x32_bf16 v[168:171], a[252:255], v[92:95], v[168:171]
    s_waitcnt vmcnt(32)
    s_barrier
    ds_read_b64_tr_b16 a[248:249], v13 offset:18496
    s_waitcnt lgkmcnt(9)
    v_mfma_f32_16x16x32_bf16 v[164:167], a[224:227], v[88:91], v[164:167]
    ds_read_b64_tr_b16 a[250:251], v13 offset:23104
    s_add_u32 m0, s52, 18496
    s_cmp_eq_u32 s37, 0
    s_mov_b32 s32, 295488
    s_cselect_b32 s32, 258912, s32
    buffer_load_dwordx4 v7, s[12:15], s32 offen offset:0 lds
    v_mfma_f32_16x16x32_bf16 v[172:175], a[224:227], v[92:95], v[172:175]
    ds_read_b64_tr_b16 a[252:253], v13 offset:18528
    v_mfma_f32_16x16x32_bf16 v[176:179], a[228:231], v[88:91], v[176:179]
    ds_read_b64_tr_b16 a[254:255], v13 offset:23136
    buffer_load_dwordx4 v8, s[12:15], s32 offen offset:1024 lds
    v_accvgpr_read_b32 v27, a155
    v_mfma_f32_16x16x32_bf16 v[184:187], a[228:231], v[92:95], v[184:187]
    ds_read_b64_tr_b16 a[224:225], v13 offset:18560
    s_waitcnt lgkmcnt(9)
    v_mfma_f32_16x16x32_bf16 v[180:183], a[232:235], v[88:91], v[180:183]
    ds_read_b64_tr_b16 a[226:227], v13 offset:23168
    buffer_load_dwordx4 v9, s[12:15], s32 offen offset:2048 lds
    v_accvgpr_read_b32 v28, a156
    v_mfma_f32_16x16x32_bf16 v[188:191], a[232:235], v[92:95], v[188:191]
    ds_read_b64_tr_b16 a[228:229], v13 offset:18592
    v_mfma_f32_16x16x32_bf16 v[192:195], a[236:239], v[88:91], v[192:195]
    ds_read_b64_tr_b16 a[230:231], v13 offset:23200
    buffer_load_dwordx4 v10, s[12:15], s32 offen offset:3072 lds
    v_accvgpr_read_b32 v29, a157
    v_mfma_f32_16x16x32_bf16 v[200:203], a[236:239], v[92:95], v[200:203]
    ds_read_b64_tr_b16 a[232:233], v13 offset:18624
    s_waitcnt lgkmcnt(9)
    v_mfma_f32_16x16x32_bf16 v[196:199], a[240:243], v[88:91], v[196:199]
    ds_read_b64_tr_b16 a[234:235], v13 offset:23232
    s_add_u32 m0, m0, 0x400
    s_mov_b64 exec, s[34:35]
    buffer_load_dwordx4 v11, s[12:15], s32 offen offset:3072 lds
    s_mov_b64 exec, -1
    v_mfma_f32_16x16x32_bf16 v[204:207], a[240:243], v[92:95], v[204:207]
    ds_read_b64_tr_b16 a[236:237], v13 offset:18656
    v_mfma_f32_16x16x32_bf16 v[208:211], a[244:247], v[88:91], v[208:211]
    ds_read_b64_tr_b16 a[238:239], v13 offset:23264
    v_accvgpr_read_b32 v30, a158
    v_accvgpr_read_b32 v31, a159
    v_mfma_f32_16x16x32_bf16 v[216:219], a[244:247], v[92:95], v[216:219]
    ds_read_b64_tr_b16 a[240:241], v13 offset:18688
    s_waitcnt lgkmcnt(9)
    v_mfma_f32_16x16x32_bf16 v[144:147], a[248:251], v[96:99], v[144:147]
    ds_read_b64_tr_b16 a[242:243], v13 offset:23296
    v_cvt_pk_bf16_f32 v24, v24, v25
    v_cvt_pk_bf16_f32 v25, v26, v27
    v_mfma_f32_16x16x32_bf16 v[152:155], a[248:251], v[100:103], v[152:155]
    ds_read_b64_tr_b16 a[244:245], v13 offset:18720
    v_mfma_f32_16x16x32_bf16 v[148:151], a[252:255], v[96:99], v[148:151]
    ds_read_b64_tr_b16 a[246:247], v13 offset:23328
    v_cvt_pk_bf16_f32 v26, v28, v29
    v_cvt_pk_bf16_f32 v27, v30, v31
    v_mfma_f32_16x16x32_bf16 v[156:159], a[252:255], v[100:103], v[156:159]
    ds_read_b64_tr_b16 a[248:249], v13 offset:18752
    s_waitcnt lgkmcnt(9)
    v_mfma_f32_16x16x32_bf16 v[160:163], a[224:227], v[96:99], v[160:163]
    ds_read_b64_tr_b16 a[250:251], v13 offset:23360
    s_mov_b32 s33, 3072
    buffer_store_dwordx4 v[24:27], v19, s[20:23], s33 offen sc0 sc1
    v_mfma_f32_16x16x32_bf16 v[168:171], a[224:227], v[100:103], v[168:171]
    ds_read_b64_tr_b16 a[252:253], v13 offset:27712
    v_mfma_f32_16x16x32_bf16 v[164:167], a[228:231], v[96:99], v[164:167]
    ds_read_b64_tr_b16 a[254:255], v13 offset:32320
    v_accvgpr_read_b32 v24, a160
    v_accvgpr_read_b32 v25, a161
    v_mfma_f32_16x16x32_bf16 v[172:175], a[228:231], v[100:103], v[172:175]
    ds_read_b64_tr_b16 a[224:225], v13 offset:27744
    s_waitcnt lgkmcnt(9)
    v_mfma_f32_16x16x32_bf16 v[176:179], a[232:235], v[96:99], v[176:179]
    ds_read_b64_tr_b16 a[226:227], v13 offset:32352
    v_accvgpr_read_b32 v26, a162
    v_accvgpr_read_b32 v27, a163
    v_mfma_f32_16x16x32_bf16 v[184:187], a[232:235], v[100:103], v[184:187]
    ds_read_b64_tr_b16 a[228:229], v13 offset:27776
    v_mfma_f32_16x16x32_bf16 v[180:183], a[236:239], v[96:99], v[180:183]
    ds_read_b64_tr_b16 a[230:231], v13 offset:32384
    v_accvgpr_read_b32 v28, a164
    v_accvgpr_read_b32 v29, a165
    v_mfma_f32_16x16x32_bf16 v[188:191], a[236:239], v[100:103], v[188:191]
    ds_read_b64_tr_b16 a[232:233], v13 offset:27808
    s_waitcnt lgkmcnt(9)
    v_mfma_f32_16x16x32_bf16 v[192:195], a[240:243], v[96:99], v[192:195]
    ds_read_b64_tr_b16 a[234:235], v13 offset:32416
    v_accvgpr_read_b32 v30, a166
    v_accvgpr_read_b32 v31, a167
    v_mfma_f32_16x16x32_bf16 v[200:203], a[240:243], v[100:103], v[200:203]
    ds_read_b64_tr_b16 a[236:237], v13 offset:27840
    v_mfma_f32_16x16x32_bf16 v[196:199], a[244:247], v[96:99], v[196:199]
    ds_read_b64_tr_b16 a[238:239], v13 offset:32448
    v_cvt_pk_bf16_f32 v24, v24, v25
    v_cvt_pk_bf16_f32 v25, v26, v27
    v_mfma_f32_16x16x32_bf16 v[204:207], a[244:247], v[100:103], v[204:207]
    ds_read_b64_tr_b16 a[240:241], v13 offset:27872
    s_waitcnt lgkmcnt(9)
    v_mfma_f32_16x16x32_bf16 v[208:211], a[248:251], v[96:99], v[208:211]
    ds_read_b64_tr_b16 a[242:243], v13 offset:32480
    v_cvt_pk_bf16_f32 v26, v28, v29
    v_cvt_pk_bf16_f32 v27, v30, v31
    v_mfma_f32_16x16x32_bf16 v[216:219], a[248:251], v[100:103], v[216:219]
    ds_read_b64_tr_b16 a[244:245], v13 offset:27904
    v_mfma_f32_16x16x32_bf16 v[144:147], a[252:255], v[104:107], v[144:147]
    ds_read_b64_tr_b16 a[246:247], v13 offset:32512
    s_mov_b32 s33, 4096
    buffer_store_dwordx4 v[24:27], v18, s[20:23], s33 offen sc0 sc1
    v_mfma_f32_16x16x32_bf16 v[152:155], a[252:255], v[108:111], v[152:155]
    ds_read_b64_tr_b16 a[248:249], v13 offset:27936
    s_waitcnt lgkmcnt(9)
    v_mfma_f32_16x16x32_bf16 v[148:151], a[224:227], v[104:107], v[148:151]
    ds_read_b64_tr_b16 a[250:251], v13 offset:32544
    v_accvgpr_read_b32 v24, a168
    v_accvgpr_read_b32 v25, a169
    v_mfma_f32_16x16x32_bf16 v[156:159], a[224:227], v[108:111], v[156:159]
    ds_read_b64_tr_b16 a[252:253], v13 offset:27968
    v_mfma_f32_16x16x32_bf16 v[160:163], a[228:231], v[104:107], v[160:163]
    ds_read_b64_tr_b16 a[254:255], v13 offset:32576
    v_accvgpr_read_b32 v26, a170
    v_accvgpr_read_b32 v27, a171
    v_mfma_f32_16x16x32_bf16 v[168:171], a[228:231], v[108:111], v[168:171]
    s_waitcnt vmcnt(34)
    s_barrier
    v_add_u32 v12, s54, v12
    v_add_u32 v13, s54, v13
    s_sub_u32 s54, 0, s54
    ds_read_b64_tr_b16 a[224:225], v12 offset:0
    s_waitcnt lgkmcnt(9)
    v_mfma_f32_16x16x32_bf16 v[164:167], a[232:235], v[104:107], v[164:167]
    ds_read_b64_tr_b16 a[226:227], v12 offset:4608
    v_accvgpr_read_b32 v28, a172
    v_accvgpr_read_b32 v29, a173
    v_mfma_f32_16x16x32_bf16 v[172:175], a[232:235], v[108:111], v[172:175]
    ds_read_b64_tr_b16 a[228:229], v12 offset:32
    v_mfma_f32_16x16x32_bf16 v[176:179], a[236:239], v[104:107], v[176:179]
    ds_read_b64_tr_b16 a[230:231], v12 offset:4640
    v_accvgpr_read_b32 v30, a174
    v_accvgpr_read_b32 v31, a175
    v_mfma_f32_16x16x32_bf16 v[184:187], a[236:239], v[108:111], v[184:187]
    ds_read_b64_tr_b16 a[232:233], v12 offset:64
    s_waitcnt lgkmcnt(9)
    v_mfma_f32_16x16x32_bf16 v[180:183], a[240:243], v[104:107], v[180:183]
    ds_read_b64_tr_b16 a[234:235], v12 offset:4672
    v_cvt_pk_bf16_f32 v24, v24, v25
    v_cvt_pk_bf16_f32 v25, v26, v27
    v_mfma_f32_16x16x32_bf16 v[188:191], a[240:243], v[108:111], v[188:191]
    ds_read_b64_tr_b16 a[236:237], v12 offset:96
    v_mfma_f32_16x16x32_bf16 v[192:195], a[244:247], v[104:107], v[192:195]
    ds_read_b64_tr_b16 a[238:239], v12 offset:4704
    v_cvt_pk_bf16_f32 v26, v28, v29
    v_cvt_pk_bf16_f32 v27, v30, v31
    v_mfma_f32_16x16x32_bf16 v[200:203], a[244:247], v[108:111], v[200:203]
    ds_read_b64_tr_b16 a[240:241], v12 offset:128
    s_waitcnt lgkmcnt(9)
    v_mfma_f32_16x16x32_bf16 v[196:199], a[248:251], v[104:107], v[196:199]
    ds_read_b64_tr_b16 a[242:243], v12 offset:4736
    s_mov_b32 s33, 4096
    buffer_store_dwordx4 v[24:27], v19, s[20:23], s33 offen sc0 sc1
    v_mfma_f32_16x16x32_bf16 v[204:207], a[248:251], v[108:111], v[204:207]
    ds_read_b64_tr_b16 a[244:245], v12 offset:160
    v_mfma_f32_16x16x32_bf16 v[208:211], a[252:255], v[104:107], v[208:211]
    ds_read_b64_tr_b16 a[246:247], v12 offset:4768
    v_accvgpr_read_b32 v24, a176
    v_accvgpr_read_b32 v25, a177
    v_mfma_f32_16x16x32_bf16 v[216:219], a[252:255], v[108:111], v[216:219]
    ds_read_b64_tr_b16 a[248:249], v12 offset:192
    s_waitcnt lgkmcnt(9)
    v_mfma_f32_16x16x32_bf16 v[144:147], a[224:227], v[112:115], v[144:147]
    ds_read_b64_tr_b16 a[250:251], v12 offset:4800
    v_accvgpr_read_b32 v26, a178
    v_accvgpr_read_b32 v27, a179
    v_mfma_f32_16x16x32_bf16 v[152:155], a[224:227], v[116:119], v[152:155]
    ds_read_b64_tr_b16 a[252:253], v12 offset:224
    v_mfma_f32_16x16x32_bf16 v[148:151], a[228:231], v[112:115], v[148:151]
    ds_read_b64_tr_b16 a[254:255], v12 offset:4832
    v_accvgpr_read_b32 v28, a180
    v_accvgpr_read_b32 v29, a181
    v_mfma_f32_16x16x32_bf16 v[156:159], a[228:231], v[116:119], v[156:159]
    ds_read_b64_tr_b16 a[224:225], v12 offset:256
    s_waitcnt lgkmcnt(9)
    v_mfma_f32_16x16x32_bf16 v[160:163], a[232:235], v[112:115], v[160:163]
    ds_read_b64_tr_b16 a[226:227], v12 offset:4864
    v_accvgpr_read_b32 v30, a182
    v_accvgpr_read_b32 v31, a183
    v_mfma_f32_16x16x32_bf16 v[168:171], a[232:235], v[116:119], v[168:171]
    ds_read_b64_tr_b16 a[228:229], v12 offset:9216
    v_mfma_f32_16x16x32_bf16 v[164:167], a[236:239], v[112:115], v[164:167]
    ds_read_b64_tr_b16 a[230:231], v12 offset:13824
    v_cvt_pk_bf16_f32 v24, v24, v25
    v_cvt_pk_bf16_f32 v25, v26, v27
    v_mfma_f32_16x16x32_bf16 v[172:175], a[236:239], v[116:119], v[172:175]
    ds_read_b64_tr_b16 a[232:233], v12 offset:9248
    s_waitcnt lgkmcnt(9)
    v_mfma_f32_16x16x32_bf16 v[176:179], a[240:243], v[112:115], v[176:179]
    ds_read_b64_tr_b16 a[234:235], v12 offset:13856
    v_cvt_pk_bf16_f32 v26, v28, v29
    v_cvt_pk_bf16_f32 v27, v30, v31
    v_mfma_f32_16x16x32_bf16 v[184:187], a[240:243], v[116:119], v[184:187]
    ds_read_b64_tr_b16 a[236:237], v12 offset:9280
    v_mfma_f32_16x16x32_bf16 v[180:183], a[244:247], v[112:115], v[180:183]
    ds_read_b64_tr_b16 a[238:239], v12 offset:13888
    s_mov_b32 s33, 5120
    buffer_store_dwordx4 v[24:27], v18, s[20:23], s33 offen sc0 sc1
    v_mfma_f32_16x16x32_bf16 v[188:191], a[244:247], v[116:119], v[188:191]
    ds_read_b64_tr_b16 a[240:241], v12 offset:9312
    s_waitcnt lgkmcnt(9)
    v_mfma_f32_16x16x32_bf16 v[192:195], a[248:251], v[112:115], v[192:195]
    ds_read_b64_tr_b16 a[242:243], v12 offset:13920
    v_accvgpr_read_b32 v24, a184
    v_accvgpr_read_b32 v25, a185
    v_mfma_f32_16x16x32_bf16 v[200:203], a[248:251], v[116:119], v[200:203]
    ds_read_b64_tr_b16 a[244:245], v12 offset:9344
    v_mfma_f32_16x16x32_bf16 v[196:199], a[252:255], v[112:115], v[196:199]
    ds_read_b64_tr_b16 a[246:247], v12 offset:13952
    v_accvgpr_read_b32 v26, a186
    v_accvgpr_read_b32 v27, a187
    v_mfma_f32_16x16x32_bf16 v[204:207], a[252:255], v[116:119], v[204:207]
    ds_read_b64_tr_b16 a[248:249], v12 offset:9376
    s_waitcnt lgkmcnt(9)
    v_mfma_f32_16x16x32_bf16 v[208:211], a[224:227], v[112:115], v[208:211]
    ds_read_b64_tr_b16 a[250:251], v12 offset:13984
    v_accvgpr_read_b32 v28, a188
    v_accvgpr_read_b32 v29, a189
    v_mfma_f32_16x16x32_bf16 v[216:219], a[224:227], v[116:119], v[216:219]
    ds_read_b64_tr_b16 a[252:253], v12 offset:9408
    v_mfma_f32_16x16x32_bf16 v[144:147], a[228:231], v[120:123], v[144:147]
    ds_read_b64_tr_b16 a[254:255], v12 offset:14016
    v_accvgpr_read_b32 v30, a190
    v_accvgpr_read_b32 v31, a191
    v_mfma_f32_16x16x32_bf16 v[152:155], a[228:231], v[124:127], v[152:155]
    ds_read_b64_tr_b16 a[224:225], v12 offset:9440
    s_waitcnt lgkmcnt(9)
    v_mfma_f32_16x16x32_bf16 v[148:151], a[232:235], v[120:123], v[148:151]
    ds_read_b64_tr_b16 a[226:227], v12 offset:14048
    v_cvt_pk_bf16_f32 v24, v24, v25
    v_cvt_pk_bf16_f32 v25, v26, v27
    v_mfma_f32_16x16x32_bf16 v[156:159], a[232:235], v[124:127], v[156:159]
    ds_read_b64_tr_b16 a[228:229], v12 offset:9472
    v_mfma_f32_16x16x32_bf16 v[160:163], a[236:239], v[120:123], v[160:163]
    ds_read_b64_tr_b16 a[230:231], v12 offset:14080
    v_cvt_pk_bf16_f32 v26, v28, v29
    v_cvt_pk_bf16_f32 v27, v30, v31
    v_mfma_f32_16x16x32_bf16 v[168:171], a[236:239], v[124:127], v[168:171]
    s_waitcnt vmcnt(31)
    s_barrier
    ds_read_b64_tr_b16 a[232:233], v12 offset:18496
    s_waitcnt lgkmcnt(9)
    v_mfma_f32_16x16x32_bf16 v[164:167], a[240:243], v[120:123], v[164:167]
    ds_read_b64_tr_b16 a[234:235], v12 offset:23104
    s_mov_b32 s33, 5120
    buffer_store_dwordx4 v[24:27], v19, s[20:23], s33 offen sc0 sc1
    v_mfma_f32_16x16x32_bf16 v[172:175], a[240:243], v[124:127], v[172:175]
    ds_read_b64_tr_b16 a[236:237], v12 offset:18528
    v_mfma_f32_16x16x32_bf16 v[176:179], a[244:247], v[120:123], v[176:179]
    ds_read_b64_tr_b16 a[238:239], v12 offset:23136
    v_accvgpr_read_b32 v24, a192
    v_accvgpr_read_b32 v25, a193
    v_mfma_f32_16x16x32_bf16 v[184:187], a[244:247], v[124:127], v[184:187]
    ds_read_b64_tr_b16 a[240:241], v12 offset:18560
    s_waitcnt lgkmcnt(9)
    v_mfma_f32_16x16x32_bf16 v[180:183], a[248:251], v[120:123], v[180:183]
    ds_read_b64_tr_b16 a[242:243], v12 offset:23168
    v_accvgpr_read_b32 v26, a194
    v_accvgpr_read_b32 v27, a195
    v_mfma_f32_16x16x32_bf16 v[188:191], a[248:251], v[124:127], v[188:191]
    ds_read_b64_tr_b16 a[244:245], v12 offset:18592
    v_mfma_f32_16x16x32_bf16 v[192:195], a[252:255], v[120:123], v[192:195]
    ds_read_b64_tr_b16 a[246:247], v12 offset:23200
    v_accvgpr_read_b32 v28, a196
    v_accvgpr_read_b32 v29, a197
    v_mfma_f32_16x16x32_bf16 v[200:203], a[252:255], v[124:127], v[200:203]
    ds_read_b64_tr_b16 a[248:249], v12 offset:18624
    s_waitcnt lgkmcnt(9)
    v_mfma_f32_16x16x32_bf16 v[196:199], a[224:227], v[120:123], v[196:199]
    ds_read_b64_tr_b16 a[250:251], v12 offset:23232
    v_accvgpr_read_b32 v30, a198
    v_accvgpr_read_b32 v31, a199
    v_mfma_f32_16x16x32_bf16 v[204:207], a[224:227], v[124:127], v[204:207]
    ds_read_b64_tr_b16 a[252:253], v12 offset:18656
    v_mfma_f32_16x16x32_bf16 v[208:211], a[228:231], v[120:123], v[208:211]
    ds_read_b64_tr_b16 a[254:255], v12 offset:23264
    v_cvt_pk_bf16_f32 v24, v24, v25
    v_cvt_pk_bf16_f32 v25, v26, v27
    v_mfma_f32_16x16x32_bf16 v[216:219], a[228:231], v[124:127], v[216:219]
    ds_read_b64_tr_b16 a[224:225], v12 offset:18688
    s_waitcnt lgkmcnt(9)
    v_mfma_f32_16x16x32_bf16 v[144:147], a[232:235], v[128:131], v[144:147]
    ds_read_b64_tr_b16 a[226:227], v12 offset:23296
    v_cvt_pk_bf16_f32 v26, v28, v29
    v_cvt_pk_bf16_f32 v27, v30, v31
    v_mfma_f32_16x16x32_bf16 v[152:155], a[232:235], v[132:135], v[152:155]
    ds_read_b64_tr_b16 a[228:229], v12 offset:18720
    v_mfma_f32_16x16x32_bf16 v[148:151], a[236:239], v[128:131], v[148:151]
    ds_read_b64_tr_b16 a[230:231], v12 offset:23328
    s_mov_b32 s33, 6144
    buffer_store_dwordx4 v[24:27], v18, s[20:23], s33 offen sc0 sc1
    v_mfma_f32_16x16x32_bf16 v[156:159], a[236:239], v[132:135], v[156:159]
    ds_read_b64_tr_b16 a[232:233], v12 offset:18752
    s_waitcnt lgkmcnt(9)
    v_mfma_f32_16x16x32_bf16 v[160:163], a[240:243], v[128:131], v[160:163]
    ds_read_b64_tr_b16 a[234:235], v12 offset:23360
    v_accvgpr_read_b32 v24, a200
    v_accvgpr_read_b32 v25, a201
    v_mfma_f32_16x16x32_bf16 v[168:171], a[240:243], v[132:135], v[168:171]
    ds_read_b64_tr_b16 a[236:237], v12 offset:27712
    v_mfma_f32_16x16x32_bf16 v[164:167], a[244:247], v[128:131], v[164:167]
    ds_read_b64_tr_b16 a[238:239], v12 offset:32320
    v_accvgpr_read_b32 v26, a202
    v_accvgpr_read_b32 v27, a203
    v_mfma_f32_16x16x32_bf16 v[172:175], a[244:247], v[132:135], v[172:175]
    ds_read_b64_tr_b16 a[240:241], v12 offset:27744
    s_waitcnt lgkmcnt(9)
    v_mfma_f32_16x16x32_bf16 v[176:179], a[248:251], v[128:131], v[176:179]
    ds_read_b64_tr_b16 a[242:243], v12 offset:32352
    v_accvgpr_read_b32 v28, a204
    v_accvgpr_read_b32 v29, a205
    v_mfma_f32_16x16x32_bf16 v[184:187], a[248:251], v[132:135], v[184:187]
    ds_read_b64_tr_b16 a[244:245], v12 offset:27776
    v_mfma_f32_16x16x32_bf16 v[180:183], a[252:255], v[128:131], v[180:183]
    ds_read_b64_tr_b16 a[246:247], v12 offset:32384
    v_accvgpr_read_b32 v30, a206
    v_accvgpr_read_b32 v31, a207
    v_mfma_f32_16x16x32_bf16 v[188:191], a[252:255], v[132:135], v[188:191]
    v_cvt_pk_bf16_f32 v24, v24, v25
    v_cvt_pk_bf16_f32 v25, v26, v27
    v_cvt_pk_bf16_f32 v26, v28, v29
    v_cvt_pk_bf16_f32 v27, v30, v31
    s_mov_b32 s33, 6144
    buffer_store_dwordx4 v[24:27], v19, s[20:23], s33 offen sc0 sc1
    ds_read_b64_tr_b16 a[248:249], v12 offset:27808
    s_waitcnt lgkmcnt(9)
    v_mfma_f32_16x16x32_bf16 v[192:195], a[224:227], v[128:131], v[192:195]
    ds_read_b64_tr_b16 a[250:251], v12 offset:32416
    v_accvgpr_read_b32 v24, a208
    v_accvgpr_read_b32 v25, a209
    v_mfma_f32_16x16x32_bf16 v[200:203], a[224:227], v[132:135], v[200:203]
    v_accvgpr_read_b32 v26, a210
    v_accvgpr_read_b32 v27, a211
    v_accvgpr_read_b32 v28, a212
    v_accvgpr_read_b32 v29, a213
    v_accvgpr_read_b32 v30, a214
    v_accvgpr_read_b32 v31, a215
    v_cvt_pk_bf16_f32 v24, v24, v25
    v_cvt_pk_bf16_f32 v25, v26, v27
    v_cvt_pk_bf16_f32 v26, v28, v29
    v_cvt_pk_bf16_f32 v27, v30, v31
    s_mov_b32 s33, 7168
    buffer_store_dwordx4 v[24:27], v18, s[20:23], s33 offen sc0 sc1
    s_nop 1
    v_accvgpr_read_b32 v24, a216
    v_accvgpr_read_b32 v25, a217
    v_accvgpr_read_b32 v26, a218
    v_accvgpr_read_b32 v27, a219
    v_accvgpr_read_b32 v28, a220
    v_accvgpr_read_b32 v29, a221
    v_accvgpr_read_b32 v30, a222
    v_accvgpr_read_b32 v31, a223
    v_cvt_pk_bf16_f32 v24, v24, v25
    v_cvt_pk_bf16_f32 v25, v26, v27
    v_cvt_pk_bf16_f32 v26, v28, v29
    v_cvt_pk_bf16_f32 v27, v30, v31
    s_mov_b32 s33, 7168
    buffer_store_dwordx4 v[24:27], v19, s[20:23], s33 offen sc0 sc1
    ds_read_b64_tr_b16 a[252:253], v12 offset:27840
    v_mfma_f32_16x16x32_bf16 v[196:199], a[228:231], v[128:131], v[196:199]
    ds_read_b64_tr_b16 a[254:255], v12 offset:32448
    v_cvt_pk_bf16_f32 v32, v32, v33
    v_cvt_pk_bf16_f32 v33, v34, v35
    v_mfma_f32_16x16x32_bf16 v[204:207], a[228:231], v[132:135], v[204:207]
    v_cvt_pk_bf16_f32 v34, v36, v37
    v_cvt_pk_bf16_f32 v35, v38, v39
    s_mov_b32 s33, 8192
    buffer_store_dwordx4 v[32:35], v18, s[20:23], s33 offen sc0 sc1
    v_cvt_pk_bf16_f32 v40, v40, v41
    v_cvt_pk_bf16_f32 v41, v42, v43
    v_cvt_pk_bf16_f32 v42, v44, v45
    v_cvt_pk_bf16_f32 v43, v46, v47
    s_mov_b32 s33, 8192
    buffer_store_dwordx4 v[40:43], v19, s[20:23], s33 offen sc0 sc1
    ds_read_b64_tr_b16 a[224:225], v12 offset:27872
    s_waitcnt lgkmcnt(9)
    v_mfma_f32_16x16x32_bf16 v[208:211], a[232:235], v[128:131], v[208:211]
    ds_read_b64_tr_b16 a[226:227], v12 offset:32480
    v_cvt_pk_bf16_f32 v144, v144, v145
    v_cvt_pk_bf16_f32 v145, v146, v147
    v_mfma_f32_16x16x32_bf16 v[216:219], a[232:235], v[132:135], v[216:219]
    ds_read_b64_tr_b16 a[228:229], v12 offset:27904
    v_mfma_f32_16x16x32_bf16 v[212:215], a[236:239], v[64:67], 0
    ds_read_b64_tr_b16 a[230:231], v12 offset:32512
    v_cvt_pk_bf16_f32 v146, v148, v149
    v_cvt_pk_bf16_f32 v147, v150, v151
    v_mfma_f32_16x16x32_bf16 v[220:223], a[236:239], v[68:71], 0
    ds_read_b64_tr_b16 a[232:233], v12 offset:27936
    s_waitcnt lgkmcnt(9)
    v_mfma_f32_16x16x32_bf16 v[224:227], a[240:243], v[64:67], 0
    ds_read_b64_tr_b16 a[234:235], v12 offset:32544
    s_mov_b32 s33, 9216
    buffer_store_dwordx4 v[144:147], v18, s[20:23], s33 offen sc0 sc1
    v_mfma_f32_16x16x32_bf16 v[232:235], a[240:243], v[68:71], 0
    ds_read_b64_tr_b16 a[236:237], v12 offset:27968
    v_mfma_f32_16x16x32_bf16 v[228:231], a[244:247], v[64:67], 0
    ds_read_b64_tr_b16 a[238:239], v12 offset:32576
    v_cvt_pk_bf16_f32 v152, v152, v153
    v_cvt_pk_bf16_f32 v153, v154, v155
    v_mfma_f32_16x16x32_bf16 v[236:239], a[244:247], v[68:71], 0
    s_waitcnt vmcnt(34)
    s_barrier
    ds_read_b64_tr_b16 a[240:241], v13 offset:0
    s_waitcnt lgkmcnt(9)
    v_mfma_f32_16x16x32_bf16 v[240:243], a[248:251], v[64:67], 0
    ds_read_b64_tr_b16 a[242:243], v13 offset:4608
    v_cvt_pk_bf16_f32 v154, v156, v157
    v_cvt_pk_bf16_f32 v155, v158, v159
    v_mfma_f32_16x16x32_bf16 v[248:251], a[248:251], v[68:71], 0
    ds_read_b64_tr_b16 a[244:245], v13 offset:32
    v_mfma_f32_16x16x32_bf16 v[244:247], a[252:255], v[64:67], 0
    ds_read_b64_tr_b16 a[246:247], v13 offset:4640
    s_mov_b32 s33, 9216
    buffer_store_dwordx4 v[152:155], v19, s[20:23], s33 offen sc0 sc1
    v_mfma_f32_16x16x32_bf16 v[252:255], a[252:255], v[68:71], 0
    ds_read_b64_tr_b16 a[248:249], v13 offset:64
    s_waitcnt lgkmcnt(9)
    v_mfma_f32_16x16x32_bf16 v[48:51], a[224:227], v[64:67], 0
    ds_read_b64_tr_b16 a[250:251], v13 offset:4672
    v_cvt_pk_bf16_f32 v160, v160, v161
    v_cvt_pk_bf16_f32 v161, v162, v163
    v_mfma_f32_16x16x32_bf16 v[56:59], a[224:227], v[68:71], 0
    ds_read_b64_tr_b16 a[252:253], v13 offset:96
    v_mfma_f32_16x16x32_bf16 v[52:55], a[228:231], v[64:67], 0
    ds_read_b64_tr_b16 a[254:255], v13 offset:4704
    v_cvt_pk_bf16_f32 v162, v164, v165
    v_cvt_pk_bf16_f32 v163, v166, v167
    v_mfma_f32_16x16x32_bf16 v[60:63], a[228:231], v[68:71], 0
    ds_read_b64_tr_b16 a[224:225], v13 offset:128
    s_waitcnt lgkmcnt(9)
    v_mfma_f32_16x16x32_bf16 a[0:3], a[232:235], v[64:67], 0
    ds_read_b64_tr_b16 a[226:227], v13 offset:4736
    s_mov_b32 s33, 10240
    buffer_store_dwordx4 v[160:163], v18, s[20:23], s33 offen sc0 sc1
    v_mfma_f32_16x16x32_bf16 a[8:11], a[232:235], v[68:71], 0
    ds_read_b64_tr_b16 a[228:229], v13 offset:160
    v_mfma_f32_16x16x32_bf16 a[4:7], a[236:239], v[64:67], 0
    ds_read_b64_tr_b16 a[230:231], v13 offset:4768
    v_cvt_pk_bf16_f32 v168, v168, v169
    v_cvt_pk_bf16_f32 v169, v170, v171
    v_mfma_f32_16x16x32_bf16 a[12:15], a[236:239], v[68:71], 0
    ds_read_b64_tr_b16 a[232:233], v13 offset:192
    s_waitcnt lgkmcnt(9)
    v_mfma_f32_16x16x32_bf16 v[212:215], a[240:243], v[72:75], v[212:215]
    ds_read_b64_tr_b16 a[234:235], v13 offset:4800
    v_cvt_pk_bf16_f32 v170, v172, v173
    v_cvt_pk_bf16_f32 v171, v174, v175
    v_mfma_f32_16x16x32_bf16 v[220:223], a[240:243], v[76:79], v[220:223]
    ds_read_b64_tr_b16 a[236:237], v13 offset:224
    v_mfma_f32_16x16x32_bf16 v[224:227], a[244:247], v[72:75], v[224:227]
    ds_read_b64_tr_b16 a[238:239], v13 offset:4832
    s_mov_b32 s33, 10240
    buffer_store_dwordx4 v[168:171], v19, s[20:23], s33 offen sc0 sc1
    v_mfma_f32_16x16x32_bf16 v[232:235], a[244:247], v[76:79], v[232:235]
    ds_read_b64_tr_b16 a[240:241], v13 offset:256
    s_waitcnt lgkmcnt(9)
    v_mfma_f32_16x16x32_bf16 v[228:231], a[248:251], v[72:75], v[228:231]
    ds_read_b64_tr_b16 a[242:243], v13 offset:4864
    v_cvt_pk_bf16_f32 v176, v176, v177
    v_cvt_pk_bf16_f32 v177, v178, v179
    v_mfma_f32_16x16x32_bf16 v[236:239], a[248:251], v[76:79], v[236:239]
    ds_read_b64_tr_b16 a[244:245], v13 offset:9216
    v_mfma_f32_16x16x32_bf16 v[240:243], a[252:255], v[72:75], v[240:243]
    ds_read_b64_tr_b16 a[246:247], v13 offset:13824
    v_cvt_pk_bf16_f32 v178, v180, v181
    v_cvt_pk_bf16_f32 v179, v182, v183
    v_mfma_f32_16x16x32_bf16 v[248:251], a[252:255], v[76:79], v[248:251]
    ds_read_b64_tr_b16 a[248:249], v13 offset:9248
    s_waitcnt lgkmcnt(9)
    v_mfma_f32_16x16x32_bf16 v[244:247], a[224:227], v[72:75], v[244:247]
    ds_read_b64_tr_b16 a[250:251], v13 offset:13856
    s_mov_b32 s33, 11264
    buffer_store_dwordx4 v[176:179], v18, s[20:23], s33 offen sc0 sc1
    v_mfma_f32_16x16x32_bf16 v[252:255], a[224:227], v[76:79], v[252:255]
    ds_read_b64_tr_b16 a[252:253], v13 offset:9280
    v_mfma_f32_16x16x32_bf16 v[48:51], a[228:231], v[72:75], v[48:51]
    ds_read_b64_tr_b16 a[254:255], v13 offset:13888
    v_cvt_pk_bf16_f32 v184, v184, v185
    v_cvt_pk_bf16_f32 v185, v186, v187
    v_mfma_f32_16x16x32_bf16 v[56:59], a[228:231], v[76:79], v[56:59]
    ds_read_b64_tr_b16 a[224:225], v13 offset:9312
    s_waitcnt lgkmcnt(9)
    v_mfma_f32_16x16x32_bf16 v[52:55], a[232:235], v[72:75], v[52:55]
    ds_read_b64_tr_b16 a[226:227], v13 offset:13920
    v_cvt_pk_bf16_f32 v186, v188, v189
    v_cvt_pk_bf16_f32 v187, v190, v191
    v_mfma_f32_16x16x32_bf16 v[60:63], a[232:235], v[76:79], v[60:63]
    ds_read_b64_tr_b16 a[228:229], v13 offset:9344
    v_mfma_f32_16x16x32_bf16 a[0:3], a[236:239], v[72:75], a[0:3]
    ds_read_b64_tr_b16 a[230:231], v13 offset:13952
    s_mov_b32 s33, 11264
    buffer_store_dwordx4 v[184:187], v19, s[20:23], s33 offen sc0 sc1
    v_mfma_f32_16x16x32_bf16 a[8:11], a[236:239], v[76:79], a[8:11]
    ds_read_b64_tr_b16 a[232:233], v13 offset:9376
    s_waitcnt lgkmcnt(9)
    v_mfma_f32_16x16x32_bf16 a[4:7], a[240:243], v[72:75], a[4:7]
    ds_read_b64_tr_b16 a[234:235], v13 offset:13984
    v_cvt_pk_bf16_f32 v192, v192, v193
    v_cvt_pk_bf16_f32 v193, v194, v195
    v_mfma_f32_16x16x32_bf16 a[12:15], a[240:243], v[76:79], a[12:15]
    ds_read_b64_tr_b16 a[236:237], v13 offset:9408
    v_mfma_f32_16x16x32_bf16 v[212:215], a[244:247], v[80:83], v[212:215]
    ds_read_b64_tr_b16 a[238:239], v13 offset:14016
    v_cvt_pk_bf16_f32 v194, v196, v197
    v_cvt_pk_bf16_f32 v195, v198, v199
    v_mfma_f32_16x16x32_bf16 v[220:223], a[244:247], v[84:87], v[220:223]
    ds_read_b64_tr_b16 a[240:241], v13 offset:9440
    s_waitcnt lgkmcnt(9)
    v_mfma_f32_16x16x32_bf16 v[224:227], a[248:251], v[80:83], v[224:227]
    ds_read_b64_tr_b16 a[242:243], v13 offset:14048
    s_mov_b32 s33, 12288
    buffer_store_dwordx4 v[192:195], v18, s[20:23], s33 offen sc0 sc1
    v_mfma_f32_16x16x32_bf16 v[232:235], a[248:251], v[84:87], v[232:235]
    ds_read_b64_tr_b16 a[244:245], v13 offset:9472
    v_mfma_f32_16x16x32_bf16 v[228:231], a[252:255], v[80:83], v[228:231]
    ds_read_b64_tr_b16 a[246:247], v13 offset:14080
    v_cvt_pk_bf16_f32 v200, v200, v201
    v_cvt_pk_bf16_f32 v201, v202, v203
    v_mfma_f32_16x16x32_bf16 v[236:239], a[252:255], v[84:87], v[236:239]
    s_waitcnt vmcnt(32)
    s_barrier
    ds_read_b64_tr_b16 a[248:249], v13 offset:18496
    s_waitcnt lgkmcnt(9)
    v_mfma_f32_16x16x32_bf16 v[240:243], a[224:227], v[80:83], v[240:243]
    ds_read_b64_tr_b16 a[250:251], v13 offset:23104
    v_cvt_pk_bf16_f32 v202, v204, v205
    v_cvt_pk_bf16_f32 v203, v206, v207
    v_mfma_f32_16x16x32_bf16 v[248:251], a[224:227], v[84:87], v[248:251]
    ds_read_b64_tr_b16 a[252:253], v13 offset:18528
    v_mfma_f32_16x16x32_bf16 v[244:247], a[228:231], v[80:83], v[244:247]
    ds_read_b64_tr_b16 a[254:255], v13 offset:23136
    s_mov_b32 s33, 12288
    buffer_store_dwordx4 v[200:203], v19, s[20:23], s33 offen sc0 sc1
    v_mfma_f32_16x16x32_bf16 v[252:255], a[228:231], v[84:87], v[252:255]
    ds_read_b64_tr_b16 a[224:225], v13 offset:18560
    s_waitcnt lgkmcnt(9)
    v_mfma_f32_16x16x32_bf16 v[48:51], a[232:235], v[80:83], v[48:51]
    ds_read_b64_tr_b16 a[226:227], v13 offset:23168
    v_mfma_f32_16x16x32_bf16 v[56:59], a[232:235], v[84:87], v[56:59]
    ds_read_b64_tr_b16 a[228:229], v13 offset:18592
    v_mfma_f32_16x16x32_bf16 v[52:55], a[236:239], v[80:83], v[52:55]
    ds_read_b64_tr_b16 a[230:231], v13 offset:23200
    v_mfma_f32_16x16x32_bf16 v[60:63], a[236:239], v[84:87], v[60:63]
    ds_read_b64_tr_b16 a[232:233], v13 offset:18624
    s_waitcnt lgkmcnt(9)
    v_mfma_f32_16x16x32_bf16 a[0:3], a[240:243], v[80:83], a[0:3]
    ds_read_b64_tr_b16 a[234:235], v13 offset:23232
    v_mfma_f32_16x16x32_bf16 a[8:11], a[240:243], v[84:87], a[8:11]
    ds_read_b64_tr_b16 a[236:237], v13 offset:18656
    v_mfma_f32_16x16x32_bf16 a[4:7], a[244:247], v[80:83], a[4:7]
    ds_read_b64_tr_b16 a[238:239], v13 offset:23264
    v_mfma_f32_16x16x32_bf16 a[12:15], a[244:247], v[84:87], a[12:15]
    ds_read_b64_tr_b16 a[240:241], v13 offset:18688
    s_waitcnt lgkmcnt(9)
    v_mfma_f32_16x16x32_bf16 v[212:215], a[248:251], v[88:91], v[212:215]
    ds_read_b64_tr_b16 a[242:243], v13 offset:23296
    v_mfma_f32_16x16x32_bf16 v[220:223], a[248:251], v[92:95], v[220:223]
    ds_read_b64_tr_b16 a[244:245], v13 offset:18720
    v_mfma_f32_16x16x32_bf16 v[224:227], a[252:255], v[88:91], v[224:227]
    ds_read_b64_tr_b16 a[246:247], v13 offset:23328
    v_mfma_f32_16x16x32_bf16 v[232:235], a[252:255], v[92:95], v[232:235]
    ds_read_b64_tr_b16 a[248:249], v13 offset:18752
    s_waitcnt lgkmcnt(9)
    v_mfma_f32_16x16x32_bf16 v[228:231], a[224:227], v[88:91], v[228:231]
    ds_read_b64_tr_b16 a[250:251], v13 offset:23360
    v_mfma_f32_16x16x32_bf16 v[236:239], a[224:227], v[92:95], v[236:239]
    ds_read_b64_tr_b16 a[252:253], v13 offset:27712
    v_mfma_f32_16x16x32_bf16 v[240:243], a[228:231], v[88:91], v[240:243]
    ds_read_b64_tr_b16 a[254:255], v13 offset:32320
    v_mfma_f32_16x16x32_bf16 v[248:251], a[228:231], v[92:95], v[248:251]
    ds_read_b64_tr_b16 a[224:225], v13 offset:27744
    s_waitcnt lgkmcnt(9)
    v_mfma_f32_16x16x32_bf16 v[244:247], a[232:235], v[88:91], v[244:247]
    ds_read_b64_tr_b16 a[226:227], v13 offset:32352
    v_mfma_f32_16x16x32_bf16 v[252:255], a[232:235], v[92:95], v[252:255]
    ds_read_b64_tr_b16 a[228:229], v13 offset:27776
    v_mfma_f32_16x16x32_bf16 v[48:51], a[236:239], v[88:91], v[48:51]
    ds_read_b64_tr_b16 a[230:231], v13 offset:32384
    v_mfma_f32_16x16x32_bf16 v[56:59], a[236:239], v[92:95], v[56:59]
    ds_read_b64_tr_b16 a[232:233], v13 offset:27808
    s_waitcnt lgkmcnt(9)
    v_mfma_f32_16x16x32_bf16 v[52:55], a[240:243], v[88:91], v[52:55]
    ds_read_b64_tr_b16 a[234:235], v13 offset:32416
    v_mfma_f32_16x16x32_bf16 v[60:63], a[240:243], v[92:95], v[60:63]
    ds_read_b64_tr_b16 a[236:237], v13 offset:27840
    v_mfma_f32_16x16x32_bf16 a[0:3], a[244:247], v[88:91], a[0:3]
    ds_read_b64_tr_b16 a[238:239], v13 offset:32448
    v_mfma_f32_16x16x32_bf16 a[8:11], a[244:247], v[92:95], a[8:11]
    ds_read_b64_tr_b16 a[240:241], v13 offset:27872
    s_waitcnt lgkmcnt(9)
    v_mfma_f32_16x16x32_bf16 a[4:7], a[248:251], v[88:91], a[4:7]
    ds_read_b64_tr_b16 a[242:243], v13 offset:32480
    v_mfma_f32_16x16x32_bf16 a[12:15], a[248:251], v[92:95], a[12:15]
    ds_read_b64_tr_b16 a[244:245], v13 offset:27904
    v_mfma_f32_16x16x32_bf16 v[212:215], a[252:255], v[96:99], v[212:215]
    ds_read_b64_tr_b16 a[246:247], v13 offset:32512
    v_mfma_f32_16x16x32_bf16 v[220:223], a[252:255], v[100:103], v[220:223]
    ds_read_b64_tr_b16 a[248:249], v13 offset:27936
    s_waitcnt lgkmcnt(9)
    v_mfma_f32_16x16x32_bf16 v[224:227], a[224:227], v[96:99], v[224:227]
    ds_read_b64_tr_b16 a[250:251], v13 offset:32544
    v_mfma_f32_16x16x32_bf16 v[232:235], a[224:227], v[100:103], v[232:235]
    ds_read_b64_tr_b16 a[252:253], v13 offset:27968
    v_mfma_f32_16x16x32_bf16 v[228:231], a[228:231], v[96:99], v[228:231]
    ds_read_b64_tr_b16 a[254:255], v13 offset:32576
    v_mfma_f32_16x16x32_bf16 v[236:239], a[228:231], v[100:103], v[236:239]
    s_waitcnt vmcnt(26)
    s_barrier
    v_add_u32 v12, s54, v12
    v_add_u32 v13, s54, v13
    s_sub_u32 s54, 0, s54
    ds_read_b64_tr_b16 a[224:225], v12 offset:0
    s_waitcnt lgkmcnt(9)
    v_mfma_f32_16x16x32_bf16 v[240:243], a[232:235], v[96:99], v[240:243]
    ds_read_b64_tr_b16 a[226:227], v12 offset:4608
    v_mfma_f32_16x16x32_bf16 v[248:251], a[232:235], v[100:103], v[248:251]
    ds_read_b64_tr_b16 a[228:229], v12 offset:32
    v_mfma_f32_16x16x32_bf16 v[244:247], a[236:239], v[96:99], v[244:247]
    ds_read_b64_tr_b16 a[230:231], v12 offset:4640
    v_mfma_f32_16x16x32_bf16 v[252:255], a[236:239], v[100:103], v[252:255]
    ds_read_b64_tr_b16 a[232:233], v12 offset:64
    s_waitcnt lgkmcnt(9)
    v_mfma_f32_16x16x32_bf16 v[48:51], a[240:243], v[96:99], v[48:51]
    ds_read_b64_tr_b16 a[234:235], v12 offset:4672
    v_mfma_f32_16x16x32_bf16 v[56:59], a[240:243], v[100:103], v[56:59]
    ds_read_b64_tr_b16 a[236:237], v12 offset:96
    v_mfma_f32_16x16x32_bf16 v[52:55], a[244:247], v[96:99], v[52:55]
    ds_read_b64_tr_b16 a[238:239], v12 offset:4704
    v_mfma_f32_16x16x32_bf16 v[60:63], a[244:247], v[100:103], v[60:63]
    ds_read_b64_tr_b16 a[240:241], v12 offset:128
    s_waitcnt lgkmcnt(9)
    v_mfma_f32_16x16x32_bf16 a[0:3], a[248:251], v[96:99], a[0:3]
    ds_read_b64_tr_b16 a[242:243], v12 offset:4736
    v_mfma_f32_16x16x32_bf16 a[8:11], a[248:251], v[100:103], a[8:11]
    ds_read_b64_tr_b16 a[244:245], v12 offset:160
    v_mfma_f32_16x16x32_bf16 a[4:7], a[252:255], v[96:99], a[4:7]
    ds_read_b64_tr_b16 a[246:247], v12 offset:4768
    v_mfma_f32_16x16x32_bf16 a[12:15], a[252:255], v[100:103], a[12:15]
    ds_read_b64_tr_b16 a[248:249], v12 offset:192
    s_waitcnt lgkmcnt(9)
    v_mfma_f32_16x16x32_bf16 v[212:215], a[224:227], v[104:107], v[212:215]
    ds_read_b64_tr_b16 a[250:251], v12 offset:4800
    v_mfma_f32_16x16x32_bf16 v[220:223], a[224:227], v[108:111], v[220:223]
    ds_read_b64_tr_b16 a[252:253], v12 offset:224
    v_mfma_f32_16x16x32_bf16 v[224:227], a[228:231], v[104:107], v[224:227]
    ds_read_b64_tr_b16 a[254:255], v12 offset:4832
    v_mfma_f32_16x16x32_bf16 v[232:235], a[228:231], v[108:111], v[232:235]
    ds_read_b64_tr_b16 a[224:225], v12 offset:256
    s_waitcnt lgkmcnt(9)
    v_mfma_f32_16x16x32_bf16 v[228:231], a[232:235], v[104:107], v[228:231]
    ds_read_b64_tr_b16 a[226:227], v12 offset:4864
    v_mfma_f32_16x16x32_bf16 v[236:239], a[232:235], v[108:111], v[236:239]
    ds_read_b64_tr_b16 a[228:229], v12 offset:9216
    v_mfma_f32_16x16x32_bf16 v[240:243], a[236:239], v[104:107], v[240:243]
    ds_read_b64_tr_b16 a[230:231], v12 offset:13824
    v_mfma_f32_16x16x32_bf16 v[248:251], a[236:239], v[108:111], v[248:251]
    ds_read_b64_tr_b16 a[232:233], v12 offset:9248
    s_waitcnt lgkmcnt(9)
    v_mfma_f32_16x16x32_bf16 v[244:247], a[240:243], v[104:107], v[244:247]
    ds_read_b64_tr_b16 a[234:235], v12 offset:13856
    v_mfma_f32_16x16x32_bf16 v[252:255], a[240:243], v[108:111], v[252:255]
    ds_read_b64_tr_b16 a[236:237], v12 offset:9280
    v_mfma_f32_16x16x32_bf16 v[48:51], a[244:247], v[104:107], v[48:51]
    ds_read_b64_tr_b16 a[238:239], v12 offset:13888
    v_mfma_f32_16x16x32_bf16 v[56:59], a[244:247], v[108:111], v[56:59]
    ds_read_b64_tr_b16 a[240:241], v12 offset:9312
    s_waitcnt lgkmcnt(9)
    v_mfma_f32_16x16x32_bf16 v[52:55], a[248:251], v[104:107], v[52:55]
    ds_read_b64_tr_b16 a[242:243], v12 offset:13920
    v_mfma_f32_16x16x32_bf16 v[60:63], a[248:251], v[108:111], v[60:63]
    ds_read_b64_tr_b16 a[244:245], v12 offset:9344
    v_mfma_f32_16x16x32_bf16 a[0:3], a[252:255], v[104:107], a[0:3]
    ds_read_b64_tr_b16 a[246:247], v12 offset:13952
    v_mfma_f32_16x16x32_bf16 a[8:11], a[252:255], v[108:111], a[8:11]
    ds_read_b64_tr_b16 a[248:249], v12 offset:9376
    s_waitcnt lgkmcnt(9)
    v_mfma_f32_16x16x32_bf16 a[4:7], a[224:227], v[104:107], a[4:7]
    ds_read_b64_tr_b16 a[250:251], v12 offset:13984
    v_mfma_f32_16x16x32_bf16 a[12:15], a[224:227], v[108:111], a[12:15]
    ds_read_b64_tr_b16 a[252:253], v12 offset:9408
    v_mfma_f32_16x16x32_bf16 v[212:215], a[228:231], v[112:115], v[212:215]
    ds_read_b64_tr_b16 a[254:255], v12 offset:14016
    v_mfma_f32_16x16x32_bf16 v[220:223], a[228:231], v[116:119], v[220:223]
    ds_read_b64_tr_b16 a[224:225], v12 offset:9440
    s_waitcnt lgkmcnt(9)
    v_mfma_f32_16x16x32_bf16 v[224:227], a[232:235], v[112:115], v[224:227]
    ds_read_b64_tr_b16 a[226:227], v12 offset:14048
    v_mfma_f32_16x16x32_bf16 v[232:235], a[232:235], v[116:119], v[232:235]
    ds_read_b64_tr_b16 a[228:229], v12 offset:9472
    v_mfma_f32_16x16x32_bf16 v[228:231], a[236:239], v[112:115], v[228:231]
    ds_read_b64_tr_b16 a[230:231], v12 offset:14080
    v_mfma_f32_16x16x32_bf16 v[236:239], a[236:239], v[116:119], v[236:239]
    s_waitcnt vmcnt(19)
    s_barrier
    ds_read_b64_tr_b16 a[232:233], v12 offset:18496
    s_waitcnt lgkmcnt(9)
    v_mfma_f32_16x16x32_bf16 v[240:243], a[240:243], v[112:115], v[240:243]
    ds_read_b64_tr_b16 a[234:235], v12 offset:23104
    v_mfma_f32_16x16x32_bf16 v[248:251], a[240:243], v[116:119], v[248:251]
    ds_read_b64_tr_b16 a[236:237], v12 offset:18528
    v_mfma_f32_16x16x32_bf16 v[244:247], a[244:247], v[112:115], v[244:247]
    ds_read_b64_tr_b16 a[238:239], v12 offset:23136
    v_mfma_f32_16x16x32_bf16 v[252:255], a[244:247], v[116:119], v[252:255]
    ds_read_b64_tr_b16 a[240:241], v12 offset:18560
    s_waitcnt lgkmcnt(9)
    v_mfma_f32_16x16x32_bf16 v[48:51], a[248:251], v[112:115], v[48:51]
    ds_read_b64_tr_b16 a[242:243], v12 offset:23168
    v_mfma_f32_16x16x32_bf16 v[56:59], a[248:251], v[116:119], v[56:59]
    ds_read_b64_tr_b16 a[244:245], v12 offset:18592
    v_mfma_f32_16x16x32_bf16 v[52:55], a[252:255], v[112:115], v[52:55]
    ds_read_b64_tr_b16 a[246:247], v12 offset:23200
    v_mfma_f32_16x16x32_bf16 v[60:63], a[252:255], v[116:119], v[60:63]
    ds_read_b64_tr_b16 a[248:249], v12 offset:18624
    s_waitcnt lgkmcnt(9)
    v_mfma_f32_16x16x32_bf16 a[0:3], a[224:227], v[112:115], a[0:3]
    ds_read_b64_tr_b16 a[250:251], v12 offset:23232
    v_mfma_f32_16x16x32_bf16 a[8:11], a[224:227], v[116:119], a[8:11]
    ds_read_b64_tr_b16 a[252:253], v12 offset:18656
    v_mfma_f32_16x16x32_bf16 a[4:7], a[228:231], v[112:115], a[4:7]
    ds_read_b64_tr_b16 a[254:255], v12 offset:23264
    v_mfma_f32_16x16x32_bf16 a[12:15], a[228:231], v[116:119], a[12:15]
    ds_read_b64_tr_b16 a[224:225], v12 offset:18688
    s_waitcnt lgkmcnt(9)
    v_mfma_f32_16x16x32_bf16 v[212:215], a[232:235], v[120:123], v[212:215]
    ds_read_b64_tr_b16 a[226:227], v12 offset:23296
    v_mfma_f32_16x16x32_bf16 v[220:223], a[232:235], v[124:127], v[220:223]
    ds_read_b64_tr_b16 a[228:229], v12 offset:18720
    v_mfma_f32_16x16x32_bf16 v[224:227], a[236:239], v[120:123], v[224:227]
    ds_read_b64_tr_b16 a[230:231], v12 offset:23328
    v_mfma_f32_16x16x32_bf16 v[232:235], a[236:239], v[124:127], v[232:235]
    ds_read_b64_tr_b16 a[232:233], v12 offset:18752
    s_waitcnt lgkmcnt(9)
    v_mfma_f32_16x16x32_bf16 v[228:231], a[240:243], v[120:123], v[228:231]
    ds_read_b64_tr_b16 a[234:235], v12 offset:23360
    v_mfma_f32_16x16x32_bf16 v[236:239], a[240:243], v[124:127], v[236:239]
    ds_read_b64_tr_b16 a[236:237], v12 offset:27712
    v_mfma_f32_16x16x32_bf16 v[240:243], a[244:247], v[120:123], v[240:243]
    ds_read_b64_tr_b16 a[238:239], v12 offset:32320
    v_mfma_f32_16x16x32_bf16 v[248:251], a[244:247], v[124:127], v[248:251]
    ds_read_b64_tr_b16 a[240:241], v12 offset:27744
    s_waitcnt lgkmcnt(9)
    v_mfma_f32_16x16x32_bf16 v[244:247], a[248:251], v[120:123], v[244:247]
    ds_read_b64_tr_b16 a[242:243], v12 offset:32352
    v_mfma_f32_16x16x32_bf16 v[252:255], a[248:251], v[124:127], v[252:255]
    ds_read_b64_tr_b16 a[244:245], v12 offset:27776
    v_mfma_f32_16x16x32_bf16 v[48:51], a[252:255], v[120:123], v[48:51]
    ds_read_b64_tr_b16 a[246:247], v12 offset:32384
    v_mfma_f32_16x16x32_bf16 v[56:59], a[252:255], v[124:127], v[56:59]
    ds_read_b64_tr_b16 a[248:249], v12 offset:27808
    s_waitcnt lgkmcnt(9)
    v_mfma_f32_16x16x32_bf16 v[52:55], a[224:227], v[120:123], v[52:55]
    ds_read_b64_tr_b16 a[250:251], v12 offset:32416
    v_mfma_f32_16x16x32_bf16 v[60:63], a[224:227], v[124:127], v[60:63]
    ds_read_b64_tr_b16 a[252:253], v12 offset:27840
    v_mfma_f32_16x16x32_bf16 a[0:3], a[228:231], v[120:123], a[0:3]
    ds_read_b64_tr_b16 a[254:255], v12 offset:32448
    v_mfma_f32_16x16x32_bf16 a[8:11], a[228:231], v[124:127], a[8:11]
    ds_read_b64_tr_b16 a[224:225], v12 offset:27872
    s_waitcnt lgkmcnt(9)
    v_mfma_f32_16x16x32_bf16 a[4:7], a[232:235], v[120:123], a[4:7]
    ds_read_b64_tr_b16 a[226:227], v12 offset:32480
    v_mfma_f32_16x16x32_bf16 a[12:15], a[232:235], v[124:127], a[12:15]
    ds_read_b64_tr_b16 a[228:229], v12 offset:27904
    v_mfma_f32_16x16x32_bf16 v[212:215], a[236:239], v[128:131], v[212:215]
    ds_read_b64_tr_b16 a[230:231], v12 offset:32512
    v_mfma_f32_16x16x32_bf16 v[220:223], a[236:239], v[132:135], v[220:223]
    ds_read_b64_tr_b16 a[232:233], v12 offset:27936
    s_waitcnt lgkmcnt(9)
    v_mfma_f32_16x16x32_bf16 v[224:227], a[240:243], v[128:131], v[224:227]
    ds_read_b64_tr_b16 a[234:235], v12 offset:32544
    v_mfma_f32_16x16x32_bf16 v[232:235], a[240:243], v[132:135], v[232:235]
    ds_read_b64_tr_b16 a[236:237], v12 offset:27968
    v_mfma_f32_16x16x32_bf16 v[228:231], a[244:247], v[128:131], v[228:231]
    ds_read_b64_tr_b16 a[238:239], v12 offset:32576
    v_mfma_f32_16x16x32_bf16 v[236:239], a[244:247], v[132:135], v[236:239]
    s_waitcnt lgkmcnt(8)
    v_mfma_f32_16x16x32_bf16 v[240:243], a[248:251], v[128:131], v[240:243]
    v_cvt_pk_bf16_f32 v208, v208, v209
    v_cvt_pk_bf16_f32 v209, v210, v211
    v_cvt_pk_bf16_f32 v210, v212, v213
    v_cvt_pk_bf16_f32 v211, v214, v215
    v_mfma_f32_16x16x32_bf16 v[248:251], a[248:251], v[132:135], v[248:251]
    v_mfma_f32_16x16x32_bf16 v[244:247], a[252:255], v[128:131], v[244:247]
    s_mov_b32 s33, 13312
    buffer_store_dwordx4 v[208:211], v18, s[20:23], s33 offen sc0 sc1
    v_cvt_pk_bf16_f32 v216, v216, v217
    v_cvt_pk_bf16_f32 v217, v218, v219
    v_mfma_f32_16x16x32_bf16 v[252:255], a[252:255], v[132:135], v[252:255]
    s_waitcnt lgkmcnt(4)
    v_mfma_f32_16x16x32_bf16 v[48:51], a[224:227], v[128:131], v[48:51]
    v_cvt_pk_bf16_f32 v218, v220, v221
    v_cvt_pk_bf16_f32 v219, v222, v223
    s_mov_b32 s33, 13312
    buffer_store_dwordx4 v[216:219], v19, s[20:23], s33 offen sc0 sc1
    v_mfma_f32_16x16x32_bf16 v[56:59], a[224:227], v[132:135], v[56:59]
    v_mfma_f32_16x16x32_bf16 v[52:55], a[228:231], v[128:131], v[52:55]
    v_cvt_pk_bf16_f32 v224, v224, v225
    v_cvt_pk_bf16_f32 v225, v226, v227
    v_cvt_pk_bf16_f32 v226, v228, v229
    v_cvt_pk_bf16_f32 v227, v230, v231
    v_mfma_f32_16x16x32_bf16 v[60:63], a[228:231], v[132:135], v[60:63]
    s_waitcnt lgkmcnt(0)
    v_mfma_f32_16x16x32_bf16 a[0:3], a[232:235], v[128:131], a[0:3]
    s_mov_b32 s33, 14336
    buffer_store_dwordx4 v[224:227], v18, s[20:23], s33 offen sc0 sc1
    v_cvt_pk_bf16_f32 v232, v232, v233
    v_cvt_pk_bf16_f32 v233, v234, v235
    v_mfma_f32_16x16x32_bf16 a[8:11], a[232:235], v[132:135], a[8:11]
    v_mfma_f32_16x16x32_bf16 a[4:7], a[236:239], v[128:131], a[4:7]
    v_cvt_pk_bf16_f32 v234, v236, v237
    v_cvt_pk_bf16_f32 v235, v238, v239
    s_mov_b32 s33, 14336
    buffer_store_dwordx4 v[232:235], v19, s[20:23], s33 offen sc0 sc1
    v_mfma_f32_16x16x32_bf16 a[12:15], a[236:239], v[132:135], a[12:15]
    v_cvt_pk_bf16_f32 v240, v240, v241
    v_cvt_pk_bf16_f32 v241, v242, v243
    v_cvt_pk_bf16_f32 v242, v244, v245
    v_cvt_pk_bf16_f32 v243, v246, v247
    s_mov_b32 s33, 15360
    buffer_store_dwordx4 v[240:243], v18, s[20:23], s33 offen sc0 sc1
    v_cvt_pk_bf16_f32 v248, v248, v249
    v_cvt_pk_bf16_f32 v249, v250, v251
    v_cvt_pk_bf16_f32 v250, v252, v253
    v_cvt_pk_bf16_f32 v251, v254, v255
    s_mov_b32 s33, 15360
    buffer_store_dwordx4 v[248:251], v19, s[20:23], s33 offen sc0 sc1
    v_cvt_pk_bf16_f32 v48, v48, v49
    v_cvt_pk_bf16_f32 v49, v50, v51
    v_cvt_pk_bf16_f32 v50, v52, v53
    v_cvt_pk_bf16_f32 v51, v54, v55
    s_mov_b32 s33, 16384
    buffer_store_dwordx4 v[48:51], v18, s[20:23], s33 offen sc0 sc1
    v_cvt_pk_bf16_f32 v56, v56, v57
    v_cvt_pk_bf16_f32 v57, v58, v59
    v_cvt_pk_bf16_f32 v58, v60, v61
    v_cvt_pk_bf16_f32 v59, v62, v63
    s_mov_b32 s33, 16384
    buffer_store_dwordx4 v[56:59], v19, s[20:23], s33 offen sc0 sc1
    v_accvgpr_read_b32 v24, a0
    v_accvgpr_read_b32 v25, a1
    v_accvgpr_read_b32 v26, a2
    v_accvgpr_read_b32 v27, a3
    v_accvgpr_read_b32 v28, a4
    v_accvgpr_read_b32 v29, a5
    v_accvgpr_read_b32 v30, a6
    v_accvgpr_read_b32 v31, a7
    v_cvt_pk_bf16_f32 v24, v24, v25
    v_cvt_pk_bf16_f32 v25, v26, v27
    v_cvt_pk_bf16_f32 v26, v28, v29
    v_cvt_pk_bf16_f32 v27, v30, v31
    s_mov_b32 s33, 17408
    buffer_store_dwordx4 v[24:27], v18, s[20:23], s33 offen sc0 sc1
    s_nop 1
    v_accvgpr_read_b32 v24, a8
    v_accvgpr_read_b32 v25, a9
    v_accvgpr_read_b32 v26, a10
    v_accvgpr_read_b32 v27, a11
    v_accvgpr_read_b32 v28, a12
    v_accvgpr_read_b32 v29, a13
    v_accvgpr_read_b32 v30, a14
    v_accvgpr_read_b32 v31, a15
    v_cvt_pk_bf16_f32 v24, v24, v25
    v_cvt_pk_bf16_f32 v25, v26, v27
    v_cvt_pk_bf16_f32 v26, v28, v29
    v_cvt_pk_bf16_f32 v27, v30, v31
    s_mov_b32 s33, 17408
    buffer_store_dwordx4 v[24:27], v19, s[20:23], s33 offen sc0 sc1
L_k3_done:
    s_endpgm
.section .rodata,"a"
.p2align 6
.amdhsa_kernel ffn_kernel
  .amdhsa_next_free_vgpr 512
  .amdhsa_next_free_sgpr 102
  .amdhsa_accum_offset 256
  .amdhsa_group_segment_fixed_size 0
  .amdhsa_kernarg_size 80
  .amdhsa_user_sgpr_count 2
  .amdhsa_user_sgpr_kernarg_segment_ptr 1
  .amdhsa_system_sgpr_workgroup_id_x 1
.end_amdhsa_kernel
.text
.globl red_kernel
.p2align 8
.type red_kernel,@function
red_kernel:

    s_cmp_ge_u32 s2, 256
    s_cbranch_scc1 L_k4_done
    s_load_dwordx2 s[4:5], s[0:1], 56
    s_load_dwordx2 s[6:7], s[0:1], 72
    v_lshrrev_b32 v1, 6, v0
    s_nop 0
    v_readfirstlane_b32 s3, v1
    v_and_b32 v1, 63, v0
    s_mul_i32 s20, s2, 9
    s_add_u32 s20, s20, s3
    s_mul_i32 s21, s20, 3641
    s_lshr_b32 s21, s21, 16
    s_mul_i32 s22, s21, 18
    s_sub_u32 s22, s20, s22
    s_lshl_b32 s23, s20, 10
    v_lshl_add_u32 v2, v1, 4, s23
    s_lshl_b32 s24, s21, 4
    v_and_b32 v3, 15, v1
    v_add_u32 v3, s24, v3
    v_mul_u32_u24 v3, 1152, v3
    v_lshrrev_b32 v4, 4, v1
    v_lshl_add_u32 v3, v4, 3, v3
    s_lshl_b32 s25, s22, 6
    v_add_u32 v3, s25, v3
    s_mov_b32 s27, 0xffff0000
    s_waitcnt lgkmcnt(0)
    s_add_u32 s16, s6, 4915200
    s_addc_u32 s17, s7, 0
    s_and_b32 s17, s17, 0xffff
    s_mov_b32 s18, 37748736
    s_mov_b32 s19, 0x00020000
    s_mov_b32 s26, 0
    buffer_load_dwordx4 v[12:15], v2, s[16:19], s26 offen
    s_add_u32 s26, s26, 2359296
    buffer_load_dwordx4 v[16:19], v2, s[16:19], s26 offen
    s_add_u32 s26, s26, 2359296
    buffer_load_dwordx4 v[20:23], v2, s[16:19], s26 offen
    s_add_u32 s26, s26, 2359296
    buffer_load_dwordx4 v[24:27], v2, s[16:19], s26 offen
    s_add_u32 s26, s26, 2359296
    buffer_load_dwordx4 v[28:31], v2, s[16:19], s26 offen
    s_add_u32 s26, s26, 2359296
    buffer_load_dwordx4 v[32:35], v2, s[16:19], s26 offen
    s_add_u32 s26, s26, 2359296
    buffer_load_dwordx4 v[36:39], v2, s[16:19], s26 offen
    s_add_u32 s26, s26, 2359296
    buffer_load_dwordx4 v[40:43], v2, s[16:19], s26 offen
    s_add_u32 s26, s26, 2359296
    buffer_load_dwordx4 v[44:47], v2, s[16:19], s26 offen
    s_add_u32 s26, s26, 2359296
    buffer_load_dwordx4 v[48:51], v2, s[16:19], s26 offen
    s_add_u32 s26, s26, 2359296
    buffer_load_dwordx4 v[52:55], v2, s[16:19], s26 offen
    s_add_u32 s26, s26, 2359296
    buffer_load_dwordx4 v[56:59], v2, s[16:19], s26 offen
    s_add_u32 s26, s26, 2359296
    buffer_load_dwordx4 v[60:63], v2, s[16:19], s26 offen
    s_add_u32 s26, s26, 2359296
    buffer_load_dwordx4 v[64:67], v2, s[16:19], s26 offen
    s_add_u32 s26, s26, 2359296
    buffer_load_dwordx4 v[68:71], v2, s[16:19], s26 offen
    s_add_u32 s26, s26, 2359296
    buffer_load_dwordx4 v[72:75], v2, s[16:19], s26 offen
    s_add_u32 s12, s6, 2555904
    s_addc_u32 s13, s7, 0
    s_and_b32 s13, s13, 0xffff
    s_mov_b32 s14, 2359296
    s_mov_b32 s15, 0x00020000
    buffer_load_dwordx4 v[8:11], v2, s[12:15], 0 offen
    s_mov_b32 s8, s4
    s_and_b32 s9, s5, 0xffff
    s_mov_b32 s10, 2359296
    s_mov_b32 s11, 0x00020000
    s_waitcnt vmcnt(16)
    v_lshlrev_b32 v80, 16, v12
    v_and_b32 v81, s27, v12
    v_lshlrev_b32 v82, 16, v13
    v_and_b32 v83, s27, v13
    v_lshlrev_b32 v84, 16, v14
    v_and_b32 v85, s27, v14
    v_lshlrev_b32 v86, 16, v15
    v_and_b32 v87, s27, v15
    s_waitcnt vmcnt(15)
    v_lshlrev_b32 v88, 16, v16
    v_and_b32 v89, s27, v16
    v_pk_add_f32 v[80:81], v[80:81], v[88:89]
    v_lshlrev_b32 v90, 16, v17
    v_and_b32 v91, s27, v17
    v_pk_add_f32 v[82:83], v[82:83], v[90:91]
    v_lshlrev_b32 v88, 16, v18
    v_and_b32 v89, s27, v18
    v_pk_add_f32 v[84:85], v[84:85], v[88:89]
    v_lshlrev_b32 v90, 16, v19
    v_and_b32 v91, s27, v19
    v_pk_add_f32 v[86:87], v[86:87], v[90:91]
    s_waitcnt vmcnt(14)
    v_lshlrev_b32 v88, 16, v20
    v_and_b32 v89, s27, v20
    v_pk_add_f32 v[80:81], v[80:81], v[88:89]
    v_lshlrev_b32 v90, 16, v21
    v_and_b32 v91, s27, v21
    v_pk_add_f32 v[82:83], v[82:83], v[90:91]
    v_lshlrev_b32 v88, 16, v22
    v_and_b32 v89, s27, v22
    v_pk_add_f32 v[84:85], v[84:85], v[88:89]
    v_lshlrev_b32 v90, 16, v23
    v_and_b32 v91, s27, v23
    v_pk_add_f32 v[86:87], v[86:87], v[90:91]
    s_waitcnt vmcnt(13)
    v_lshlrev_b32 v88, 16, v24
    v_and_b32 v89, s27, v24
    v_pk_add_f32 v[80:81], v[80:81], v[88:89]
    v_lshlrev_b32 v90, 16, v25
    v_and_b32 v91, s27, v25
    v_pk_add_f32 v[82:83], v[82:83], v[90:91]
    v_lshlrev_b32 v88, 16, v26
    v_and_b32 v89, s27, v26
    v_pk_add_f32 v[84:85], v[84:85], v[88:89]
    v_lshlrev_b32 v90, 16, v27
    v_and_b32 v91, s27, v27
    v_pk_add_f32 v[86:87], v[86:87], v[90:91]
    s_waitcnt vmcnt(12)
    v_lshlrev_b32 v88, 16, v28
    v_and_b32 v89, s27, v28
    v_pk_add_f32 v[80:81], v[80:81], v[88:89]
    v_lshlrev_b32 v90, 16, v29
    v_and_b32 v91, s27, v29
    v_pk_add_f32 v[82:83], v[82:83], v[90:91]
    v_lshlrev_b32 v88, 16, v30
    v_and_b32 v89, s27, v30
    v_pk_add_f32 v[84:85], v[84:85], v[88:89]
    v_lshlrev_b32 v90, 16, v31
    v_and_b32 v91, s27, v31
    v_pk_add_f32 v[86:87], v[86:87], v[90:91]
    s_waitcnt vmcnt(11)
    v_lshlrev_b32 v88, 16, v32
    v_and_b32 v89, s27, v32
    v_pk_add_f32 v[80:81], v[80:81], v[88:89]
    v_lshlrev_b32 v90, 16, v33
    v_and_b32 v91, s27, v33
    v_pk_add_f32 v[82:83], v[82:83], v[90:91]
    v_lshlrev_b32 v88, 16, v34
    v_and_b32 v89, s27, v34
    v_pk_add_f32 v[84:85], v[84:85], v[88:89]
    v_lshlrev_b32 v90, 16, v35
    v_and_b32 v91, s27, v35
    v_pk_add_f32 v[86:87], v[86:87], v[90:91]
    s_waitcnt vmcnt(10)
    v_lshlrev_b32 v88, 16, v36
    v_and_b32 v89, s27, v36
    v_pk_add_f32 v[80:81], v[80:81], v[88:89]
    v_lshlrev_b32 v90, 16, v37
    v_and_b32 v91, s27, v37
    v_pk_add_f32 v[82:83], v[82:83], v[90:91]
    v_lshlrev_b32 v88, 16, v38
    v_and_b32 v89, s27, v38
    v_pk_add_f32 v[84:85], v[84:85], v[88:89]
    v_lshlrev_b32 v90, 16, v39
    v_and_b32 v91, s27, v39
    v_pk_add_f32 v[86:87], v[86:87], v[90:91]
    s_waitcnt vmcnt(9)
    v_lshlrev_b32 v88, 16, v40
    v_and_b32 v89, s27, v40
    v_pk_add_f32 v[80:81], v[80:81], v[88:89]
    v_lshlrev_b32 v90, 16, v41
    v_and_b32 v91, s27, v41
    v_pk_add_f32 v[82:83], v[82:83], v[90:91]
    v_lshlrev_b32 v88, 16, v42
    v_and_b32 v89, s27, v42
    v_pk_add_f32 v[84:85], v[84:85], v[88:89]
    v_lshlrev_b32 v90, 16, v43
    v_and_b32 v91, s27, v43
    v_pk_add_f32 v[86:87], v[86:87], v[90:91]
    s_waitcnt vmcnt(8)
    v_lshlrev_b32 v88, 16, v44
    v_and_b32 v89, s27, v44
    v_pk_add_f32 v[80:81], v[80:81], v[88:89]
    v_lshlrev_b32 v90, 16, v45
    v_and_b32 v91, s27, v45
    v_pk_add_f32 v[82:83], v[82:83], v[90:91]
    v_lshlrev_b32 v88, 16, v46
    v_and_b32 v89, s27, v46
    v_pk_add_f32 v[84:85], v[84:85], v[88:89]
    v_lshlrev_b32 v90, 16, v47
    v_and_b32 v91, s27, v47
    v_pk_add_f32 v[86:87], v[86:87], v[90:91]
    s_waitcnt vmcnt(7)
    v_lshlrev_b32 v88, 16, v48
    v_and_b32 v89, s27, v48
    v_pk_add_f32 v[80:81], v[80:81], v[88:89]
    v_lshlrev_b32 v90, 16, v49
    v_and_b32 v91, s27, v49
    v_pk_add_f32 v[82:83], v[82:83], v[90:91]
    v_lshlrev_b32 v88, 16, v50
    v_and_b32 v89, s27, v50
    v_pk_add_f32 v[84:85], v[84:85], v[88:89]
    v_lshlrev_b32 v90, 16, v51
    v_and_b32 v91, s27, v51
    v_pk_add_f32 v[86:87], v[86:87], v[90:91]
    s_waitcnt vmcnt(6)
    v_lshlrev_b32 v88, 16, v52
    v_and_b32 v89, s27, v52
    v_pk_add_f32 v[80:81], v[80:81], v[88:89]
    v_lshlrev_b32 v90, 16, v53
    v_and_b32 v91, s27, v53
    v_pk_add_f32 v[82:83], v[82:83], v[90:91]
    v_lshlrev_b32 v88, 16, v54
    v_and_b32 v89, s27, v54
    v_pk_add_f32 v[84:85], v[84:85], v[88:89]
    v_lshlrev_b32 v90, 16, v55
    v_and_b32 v91, s27, v55
    v_pk_add_f32 v[86:87], v[86:87], v[90:91]
    s_waitcnt vmcnt(5)
    v_lshlrev_b32 v88, 16, v56
    v_and_b32 v89, s27, v56
    v_pk_add_f32 v[80:81], v[80:81], v[88:89]
    v_lshlrev_b32 v90, 16, v57
    v_and_b32 v91, s27, v57
    v_pk_add_f32 v[82:83], v[82:83], v[90:91]
    v_lshlrev_b32 v88, 16, v58
    v_and_b32 v89, s27, v58
    v_pk_add_f32 v[84:85], v[84:85], v[88:89]
    v_lshlrev_b32 v90, 16, v59
    v_and_b32 v91, s27, v59
    v_pk_add_f32 v[86:87], v[86:87], v[90:91]
    s_waitcnt vmcnt(4)
    v_lshlrev_b32 v88, 16, v60
    v_and_b32 v89, s27, v60
    v_pk_add_f32 v[80:81], v[80:81], v[88:89]
    v_lshlrev_b32 v90, 16, v61
    v_and_b32 v91, s27, v61
    v_pk_add_f32 v[82:83], v[82:83], v[90:91]
    v_lshlrev_b32 v88, 16, v62
    v_and_b32 v89, s27, v62
    v_pk_add_f32 v[84:85], v[84:85], v[88:89]
    v_lshlrev_b32 v90, 16, v63
    v_and_b32 v91, s27, v63
    v_pk_add_f32 v[86:87], v[86:87], v[90:91]
    s_waitcnt vmcnt(3)
    v_lshlrev_b32 v88, 16, v64
    v_and_b32 v89, s27, v64
    v_pk_add_f32 v[80:81], v[80:81], v[88:89]
    v_lshlrev_b32 v90, 16, v65
    v_and_b32 v91, s27, v65
    v_pk_add_f32 v[82:83], v[82:83], v[90:91]
    v_lshlrev_b32 v88, 16, v66
    v_and_b32 v89, s27, v66
    v_pk_add_f32 v[84:85], v[84:85], v[88:89]
    v_lshlrev_b32 v90, 16, v67
    v_and_b32 v91, s27, v67
    v_pk_add_f32 v[86:87], v[86:87], v[90:91]
    s_waitcnt vmcnt(2)
    v_lshlrev_b32 v88, 16, v68
    v_and_b32 v89, s27, v68
    v_pk_add_f32 v[80:81], v[80:81], v[88:89]
    v_lshlrev_b32 v90, 16, v69
    v_and_b32 v91, s27, v69
    v_pk_add_f32 v[82:83], v[82:83], v[90:91]
    v_lshlrev_b32 v88, 16, v70
    v_and_b32 v89, s27, v70
    v_pk_add_f32 v[84:85], v[84:85], v[88:89]
    v_lshlrev_b32 v90, 16, v71
    v_and_b32 v91, s27, v71
    v_pk_add_f32 v[86:87], v[86:87], v[90:91]
    s_waitcnt vmcnt(1)
    v_lshlrev_b32 v88, 16, v72
    v_and_b32 v89, s27, v72
    v_pk_add_f32 v[80:81], v[80:81], v[88:89]
    v_lshlrev_b32 v90, 16, v73
    v_and_b32 v91, s27, v73
    v_pk_add_f32 v[82:83], v[82:83], v[90:91]
    v_lshlrev_b32 v88, 16, v74
    v_and_b32 v89, s27, v74
    v_pk_add_f32 v[84:85], v[84:85], v[88:89]
    v_lshlrev_b32 v90, 16, v75
    v_and_b32 v91, s27, v75
    v_pk_add_f32 v[86:87], v[86:87], v[90:91]
    v_mov_b32 v94, 0xbf317218
    s_waitcnt vmcnt(0)
    v_lshlrev_b32 v88, 16, v8
    v_and_b32 v89, s27, v8
    v_fma_f32 v80, v80, v94, v88
    v_fma_f32 v81, v81, v94, v89
    v_lshlrev_b32 v90, 16, v9
    v_and_b32 v91, s27, v9
    v_fma_f32 v82, v82, v94, v90
    v_fma_f32 v83, v83, v94, v91
    v_lshlrev_b32 v88, 16, v10
    v_and_b32 v89, s27, v10
    v_fma_f32 v84, v84, v94, v88
    v_fma_f32 v85, v85, v94, v89
    v_lshlrev_b32 v90, 16, v11
    v_and_b32 v91, s27, v11
    v_fma_f32 v86, v86, v94, v90
    v_fma_f32 v87, v87, v94, v91
    v_cvt_pk_bf16_f32 v12, v80, v81
    v_cvt_pk_bf16_f32 v13, v82, v83
    v_cvt_pk_bf16_f32 v14, v84, v85
    v_cvt_pk_bf16_f32 v15, v86, v87
    buffer_store_dwordx2 v[12:13], v3, s[8:11], 0 offen
    buffer_store_dwordx2 v[14:15], v3, s[8:11], 0 offen offset:32
L_k4_done:
    s_endpgm
.section .rodata,"a"
.p2align 6
.amdhsa_kernel red_kernel
  .amdhsa_next_free_vgpr 96
  .amdhsa_next_free_sgpr 102
  .amdhsa_accum_offset 96
  .amdhsa_group_segment_fixed_size 0
  .amdhsa_kernarg_size 80
  .amdhsa_user_sgpr_count 2
  .amdhsa_user_sgpr_kernarg_segment_ptr 1
  .amdhsa_system_sgpr_workgroup_id_x 1
.end_amdhsa_kernel
.text
L_code_end:
    s_endpgm
```
